```python
import torch

def _softmax(x, axis=-1):
    return torch.softmax(x, dim=axis)
def _gelu(x):
    return torch.nn.functional.gelu(x, approximate="tanh")
def _silu(x):
    return torch.nn.functional.silu(x)
def _sigmoid(x):
    return torch.sigmoid(x)
def _layernorm(x, axis=-1, eps=1e-5):
    m = x.mean(dim=axis, keepdim=True)
    v = x.var(dim=axis, keepdim=True, unbiased=False)
    return (x - m) / torch.sqrt(v + eps)
def _scatter_add(tgt, idx, src, axis=0):
    return tgt.clone().index_add_(axis, idx, src)
def _segment_sum(src, seg, n):
    out = torch.zeros((n,) + src.shape[1:], dtype=src.dtype)
    return out.index_add_(0, seg, src)
def _pad(x, pw):
    flat = tuple(v for pair in reversed(pw) for v in pair)
    return torch.nn.functional.pad(x, flat)

kernel_name = 'interleave_layers__ssm_conv_s4d__dense_activation_silu__prompt'

def setup_inputs():

    _w = (lambda a: (lambda t: t.to(torch.bfloat16) if t.is_floating_point() else t)(torch.as_tensor(a)))
    def _A_setup():
        Bsz, L, D, N = 1, 2048, 512, 128
        return {
            "u": _w((lambda *s: torch.randn(*s, dtype=torch.bfloat16) * 0.05)(Bsz, L, D)),
            "log_A_real": _w((lambda *s: torch.randn(*s, dtype=torch.bfloat16) * 3.2)(D, N) * 0.5),
            "A_imag": _w((lambda *s: torch.randn(*s, dtype=torch.bfloat16) * 0.05)(D, N) * 3.14),
            "C_real": _w((lambda *s: torch.randn(*s, dtype=torch.bfloat16) * 0.05)(D, N) / N ** 0.5),
            "C_imag": _w((lambda *s: torch.randn(*s, dtype=torch.bfloat16) * 0.05)(D, N) / N ** 0.5),
            "log_dt": _w((lambda *s: torch.randn(*s, dtype=torch.bfloat16) * 0.05)(D) * 0.5 - 4.0),
            "D_skip": _w((lambda *s: torch.randn(*s, dtype=torch.bfloat16) * 0.05)(D)),
        }
    _A_in = _A_setup()

    def _B_setup():
        B, S, D, F = 1, 2048, 512, 1792
        return {
            "x": _w((lambda *s: torch.randn(*s, dtype=torch.bfloat16) * 0.05)(B, S, D)),
            "w1": _w((lambda *s: torch.randn(*s, dtype=torch.bfloat16) * 0.8)(D, F) * (D ** -0.5)),
            "w2": _w((lambda *s: torch.randn(*s, dtype=torch.bfloat16) * 0.2)(F, D) * (F ** -0.5)),
        }
    _B_in = _B_setup()

    return {
        "A_u": _A_in["u"],
        "A_log_A_real": _A_in["log_A_real"],
        "A_A_imag": _A_in["A_imag"],
        "A_C_real": _A_in["C_real"],
        "A_C_imag": _A_in["C_imag"],
        "A_log_dt": _A_in["log_dt"],
        "A_D_skip": _A_in["D_skip"],
        "B_x": _B_in["x"],
        "B_w1": _B_in["w1"],
        "B_w2": _B_in["w2"],
    }

def reference(A_u, A_log_A_real, A_A_imag, A_C_real, A_C_imag, A_log_dt, A_D_skip, B_x, B_w1, B_w2):
    def _A_ref(u, log_A_real, A_imag, C_real, C_imag, log_dt, D_skip):
        L = u.shape[1]
        dt = torch.exp(log_dt)
        A = -torch.exp(log_A_real) + 1j * A_imag
        C = (C_real + 1j * C_imag) * dt[:, None]
        pos = (lambda x, dt: x.to(dt))(torch.arange(L), log_dt.dtype)
        P = torch.exp((A * dt[:, None])[:, :, None] * pos[None, None, :])
        K = 2.0 * torch.einsum("dn,dnl->dl", C, P).real
        L2 = 2 * L
        u_t = (lambda x, *d: x.permute(*d))(u, 0, 2, 1)
        Kf = (lambda x, *a, **k: torch.fft.rfft(x.float(), *a, **k))(K, L2)
        Uf = (lambda x, *a, **k: torch.fft.rfft(x.float(), *a, **k))(u_t, L2)
        y = (lambda x, *a, **k: torch.fft.irfft(x, *a, **k).to(torch.bfloat16))(Uf * Kf[None, :, :], L2)[:, :, :L]
        y = (lambda x, *d: x.permute(*d))(y, 0, 2, 1)
        return y + u * D_skip[None, None, :]

    def _B_ref(x, w1, w2):
        h = torch.einsum("bsd,df->bsf", x, w1)
        h = _silu(h)
        out = torch.einsum("bsf,fd->bsd", h, w2)
        return out

    x = A_u
    x = x + _A_ref(_layernorm(x, axis=-1), A_log_A_real, A_A_imag, A_C_real, A_C_imag, A_log_dt, A_D_skip)
    x = x + _B_ref(_layernorm(x, axis=-1), B_w1, B_w2)
    x = x + _A_ref(_layernorm(x, axis=-1), A_log_A_real, A_A_imag, A_C_real, A_C_imag, A_log_dt, A_D_skip)
    x = x + _B_ref(_layernorm(x, axis=-1), B_w1, B_w2)
    return x
```

```asm
; @launch grid=(256,1,1) block=(256,1,1) lds=163840
.amdgcn_target "amdgcn-amd-amdhsa--gfx950"
.text
.globl interleave_layers__ssm_conv_s4d__dense_activation_silu__prompt_kernel
.p2align 8
.type interleave_layers__ssm_conv_s4d__dense_activation_silu__prompt_kernel,@function
interleave_layers__ssm_conv_s4d__dense_activation_silu__prompt_kernel:
    s_cmp_ge_u32 s2, 256
    s_cbranch_scc1 main_end
    s_load_dwordx16 s[12:27], s[0:1], 0
    s_load_dwordx2 s[8:9], s[0:1], 96
    s_load_dwordx4 s[4:7], s[0:1], 80
    s_load_dwordx4 s[28:31], s[0:1], 64
    s_getpc_b64 s[48:49]
pf_here:
    v_lshlrev_b32 v2, 7, v0
    v_min_u32 v3, code_end-pf_here-4, v2
    v_lshlrev_b32 v3, 5, v0
    v_and_b32 v3, 0xffffff80, v3
    global_load_dword v150, v3, s[48:49]
    v_and_b32 v1, 63, v0
    v_lshrrev_b32 v5, 6, v0
    s_nop 0
    v_readfirstlane_b32 s10, v5
    s_lshl_b32 s40, s2, 13
    v_lshlrev_b32 v6, 11, v5
    v_lshl_add_u32 v6, v1, 4, v6
    v_add_u32 v6, s40, v6
    v_lshl_add_u32 v46, v0, 4, s40
    s_lshl_b32 s41, s2, 10
    s_add_u32 s41, s41, 17039360
    v_lshlrev_b32 v5, 8, v5
    v_lshl_add_u32 v5, v1, 4, v5
    v_add_u32 v5, s41, v5
    v_mov_b32 v50, 0
    v_mov_b32 v51, 0
    v_mov_b32 v52, 0
    v_mov_b32 v53, 0
    s_and_b32 s50, s2, 7
    s_lshl_b32 s50, s50, 5
    s_lshr_b32 s32, s2, 3
    s_or_b32 s50, s50, s32
    s_lshr_b32 s47, s10, 1
    s_and_b32 s34, s10, 1
    s_lshl_b32 s35, s50, 1
    s_add_u32 s35, s35, s47
    s_lshl_b32 s36, s35, 8
    s_lshl_b32 s37, s34, 7
    s_add_u32 s37, s37, s36
    v_lshl_add_u32 v3, v1, 1, s37
    v_lshl_add_u32 v7, v1, 2, s36
    s_lshl_b32 s37, s50, 2
    v_mov_b32 v10, 0
    v_mov_b32 v11, 0
    v_mov_b32 v12, 0
    v_mov_b32 v13, 0
    s_add_u32 s40, s2, s10
    s_waitcnt lgkmcnt(0)
    global_load_dwordx4 v[32:35], v6, s[12:13]
    global_load_dwordx4 v[36:39], v6, s[12:13] offset:1024
    global_load_short_d16_hi v10, v3, s[14:15]
    global_load_short_d16_hi v11, v3, s[16:17]
    global_load_short_d16_hi v12, v3, s[18:19]
    global_load_short_d16_hi v13, v3, s[20:21]
    global_load_dword v8, v7, s[18:19]
    global_load_dword v9, v7, s[20:21]
    s_mov_b32 s68, s30
    s_mov_b32 s69, s31
    s_cmp_lg_u32 s40, 0
    s_cbranch_scc1 prep_notag
    s_memrealtime s[66:67]
    s_waitcnt lgkmcnt(0)
    s_or_b32 s66, s66, 1
    v_mov_b32 v14, s66
    v_mov_b32 v15, s67
    s_mov_b64 exec, 1
    global_store_dwordx2 v50, v[14:15], s[6:7] sc1
    s_mov_b64 exec, -1
prep_notag:
    s_load_dword s30, s[22:23], s37
    s_load_dword s52, s[24:25], s37
    s_mov_b64 exec, 0xffff
    global_store_dwordx4 v5, v[50:53], s[8:9] sc1
    v_lshlrev_b32 v148, 20, v1
    global_load_dword v148, v148, s[8:9] sc1
    s_mov_b64 exec, 1
    global_load_dword v143, v50, s[6:7] offset:128 sc1
    s_mov_b64 exec, -1
    v_lshrrev_b32 v2, 4, v0
    v_lshlrev_b32 v2, 7, v2
    s_lshl_b32 s41, s32, 11
    v_add_u32 v2, s41, v2
    v_min_u32 v2, code_end-pf_here-4, v2
    s_mov_b32 s64, s6
    s_mov_b32 s65, s7
    s_mov_b32 s6, s4
    s_mov_b32 s7, s5
    s_mov_b32 s36, s28
    s_mov_b32 s37, s29
    s_mov_b32 s38, 1835008
    s_mov_b32 s39, 0x20000
    s_mov_b32 s70, 1835008
    s_mov_b32 s71, 0x20000
    s_lshl_b32 s40, s2, 1
    s_add_u32 s40, s40, s34
    s_mul_i32 s40, s40, 3584
    v_min_u32 v7, 27, v1
    v_lshl_add_u32 v5, v7, 7, s40
    s_cmp_ge_u32 s10, 2
    s_cselect_b64 s[42:43], s[68:69], s[36:37]
    v_mov_b32 v149, v5
    v_mov_b32 v151, v2
    s_mov_b64 s[44:45], s[42:43]
    s_mov_b64 s[62:63], s[48:49]
    global_load_dword v149, v149, s[44:45]
    global_load_dword v151, v151, s[62:63]
    s_and_b32 s11, s2, 7
    s_lshl_b32 s11, s11, 1
    s_lshr_b32 s12, s2, 7
    s_add_u32 s11, s11, s12
    s_bfe_u32 s12, s2, 0x40003
    s_lshl_b32 s13, s12, 2
    s_add_u32 s13, s13, s10
    s_min_u32 s13, s13, 55
    s_and_b32 s35, s12, 1
    s_lshl_b32 s32, s11, 1
    s_add_u32 s32, s32, s35
    s_lshr_b32 s33, s12, 1
    s_lshl_b32 s46, s33, 6
    s_lshl_b32 s14, s10, 4
    s_add_u32 s46, s46, s14
    s_mul_i32 s14, s10, 28672
    s_mul_i32 s42, s32, 114688
    s_add_u32 s42, s42, s14
    s_add_u32 s42, s42, 6291456
    s_mul_i32 s40, s11, 229376
    s_lshl_b32 s14, s13, 11
    s_add_u32 s40, s40, s14
    s_add_u32 s40, s40, 6291456
    s_mov_b32 s18, 0x200000
    s_mov_b32 s19, 0x20000
    s_lshr_b32 s56, s50, 1
    s_lshl_b32 s56, s56, 14
    s_and_b32 s15, s50, 1
    s_lshl_b32 s15, s15, 2
    s_add_u32 s56, s56, s15
    s_lshl_b32 s57, s50, 13
    s_lshl_b32 s20, s10, 15
    s_lshl_b32 s21, s10, 10
    s_mov_b32 s48, 0x8000
    s_mov_b32 s49, 0x100000
    s_cmp_eq_u32 s12, 15
    s_cselect_b32 s14, s48, 0
    s_cselect_b32 s15, s49, 0
    s_or_b32 s21, s21, s14
    s_or_b32 s20, s20, s15
    s_lshl_b32 s24, s50, 5
    s_add_u32 s58, s24, 17137664
    s_lshl_b32 s15, s11, 11
    s_add_u32 s15, s15, 17104896
    s_lshl_b32 s59, s12, 7
    s_add_u32 s59, s59, s15
    s_mul_i32 s60, s10, 7
    s_lshr_b32 s60, s60, 1
    s_lshl_b32 s60, s60, 7
    s_add_u32 s60, s60, s15
    s_lshl_b32 s24, s2, 2
    s_add_u32 s24, s24, s10
    s_lshl_b32 s24, s24, 7
    s_add_u32 s24, s24, 16908288
    s_cmp_eq_u32 s10, 0
    s_cselect_b32 s58, s58, s24
    s_cselect_b32 s59, s59, s24
    s_lshl_b32 s29, s50, 5
    s_add_u32 s29, s29, 16842752
    s_cmp_eq_u32 s10, 0
    s_cselect_b32 s29, s29, s24
    v_mov_b32 v152, s58
    s_mov_b32 s25, 0x3f803f80
    s_mov_b32 s26, 0x3b000000
    s_mov_b32 s27, 0x3727c5ac
    s_mov_b32 s31, 0xbfb8aa3b
    s_add_u32 s40, s8, s40
    s_addc_u32 s41, s9, 0
    s_add_u32 s42, s8, s42
    s_addc_u32 s43, s9, 0
    s_lshl_b32 s22, s13, 6
    s_mul_i32 s23, s10, 458752
    s_lshl_b32 s24, s33, 7
    s_add_u32 s23, s23, s24
    s_lshl_b32 s28, s10, 14
    s_add_u32 s28, s28, 98304
    v_lshrrev_b32 v2, 2, v1
    v_mul_u32_u24 v154, 3584, v2
    v_and_b32 v3, 3, v1
    v_lshl_add_u32 v154, v3, 4, v154
    v_lshrrev_b32 v2, 3, v1
    v_and_b32 v5, 7, v1
    v_bfe_u32 v155, v1, 4, 1
    v_lshlrev_b32 v157, 5, v155
    v_lshlrev_b32 v155, 2, v155
    v_xor_b32 v155, v155, v5
    v_lshlrev_b32 v155, 4, v155
    v_lshl_add_u32 v155, v2, 10, v155
    v_lshl_add_u32 v157, v3, 3, v157
    v_lshrrev_b32 v3, 5, v1
    v_lshl_add_u32 v157, v3, 9, v157
    v_add_u32 v157, s28, v157
    v_bfe_u32 v2, v1, 2, 2
    v_lshl_add_u32 v156, v2, 6, v157
    v_lshl_add_u32 v157, v2, 7, v157
    v_lshrrev_b32 v2, 1, v2
    v_xor_b32 v5, 1, v2
    v_lshl_add_u32 v158, v5, 6, v157
    v_lshl_add_u32 v157, v2, 6, v157
    s_lshl_b32 s24, s10, 5
    v_xor_b32 v157, s24, v157
    v_xor_b32 v158, s24, v158
    s_mul_i32 s14, s47, 27984
    s_lshl_b32 s15, s34, 8
    s_add_u32 s14, s14, s15
    v_lshl_add_u32 v126, v1, 2, s14
    v_and_b32 v2, 31, v1
    v_mul_u32_u24 v127, 528, v2
    v_lshl_add_u32 v127, v3, 4, v127
    v_add_u32 v127, s14, v127
    s_mul_i32 s14, s10, 8320
    s_add_u32 s14, s14, 56064
    v_lshl_add_u32 v2, v2, 2, s14
    v_lshl_add_u32 v48, v3, 9, v2
    v_lshl_add_u32 v49, v3, 12, v2
    v_lshl_add_u32 v28, v3, 10, v2
    v_lshlrev_b32 v3, 8, v3
    v_add_u32 v3, 256, v3
    v_add_u32 v29, v28, v3
    v_add_u32 v30, v29, v3
    v_add_u32 v31, v30, v3
    v_and_b32 v2, 15, v1
    v_xor_b32 v2, s10, v2
    v_lshlrev_b32 v40, 7, v1
    v_add_u32 v40, 89600, v40
    v_lshl_add_u32 v40, v2, 3, v40
    v_xor_b32 v41, 32, v40
    v_xor_b32 v42, 64, v40
    v_xor_b32 v43, 0x60, v40
    v_lshrrev_b32 v2, 3, v0
    v_and_b32 v3, 7, v0
    v_lshlrev_b32 v3, 1, v3
    v_and_b32 v5, 15, v2
    v_xor_b32 v3, v3, v5
    v_lshlrev_b32 v44, 7, v2
    v_add_u32 v44, 89600, v44
    v_xor_b32 v5, 1, v3
    v_lshl_add_u32 v45, v5, 3, v44
    v_lshl_add_u32 v44, v3, 3, v44
    v_add_u32 v47, 4096, v46
    v_lshlrev_b32 v7, 3, v0
    v_sub_u32 v7, 2047, v7
    v_subrev_u32 v52, 0, v7
    v_subrev_u32 v53, 1, v7
    v_max_i32 v52, 0, v52
    v_max_i32 v53, 0, v53
    v_cvt_f32_u32 v52, v52
    v_cvt_f32_u32 v53, v53
    v_cvt_pk_bf16_f32 v54, v52, v53
    v_lshlrev_b32 v52, 16, v54
    v_and_b32 v53, 0xffff0000, v54
    v_cvt_u32_f32 v52, v52
    v_cvt_u32_f32 v53, v53
    v_lshrrev_b32 v54, 8, v52
    v_and_b32 v55, 7, v52
    v_lshl_or_b32 v54, v54, 3, v55
    v_bfe_u32 v55, v52, 3, 5
    v_lshl_or_b32 v54, v54, 5, v55
    v_lshlrev_b32 v54, 2, v54
    v_add_u32 v16, 56064, v54
    v_lshrrev_b32 v54, 8, v53
    v_and_b32 v55, 7, v53
    v_lshl_or_b32 v54, v54, 3, v55
    v_bfe_u32 v55, v53, 3, 5
    v_lshl_or_b32 v54, v54, 5, v55
    v_lshlrev_b32 v54, 2, v54
    v_add_u32 v17, 56064, v54
    v_subrev_u32 v52, 2, v7
    v_subrev_u32 v53, 3, v7
    v_max_i32 v52, 0, v52
    v_max_i32 v53, 0, v53
    v_cvt_f32_u32 v52, v52
    v_cvt_f32_u32 v53, v53
    v_cvt_pk_bf16_f32 v54, v52, v53
    v_lshlrev_b32 v52, 16, v54
    v_and_b32 v53, 0xffff0000, v54
    v_cvt_u32_f32 v52, v52
    v_cvt_u32_f32 v53, v53
    v_lshrrev_b32 v54, 8, v52
    v_and_b32 v55, 7, v52
    v_lshl_or_b32 v54, v54, 3, v55
    v_bfe_u32 v55, v52, 3, 5
    v_lshl_or_b32 v54, v54, 5, v55
    v_lshlrev_b32 v54, 2, v54
    v_add_u32 v18, 56064, v54
    v_lshrrev_b32 v54, 8, v53
    v_and_b32 v55, 7, v53
    v_lshl_or_b32 v54, v54, 3, v55
    v_bfe_u32 v55, v53, 3, 5
    v_lshl_or_b32 v54, v54, 5, v55
    v_lshlrev_b32 v54, 2, v54
    v_add_u32 v19, 56064, v54
    v_subrev_u32 v52, 4, v7
    v_subrev_u32 v53, 5, v7
    v_max_i32 v52, 0, v52
    v_max_i32 v53, 0, v53
    v_cvt_f32_u32 v52, v52
    v_cvt_f32_u32 v53, v53
    v_cvt_pk_bf16_f32 v54, v52, v53
    v_lshlrev_b32 v52, 16, v54
    v_and_b32 v53, 0xffff0000, v54
    v_cvt_u32_f32 v52, v52
    v_cvt_u32_f32 v53, v53
    v_lshrrev_b32 v54, 8, v52
    v_and_b32 v55, 7, v52
    v_lshl_or_b32 v54, v54, 3, v55
    v_bfe_u32 v55, v52, 3, 5
    v_lshl_or_b32 v54, v54, 5, v55
    v_lshlrev_b32 v54, 2, v54
    v_add_u32 v20, 56064, v54
    v_lshrrev_b32 v54, 8, v53
    v_and_b32 v55, 7, v53
    v_lshl_or_b32 v54, v54, 3, v55
    v_bfe_u32 v55, v53, 3, 5
    v_lshl_or_b32 v54, v54, 5, v55
    v_lshlrev_b32 v54, 2, v54
    v_add_u32 v21, 56064, v54
    v_subrev_u32 v52, 6, v7
    v_subrev_u32 v53, 7, v7
    v_max_i32 v52, 0, v52
    v_max_i32 v53, 0, v53
    v_cvt_f32_u32 v52, v52
    v_cvt_f32_u32 v53, v53
    v_cvt_pk_bf16_f32 v54, v52, v53
    v_lshlrev_b32 v52, 16, v54
    v_and_b32 v53, 0xffff0000, v54
    v_cvt_u32_f32 v52, v52
    v_cvt_u32_f32 v53, v53
    v_lshrrev_b32 v54, 8, v52
    v_and_b32 v55, 7, v52
    v_lshl_or_b32 v54, v54, 3, v55
    v_bfe_u32 v55, v52, 3, 5
    v_lshl_or_b32 v54, v54, 5, v55
    v_lshlrev_b32 v54, 2, v54
    v_add_u32 v22, 56064, v54
    v_lshrrev_b32 v54, 8, v53
    v_and_b32 v55, 7, v53
    v_lshl_or_b32 v54, v54, 3, v55
    v_bfe_u32 v55, v53, 3, 5
    v_lshl_or_b32 v54, v54, 5, v55
    v_lshlrev_b32 v54, 2, v54
    v_add_u32 v23, 56064, v54
    v_subrev_u32 v52, 8, v7
    v_subrev_u32 v53, 9, v7
    v_max_i32 v52, 0, v52
    v_max_i32 v53, 0, v53
    v_cvt_f32_u32 v52, v52
    v_cvt_f32_u32 v53, v53
    v_cvt_pk_bf16_f32 v54, v52, v53
    v_lshlrev_b32 v52, 16, v54
    v_and_b32 v53, 0xffff0000, v54
    v_cvt_u32_f32 v52, v52
    v_cvt_u32_f32 v53, v53
    v_lshrrev_b32 v54, 8, v52
    v_and_b32 v55, 7, v52
    v_lshl_or_b32 v54, v54, 3, v55
    v_bfe_u32 v55, v52, 3, 5
    v_lshl_or_b32 v54, v54, 5, v55
    v_lshlrev_b32 v54, 2, v54
    v_add_u32 v24, 56064, v54
    v_lshrrev_b32 v54, 8, v53
    v_and_b32 v55, 7, v53
    v_lshl_or_b32 v54, v54, 3, v55
    v_bfe_u32 v55, v53, 3, 5
    v_lshl_or_b32 v54, v54, 5, v55
    v_lshlrev_b32 v54, 2, v54
    v_add_u32 v25, 56064, v54
    v_subrev_u32 v52, 10, v7
    v_subrev_u32 v53, 11, v7
    v_max_i32 v52, 0, v52
    v_max_i32 v53, 0, v53
    v_cvt_f32_u32 v52, v52
    v_cvt_f32_u32 v53, v53
    v_cvt_pk_bf16_f32 v54, v52, v53
    v_lshlrev_b32 v52, 16, v54
    v_and_b32 v53, 0xffff0000, v54
    v_cvt_u32_f32 v52, v52
    v_cvt_u32_f32 v53, v53
    v_lshrrev_b32 v54, 8, v52
    v_and_b32 v55, 7, v52
    v_lshl_or_b32 v54, v54, 3, v55
    v_bfe_u32 v55, v52, 3, 5
    v_lshl_or_b32 v54, v54, 5, v55
    v_lshlrev_b32 v54, 2, v54
    v_add_u32 v26, 56064, v54
    v_lshrrev_b32 v54, 8, v53
    v_and_b32 v55, 7, v53
    v_lshl_or_b32 v54, v54, 3, v55
    v_bfe_u32 v55, v53, 3, 5
    v_lshl_or_b32 v54, v54, 5, v55
    v_lshlrev_b32 v54, 2, v54
    v_add_u32 v27, 56064, v54
    s_mov_b32 s14, 0x3fb8aa3b
    s_waitcnt vmcnt(11)
    ds_write2_b32 v40, v32, v36 offset1:1
    ds_write2_b32 v41, v33, v37 offset1:1
    ds_write2_b32 v42, v34, v38 offset1:1
    ds_write2_b32 v43, v35, v39 offset1:1
    v_mov_b32 v144, 0
    v_mov_b32 v145, 0
    v_mov_b32 v146, 0
    v_mov_b32 v147, 0
    v_dot2c_f32_bf16 v144, s25, v32
    v_dot2c_f32_bf16 v145, v32, v32
    v_dot2c_f32_bf16 v146, s25, v36
    v_dot2c_f32_bf16 v147, v36, v36
    v_dot2c_f32_bf16 v144, s25, v33
    v_dot2c_f32_bf16 v145, v33, v33
    v_dot2c_f32_bf16 v146, s25, v37
    v_dot2c_f32_bf16 v147, v37, v37
    v_dot2c_f32_bf16 v144, s25, v34
    v_dot2c_f32_bf16 v145, v34, v34
    v_dot2c_f32_bf16 v146, s25, v38
    v_dot2c_f32_bf16 v147, v38, v38
    v_dot2c_f32_bf16 v144, s25, v35
    v_dot2c_f32_bf16 v145, v35, v35
    v_dot2c_f32_bf16 v146, s25, v39
    v_dot2c_f32_bf16 v147, v39, v39
    v_add_f32_dpp v144, v144, v144 quad_perm:[1,0,3,2] row_mask:0xf bank_mask:0xf
    v_add_f32_dpp v145, v145, v145 quad_perm:[1,0,3,2] row_mask:0xf bank_mask:0xf
    v_add_f32_dpp v146, v146, v146 quad_perm:[1,0,3,2] row_mask:0xf bank_mask:0xf
    v_add_f32_dpp v147, v147, v147 quad_perm:[1,0,3,2] row_mask:0xf bank_mask:0xf
    v_add_f32_dpp v144, v144, v144 quad_perm:[2,3,0,1] row_mask:0xf bank_mask:0xf
    v_add_f32_dpp v145, v145, v145 quad_perm:[2,3,0,1] row_mask:0xf bank_mask:0xf
    v_add_f32_dpp v146, v146, v146 quad_perm:[2,3,0,1] row_mask:0xf bank_mask:0xf
    v_add_f32_dpp v147, v147, v147 quad_perm:[2,3,0,1] row_mask:0xf bank_mask:0xf
    v_add_f32_dpp v144, v144, v144 row_half_mirror row_mask:0xf bank_mask:0xf
    v_add_f32_dpp v145, v145, v145 row_half_mirror row_mask:0xf bank_mask:0xf
    v_add_f32_dpp v146, v146, v146 row_half_mirror row_mask:0xf bank_mask:0xf
    v_add_f32_dpp v147, v147, v147 row_half_mirror row_mask:0xf bank_mask:0xf
    v_add_f32_dpp v144, v144, v144 row_mirror row_mask:0xf bank_mask:0xf
    v_add_f32_dpp v145, v145, v145 row_mirror row_mask:0xf bank_mask:0xf
    v_add_f32_dpp v146, v146, v146 row_mirror row_mask:0xf bank_mask:0xf
    v_add_f32_dpp v147, v147, v147 row_mirror row_mask:0xf bank_mask:0xf
    v_add_f32_dpp v144, v144, v144 row_bcast:15 row_mask:0xa bank_mask:0xf
    v_add_f32_dpp v145, v145, v145 row_bcast:15 row_mask:0xa bank_mask:0xf
    v_add_f32_dpp v146, v146, v146 row_bcast:15 row_mask:0xa bank_mask:0xf
    v_add_f32_dpp v147, v147, v147 row_bcast:15 row_mask:0xa bank_mask:0xf
    v_add_f32_dpp v144, v144, v144 row_bcast:31 row_mask:0xc bank_mask:0xf
    v_add_f32_dpp v145, v145, v145 row_bcast:31 row_mask:0xc bank_mask:0xf
    v_add_f32_dpp v146, v146, v146 row_bcast:31 row_mask:0xc bank_mask:0xf
    v_add_f32_dpp v147, v147, v147 row_bcast:31 row_mask:0xc bank_mask:0xf
    v_pk_mul_f32 v[144:145], v[144:145], s[26:27] op_sel_hi:[1,0]
    v_pk_mul_f32 v[146:147], v[146:147], s[26:27] op_sel_hi:[1,0]
    v_fma_f32 v145, -v144, v144, v145
    v_fma_f32 v147, -v146, v146, v147
    v_max_f32 v145, 0, v145
    v_max_f32 v147, 0, v147
    v_cvt_pk_bf16_f32 v145, 0, v145
    v_cvt_pk_bf16_f32 v147, 0, v147
    v_add_f32 v145, s27, v145
    v_add_f32 v147, s27, v147
    v_cvt_pk_bf16_f32 v145, 0, v145
    v_cvt_pk_bf16_f32 v147, 0, v147
    v_sqrt_f32 v145, v145
    v_sqrt_f32 v147, v147
    v_cvt_pk_bf16_f32 v144, 0, v144
    v_cvt_pk_bf16_f32 v146, 0, v146
    v_cvt_pk_bf16_f32 v145, 0, v145
    v_cvt_pk_bf16_f32 v147, 0, v147
    v_rcp_f32 v145, v145
    v_rcp_f32 v147, v147
    s_lshl_b32 s15, s2, 2
    s_add_u32 s15, s15, s10
    s_lshl_b32 s15, s15, 4
    s_add_u32 s15, s15, 16777216
    v_mov_b32 v5, s15
    s_lshl_b64 exec, 1, 63
    global_store_dwordx4 v5, v[144:147], s[8:9] sc1
    s_mov_b64 exec, -1
    s_waitcnt vmcnt(6)
    s_waitcnt lgkmcnt(0)
    s_lshl_b32 s15, s47, 4
    s_lshr_b32 s30, s30, s15
    s_lshl_b32 s30, s30, 16
    s_and_b32 s53, s52, 0xffff0000
    s_lshl_b32 s52, s52, 16
    v_mov_b32 v52, s14
    v_mul_f32 v52, s30, v52
    v_mul_f32 v10, s14, v10
    v_exp_f32 v52, v52
    v_exp_f32 v10, v10
    s_nop 0
    v_cvt_pk_bf16_f32 v53, v52, v10
    v_lshlrev_b32 v52, 16, v53
    v_and_b32 v10, 0xffff0000, v53
    v_lshlrev_b32 v54, 16, v8
    v_and_b32 v55, 0xffff0000, v8
    v_lshlrev_b32 v56, 16, v9
    v_and_b32 v57, 0xffff0000, v9
    v_mul_f32 v10, v52, v10
    v_mul_f32 v11, v52, v11
    v_mul_f32 v10, s31, v10
    v_mul_f32 v11, 0.15915494, v11
    v_max3_f32 v53, abs(v54), abs(v55), abs(v56)
    v_max_f32_e64 v53, abs(v57), v53
    v_mul_f32 v53, v52, v53
    v_mul_f32 v58, 0x3f800000, v10
    v_mul_f32 v59, 0xbf800000, v11
    v_fract_f32 v59, v59
    v_exp_f32 v58, v58
    v_cos_f32 v62, v59
    v_sin_f32 v63, v59
    v_max_f32_dpp v53, v53, v53 quad_perm:[1,0,3,2] row_mask:0xf bank_mask:0xf
    s_nop 1
    v_max_f32_dpp v53, v53, v53 quad_perm:[2,3,0,1] row_mask:0xf bank_mask:0xf
    s_nop 1
    v_max_f32_dpp v53, v53, v53 row_half_mirror row_mask:0xf bank_mask:0xf
    s_nop 1
    v_max_f32_dpp v53, v53, v53 row_mirror row_mask:0xf bank_mask:0xf
    s_nop 1
    v_max_f32_dpp v53, v53, v53 row_bcast:15 row_mask:0xa bank_mask:0xf
    s_nop 1
    v_max_f32_dpp v53, v53, v53 row_bcast:31 row_mask:0xc bank_mask:0xf
    v_mul_f32 v60, 0x43800000, v10
    v_mul_f32 v61, 0xc3800000, v11
    v_fract_f32 v61, v61
    v_exp_f32 v60, v60
    v_cos_f32 v64, v61
    v_sin_f32 v65, v61
    v_mul_f32 v80, 0x41000000, v10
    v_mul_f32 v81, 0x41000000, v11
    v_fract_f32 v81, v81
    v_exp_f32 v80, v80
    v_cos_f32 v70, v81
    v_sin_f32 v71, v81
    s_waitcnt lgkmcnt(0)
    s_barrier
    ds_read_b64 v[32:33], v44
    ds_read_b64 v[34:35], v45
    ds_read_b64 v[36:37], v44 offset:4096
    ds_read_b64 v[38:39], v45 offset:4096
    v_mul_f32 v82, 0x41800000, v10
    v_mul_f32 v83, 0x41800000, v11
    v_fract_f32 v83, v83
    v_exp_f32 v82, v82
    v_cos_f32 v68, v83
    v_sin_f32 v69, v83
    s_waitcnt lgkmcnt(0)
    global_store_dwordx4 v46, v[32:35], s[8:9] sc1
    global_store_dwordx4 v47, v[36:39], s[8:9] sc1
    global_load_dwordx2 v[14:15], v50, s[64:65] sc1
    v_pk_mul_f32 v[62:63], v[62:63], v[58:59] op_sel:[0,0] op_sel_hi:[1,0]
    v_pk_mul_f32 v[64:65], v[64:65], v[60:61] op_sel:[0,0] op_sel_hi:[1,0]
    v_pk_mul_f32 v[70:71], v[70:71], v[80:81] op_sel:[0,0] op_sel_hi:[1,0]
    v_pk_mul_f32 v[68:69], v[68:69], v[82:83] op_sel:[0,0] op_sel_hi:[1,0]
    v_readlane_b32 s62, v53, 63
    v_mul_f32 v12, v52, v12
    v_mul_f32 v13, v52, v13
    v_frexp_exp_i32_f32 v53, s62
    s_movk_i32 s63, 110
    v_min_i32 v53, s63, v53
    v_max_i32 v53, -100, v53
    v_sub_u32 v54, 7, v53
    v_subrev_u32 v55, 6, v53
    v_ldexp_f32 v54, 1.0, v54
    v_ldexp_f32 v55, 1.0, v55
    v_mul_f32 v84, v54, v12
    v_mul_f32_e64 v85, -v54, v13
    v_pk_mul_f32 v[66:67], v[62:63], v[62:63] op_sel:[0,0] op_sel_hi:[1,0]
    v_pk_fma_f32 v[66:67], v[62:63], v[62:63], v[66:67] op_sel:[1,1,0] op_sel_hi:[0,1,1] neg_lo:[0,1,0]
    s_lshl_b32 s14, s47, 2
    s_add_u32 s14, s14, 89344
    v_mov_b32 v2, s14
    ds_write_b32 v2, v55
    v_mov_b32 v60, 0x3c00
    ds_write_b32 v126, v60 offset:11088
    v_cvt_pk_f16_f32 v56, v84, v85
    ds_write_b32 v126, v56 offset:0
    v_cvt_pk_f16_f32 v57, v70, v71
    ds_write_b32 v126, v57 offset:11616
    v_cvt_pk_f16_f32 v58, v68, v69
    ds_write_b32 v126, v58 offset:12144
    v_pk_mul_f32 v[72:73], v[70:71], v[68:69] op_sel:[0,0] op_sel_hi:[1,0]
    v_pk_mul_f32 v[74:75], v[68:69], v[68:69] op_sel:[0,0] op_sel_hi:[1,0]
    v_pk_mul_f32 v[86:87], v[84:85], v[62:63] op_sel:[0,0] op_sel_hi:[1,0]
    v_pk_mul_f32 v[100:101], v[84:85], v[64:65] op_sel:[0,0] op_sel_hi:[1,0]
    v_pk_fma_f32 v[72:73], v[70:71], v[68:69], v[72:73] op_sel:[1,1,0] op_sel_hi:[0,1,1] neg_lo:[0,1,0]
    v_pk_fma_f32 v[74:75], v[68:69], v[68:69], v[74:75] op_sel:[1,1,0] op_sel_hi:[0,1,1] neg_lo:[0,1,0]
    v_pk_fma_f32 v[86:87], v[84:85], v[62:63], v[86:87] op_sel:[1,1,0] op_sel_hi:[0,1,1] neg_lo:[0,1,0]
    v_pk_fma_f32 v[100:101], v[84:85], v[64:65], v[100:101] op_sel:[1,1,0] op_sel_hi:[0,1,1] neg_lo:[0,1,0]
    v_cvt_pk_f16_f32 v59, v72, v73
    ds_write_b32 v126, v59 offset:12672
    v_cvt_pk_f16_f32 v56, v74, v75
    ds_write_b32 v126, v56 offset:13200
    v_cvt_pk_f16_f32 v57, v86, v87
    ds_write_b32 v126, v57 offset:528
    v_cvt_pk_f16_f32 v58, v100, v101
    ds_write_b32 v126, v58 offset:4224
    s_add_u32 m0, s28, 0
    s_add_u32 s24, s22, 0
    buffer_load_dwordx4 v154, s[36:39], s24 offen offset:0 lds
    v_pk_mul_f32 v[76:77], v[72:73], v[68:69] op_sel:[0,0] op_sel_hi:[1,0]
    v_pk_mul_f32 v[78:79], v[74:75], v[68:69] op_sel:[0,0] op_sel_hi:[1,0]
    v_pk_mul_f32 v[88:89], v[84:85], v[66:67] op_sel:[0,0] op_sel_hi:[1,0]
    v_pk_mul_f32 v[108:109], v[100:101], v[64:65] op_sel:[0,0] op_sel_hi:[1,0]
    v_pk_fma_f32 v[76:77], v[72:73], v[68:69], v[76:77] op_sel:[1,1,0] op_sel_hi:[0,1,1] neg_lo:[0,1,0]
    v_pk_fma_f32 v[78:79], v[74:75], v[68:69], v[78:79] op_sel:[1,1,0] op_sel_hi:[0,1,1] neg_lo:[0,1,0]
    v_pk_fma_f32 v[88:89], v[84:85], v[66:67], v[88:89] op_sel:[1,1,0] op_sel_hi:[0,1,1] neg_lo:[0,1,0]
    v_pk_fma_f32 v[108:109], v[100:101], v[64:65], v[108:109] op_sel:[1,1,0] op_sel_hi:[0,1,1] neg_lo:[0,1,0]
    v_cvt_pk_f16_f32 v59, v76, v77
    ds_write_b32 v126, v59 offset:13728
    v_cvt_pk_f16_f32 v56, v78, v79
    ds_write_b32 v126, v56 offset:14256
    v_cvt_pk_f16_f32 v57, v88, v89
    ds_write_b32 v126, v57 offset:1056
    v_cvt_pk_f16_f32 v58, v108, v109
    ds_write_b32 v126, v58 offset:6336
    v_pk_mul_f32 v[72:73], v[76:77], v[68:69] op_sel:[0,0] op_sel_hi:[1,0]
    v_pk_mul_f32 v[74:75], v[78:79], v[68:69] op_sel:[0,0] op_sel_hi:[1,0]
    v_pk_mul_f32 v[90:91], v[86:87], v[66:67] op_sel:[0,0] op_sel_hi:[1,0]
    v_pk_mul_f32 v[112:113], v[108:109], v[64:65] op_sel:[0,0] op_sel_hi:[1,0]
    v_pk_fma_f32 v[72:73], v[76:77], v[68:69], v[72:73] op_sel:[1,1,0] op_sel_hi:[0,1,1] neg_lo:[0,1,0]
    v_pk_fma_f32 v[74:75], v[78:79], v[68:69], v[74:75] op_sel:[1,1,0] op_sel_hi:[0,1,1] neg_lo:[0,1,0]
    v_pk_fma_f32 v[90:91], v[86:87], v[66:67], v[90:91] op_sel:[1,1,0] op_sel_hi:[0,1,1] neg_lo:[0,1,0]
    v_pk_fma_f32 v[112:113], v[108:109], v[64:65], v[112:113] op_sel:[1,1,0] op_sel_hi:[0,1,1] neg_lo:[0,1,0]
    v_cvt_pk_f16_f32 v59, v72, v73
    ds_write_b32 v126, v59 offset:14784
    v_cvt_pk_f16_f32 v56, v74, v75
    ds_write_b32 v126, v56 offset:15312
    v_cvt_pk_f16_f32 v57, v90, v91
    ds_write_b32 v126, v57 offset:1584
    v_cvt_pk_f16_f32 v58, v112, v113
    ds_write_b32 v126, v58 offset:7392
    s_add_u32 s24, s22, 56320
    buffer_load_dwordx4 v154, s[36:39], s24 offen offset:1024 lds
    v_pk_mul_f32 v[76:77], v[72:73], v[68:69] op_sel:[0,0] op_sel_hi:[1,0]
    v_pk_mul_f32 v[78:79], v[74:75], v[68:69] op_sel:[0,0] op_sel_hi:[1,0]
    v_pk_mul_f32 v[92:93], v[88:89], v[66:67] op_sel:[0,0] op_sel_hi:[1,0]
    v_pk_mul_f32 v[116:117], v[112:113], v[64:65] op_sel:[0,0] op_sel_hi:[1,0]
    v_pk_fma_f32 v[76:77], v[72:73], v[68:69], v[76:77] op_sel:[1,1,0] op_sel_hi:[0,1,1] neg_lo:[0,1,0]
    v_pk_fma_f32 v[78:79], v[74:75], v[68:69], v[78:79] op_sel:[1,1,0] op_sel_hi:[0,1,1] neg_lo:[0,1,0]
    v_pk_fma_f32 v[92:93], v[88:89], v[66:67], v[92:93] op_sel:[1,1,0] op_sel_hi:[0,1,1] neg_lo:[0,1,0]
    v_pk_fma_f32 v[116:117], v[112:113], v[64:65], v[116:117] op_sel:[1,1,0] op_sel_hi:[0,1,1] neg_lo:[0,1,0]
    v_cvt_pk_f16_f32 v59, v76, v77
    ds_write_b32 v126, v59 offset:15840
    v_cvt_pk_f16_f32 v56, v78, v79
    ds_write_b32 v126, v56 offset:16368
    v_cvt_pk_f16_f32 v57, v92, v93
    ds_write_b32 v126, v57 offset:2112
    v_cvt_pk_f16_f32 v58, v116, v117
    ds_write_b32 v126, v58 offset:8448
    v_pk_mul_f32 v[72:73], v[76:77], v[68:69] op_sel:[0,0] op_sel_hi:[1,0]
    v_pk_mul_f32 v[74:75], v[78:79], v[68:69] op_sel:[0,0] op_sel_hi:[1,0]
    v_pk_mul_f32 v[94:95], v[90:91], v[66:67] op_sel:[0,0] op_sel_hi:[1,0]
    v_pk_mul_f32 v[118:119], v[116:117], v[64:65] op_sel:[0,0] op_sel_hi:[1,0]
    v_pk_fma_f32 v[72:73], v[76:77], v[68:69], v[72:73] op_sel:[1,1,0] op_sel_hi:[0,1,1] neg_lo:[0,1,0]
    v_pk_fma_f32 v[74:75], v[78:79], v[68:69], v[74:75] op_sel:[1,1,0] op_sel_hi:[0,1,1] neg_lo:[0,1,0]
    v_pk_fma_f32 v[94:95], v[90:91], v[66:67], v[94:95] op_sel:[1,1,0] op_sel_hi:[0,1,1] neg_lo:[0,1,0]
    v_pk_fma_f32 v[118:119], v[116:117], v[64:65], v[118:119] op_sel:[1,1,0] op_sel_hi:[0,1,1] neg_lo:[0,1,0]
    v_cvt_pk_f16_f32 v59, v72, v73
    ds_write_b32 v126, v59 offset:16896
    v_cvt_pk_f16_f32 v56, v74, v75
    ds_write_b32 v126, v56 offset:17424
    v_cvt_pk_f16_f32 v57, v94, v95
    ds_write_b32 v126, v57 offset:2640
    v_cvt_pk_f16_f32 v58, v118, v119
    ds_write_b32 v126, v58 offset:8976
    s_add_u32 s24, s22, 112640
    buffer_load_dwordx4 v154, s[36:39], s24 offen offset:2048 lds
    v_pk_mul_f32 v[76:77], v[72:73], v[68:69] op_sel:[0,0] op_sel_hi:[1,0]
    v_pk_mul_f32 v[78:79], v[74:75], v[68:69] op_sel:[0,0] op_sel_hi:[1,0]
    v_pk_mul_f32 v[96:97], v[92:93], v[66:67] op_sel:[0,0] op_sel_hi:[1,0]
    v_pk_fma_f32 v[76:77], v[72:73], v[68:69], v[76:77] op_sel:[1,1,0] op_sel_hi:[0,1,1] neg_lo:[0,1,0]
    v_pk_fma_f32 v[78:79], v[74:75], v[68:69], v[78:79] op_sel:[1,1,0] op_sel_hi:[0,1,1] neg_lo:[0,1,0]
    v_pk_fma_f32 v[96:97], v[92:93], v[66:67], v[96:97] op_sel:[1,1,0] op_sel_hi:[0,1,1] neg_lo:[0,1,0]
    v_cvt_pk_f16_f32 v59, v76, v77
    ds_write_b32 v126, v59 offset:17952
    v_cvt_pk_f16_f32 v56, v78, v79
    ds_write_b32 v126, v56 offset:18480
    v_cvt_pk_f16_f32 v57, v96, v97
    ds_write_b32 v126, v57 offset:3168
    s_waitcnt vmcnt(3)
prep_tag:
    v_cmp_eq_u32 vcc, 0, v14
    s_nop 1
    s_cbranch_vccnz prep_retag
    s_waitcnt lgkmcnt(0)
    s_barrier
    s_mov_b64 exec, 1
    v_mov_b32 v153, s29
    global_store_dwordx2 v153, v[14:15], s[8:9] sc1
    s_mov_b64 exec, -1
    v_readfirstlane_b32 s66, v14
    v_readfirstlane_b32 s67, v15
    v_pk_mul_f32 v[72:73], v[76:77], v[68:69] op_sel:[0,0] op_sel_hi:[1,0]
    v_pk_mul_f32 v[74:75], v[78:79], v[68:69] op_sel:[0,0] op_sel_hi:[1,0]
    v_pk_mul_f32 v[120:121], v[118:119], v[64:65] op_sel:[0,0] op_sel_hi:[1,0]
    v_pk_fma_f32 v[72:73], v[76:77], v[68:69], v[72:73] op_sel:[1,1,0] op_sel_hi:[0,1,1] neg_lo:[0,1,0]
    v_pk_fma_f32 v[74:75], v[78:79], v[68:69], v[74:75] op_sel:[1,1,0] op_sel_hi:[0,1,1] neg_lo:[0,1,0]
    v_pk_fma_f32 v[120:121], v[118:119], v[64:65], v[120:121] op_sel:[1,1,0] op_sel_hi:[0,1,1] neg_lo:[0,1,0]
    v_cvt_pk_f16_f32 v58, v72, v73
    ds_write_b32 v126, v58 offset:19008
    v_cvt_pk_f16_f32 v59, v74, v75
    ds_write_b32 v126, v59 offset:19536
    v_cvt_pk_f16_f32 v56, v120, v121
    ds_write_b32 v126, v56 offset:9504
    s_add_u32 s24, s22, 168960
    buffer_load_dwordx4 v154, s[36:39], s24 offen offset:3072 lds
    v_pk_mul_f32 v[76:77], v[72:73], v[68:69] op_sel:[0,0] op_sel_hi:[1,0]
    v_pk_mul_f32 v[78:79], v[74:75], v[68:69] op_sel:[0,0] op_sel_hi:[1,0]
    v_pk_mul_f32 v[98:99], v[94:95], v[66:67] op_sel:[0,0] op_sel_hi:[1,0]
    v_pk_fma_f32 v[76:77], v[72:73], v[68:69], v[76:77] op_sel:[1,1,0] op_sel_hi:[0,1,1] neg_lo:[0,1,0]
    v_pk_fma_f32 v[78:79], v[74:75], v[68:69], v[78:79] op_sel:[1,1,0] op_sel_hi:[0,1,1] neg_lo:[0,1,0]
    v_pk_fma_f32 v[98:99], v[94:95], v[66:67], v[98:99] op_sel:[1,1,0] op_sel_hi:[0,1,1] neg_lo:[0,1,0]
    v_cvt_pk_f16_f32 v57, v76, v77
    ds_write_b32 v126, v57 offset:20064
    v_cvt_pk_f16_f32 v58, v78, v79
    ds_write_b32 v126, v58 offset:20592
    v_cvt_pk_f16_f32 v59, v98, v99
    ds_write_b32 v126, v59 offset:3696
    v_pk_mul_f32 v[72:73], v[76:77], v[68:69] op_sel:[0,0] op_sel_hi:[1,0]
    v_pk_mul_f32 v[74:75], v[78:79], v[68:69] op_sel:[0,0] op_sel_hi:[1,0]
    v_pk_mul_f32 v[122:123], v[120:121], v[64:65] op_sel:[0,0] op_sel_hi:[1,0]
    v_pk_fma_f32 v[72:73], v[76:77], v[68:69], v[72:73] op_sel:[1,1,0] op_sel_hi:[0,1,1] neg_lo:[0,1,0]
    v_pk_fma_f32 v[74:75], v[78:79], v[68:69], v[74:75] op_sel:[1,1,0] op_sel_hi:[0,1,1] neg_lo:[0,1,0]
    v_pk_fma_f32 v[122:123], v[120:121], v[64:65], v[122:123] op_sel:[1,1,0] op_sel_hi:[0,1,1] neg_lo:[0,1,0]
    v_cvt_pk_f16_f32 v56, v72, v73
    ds_write_b32 v126, v56 offset:21120
    v_cvt_pk_f16_f32 v57, v74, v75
    ds_write_b32 v126, v57 offset:21648
    v_cvt_pk_f16_f32 v58, v122, v123
    ds_write_b32 v126, v58 offset:10032
    s_add_u32 m0, s28, 4096
    s_add_u32 s24, s22, 229376
    buffer_load_dwordx4 v154, s[36:39], s24 offen offset:0 lds
    v_pk_mul_f32 v[76:77], v[72:73], v[68:69] op_sel:[0,0] op_sel_hi:[1,0]
    v_pk_mul_f32 v[78:79], v[74:75], v[68:69] op_sel:[0,0] op_sel_hi:[1,0]
    v_pk_mul_f32 v[102:103], v[88:89], v[64:65] op_sel:[0,0] op_sel_hi:[1,0]
    v_pk_fma_f32 v[76:77], v[72:73], v[68:69], v[76:77] op_sel:[1,1,0] op_sel_hi:[0,1,1] neg_lo:[0,1,0]
    v_pk_fma_f32 v[78:79], v[74:75], v[68:69], v[78:79] op_sel:[1,1,0] op_sel_hi:[0,1,1] neg_lo:[0,1,0]
    v_pk_fma_f32 v[102:103], v[88:89], v[64:65], v[102:103] op_sel:[1,1,0] op_sel_hi:[0,1,1] neg_lo:[0,1,0]
    v_cvt_pk_f16_f32 v59, v76, v77
    ds_write_b32 v126, v59 offset:22176
    v_cvt_pk_f16_f32 v56, v78, v79
    ds_write_b32 v126, v56 offset:22704
    v_cvt_pk_f16_f32 v57, v102, v103
    ds_write_b32 v126, v57 offset:4752
    s_add_u32 s24, s22, 285696
    buffer_load_dwordx4 v154, s[36:39], s24 offen offset:1024 lds
    v_pk_mul_f32 v[72:73], v[76:77], v[68:69] op_sel:[0,0] op_sel_hi:[1,0]
    v_pk_mul_f32 v[74:75], v[78:79], v[68:69] op_sel:[0,0] op_sel_hi:[1,0]
    v_pk_mul_f32 v[124:125], v[122:123], v[64:65] op_sel:[0,0] op_sel_hi:[1,0]
    v_pk_fma_f32 v[72:73], v[76:77], v[68:69], v[72:73] op_sel:[1,1,0] op_sel_hi:[0,1,1] neg_lo:[0,1,0]
    v_pk_fma_f32 v[74:75], v[78:79], v[68:69], v[74:75] op_sel:[1,1,0] op_sel_hi:[0,1,1] neg_lo:[0,1,0]
    v_pk_fma_f32 v[124:125], v[122:123], v[64:65], v[124:125] op_sel:[1,1,0] op_sel_hi:[0,1,1] neg_lo:[0,1,0]
    v_cvt_pk_f16_f32 v58, v72, v73
    ds_write_b32 v126, v58 offset:23232
    v_cvt_pk_f16_f32 v59, v74, v75
    ds_write_b32 v126, v59 offset:23760
    v_cvt_pk_f16_f32 v56, v124, v125
    ds_write_b32 v126, v56 offset:10560
    s_add_u32 s24, s22, 342016
    buffer_load_dwordx4 v154, s[36:39], s24 offen offset:2048 lds
    v_pk_mul_f32 v[76:77], v[72:73], v[68:69] op_sel:[0,0] op_sel_hi:[1,0]
    v_pk_mul_f32 v[78:79], v[74:75], v[68:69] op_sel:[0,0] op_sel_hi:[1,0]
    v_pk_mul_f32 v[104:105], v[92:93], v[64:65] op_sel:[0,0] op_sel_hi:[1,0]
    v_pk_fma_f32 v[76:77], v[72:73], v[68:69], v[76:77] op_sel:[1,1,0] op_sel_hi:[0,1,1] neg_lo:[0,1,0]
    v_pk_fma_f32 v[78:79], v[74:75], v[68:69], v[78:79] op_sel:[1,1,0] op_sel_hi:[0,1,1] neg_lo:[0,1,0]
    v_pk_fma_f32 v[104:105], v[92:93], v[64:65], v[104:105] op_sel:[1,1,0] op_sel_hi:[0,1,1] neg_lo:[0,1,0]
    v_cvt_pk_f16_f32 v57, v76, v77
    ds_write_b32 v126, v57 offset:24288
    v_cvt_pk_f16_f32 v58, v78, v79
    ds_write_b32 v126, v58 offset:24816
    v_cvt_pk_f16_f32 v59, v104, v105
    ds_write_b32 v126, v59 offset:5280
    s_add_u32 s24, s22, 398336
    buffer_load_dwordx4 v154, s[36:39], s24 offen offset:3072 lds
    v_pk_mul_f32 v[72:73], v[76:77], v[68:69] op_sel:[0,0] op_sel_hi:[1,0]
    v_pk_mul_f32 v[74:75], v[78:79], v[68:69] op_sel:[0,0] op_sel_hi:[1,0]
    v_pk_mul_f32 v[106:107], v[96:97], v[64:65] op_sel:[0,0] op_sel_hi:[1,0]
    v_pk_fma_f32 v[72:73], v[76:77], v[68:69], v[72:73] op_sel:[1,1,0] op_sel_hi:[0,1,1] neg_lo:[0,1,0]
    v_pk_fma_f32 v[74:75], v[78:79], v[68:69], v[74:75] op_sel:[1,1,0] op_sel_hi:[0,1,1] neg_lo:[0,1,0]
    v_pk_fma_f32 v[106:107], v[96:97], v[64:65], v[106:107] op_sel:[1,1,0] op_sel_hi:[0,1,1] neg_lo:[0,1,0]
    v_cvt_pk_f16_f32 v56, v72, v73
    ds_write_b32 v126, v56 offset:25344
    v_cvt_pk_f16_f32 v57, v74, v75
    ds_write_b32 v126, v57 offset:25872
    v_cvt_pk_f16_f32 v58, v106, v107
    ds_write_b32 v126, v58 offset:5808
    s_add_u32 m0, s28, 8192
    s_add_u32 s24, s22, 458752
    buffer_load_dwordx4 v154, s[36:39], s24 offen offset:0 lds
    v_pk_mul_f32 v[76:77], v[72:73], v[68:69] op_sel:[0,0] op_sel_hi:[1,0]
    v_pk_mul_f32 v[78:79], v[74:75], v[68:69] op_sel:[0,0] op_sel_hi:[1,0]
    v_pk_mul_f32 v[110:111], v[104:105], v[64:65] op_sel:[0,0] op_sel_hi:[1,0]
    v_pk_fma_f32 v[76:77], v[72:73], v[68:69], v[76:77] op_sel:[1,1,0] op_sel_hi:[0,1,1] neg_lo:[0,1,0]
    v_pk_fma_f32 v[78:79], v[74:75], v[68:69], v[78:79] op_sel:[1,1,0] op_sel_hi:[0,1,1] neg_lo:[0,1,0]
    v_pk_fma_f32 v[110:111], v[104:105], v[64:65], v[110:111] op_sel:[1,1,0] op_sel_hi:[0,1,1] neg_lo:[0,1,0]
    v_cvt_pk_f16_f32 v59, v76, v77
    ds_write_b32 v126, v59 offset:26400
    v_cvt_pk_f16_f32 v56, v78, v79
    ds_write_b32 v126, v56 offset:26928
    v_cvt_pk_f16_f32 v57, v110, v111
    ds_write_b32 v126, v57 offset:6864
    s_add_u32 s24, s22, 515072
    buffer_load_dwordx4 v154, s[36:39], s24 offen offset:1024 lds
    v_pk_mul_f32 v[72:73], v[76:77], v[68:69] op_sel:[0,0] op_sel_hi:[1,0]
    v_pk_mul_f32 v[114:115], v[110:111], v[64:65] op_sel:[0,0] op_sel_hi:[1,0]
    v_pk_fma_f32 v[72:73], v[76:77], v[68:69], v[72:73] op_sel:[1,1,0] op_sel_hi:[0,1,1] neg_lo:[0,1,0]
    v_pk_fma_f32 v[114:115], v[110:111], v[64:65], v[114:115] op_sel:[1,1,0] op_sel_hi:[0,1,1] neg_lo:[0,1,0]
    v_cvt_pk_f16_f32 v58, v72, v73
    ds_write_b32 v126, v58 offset:27456
    v_cvt_pk_f16_f32 v59, v114, v115
    ds_write_b32 v126, v59 offset:7920
    s_add_u32 s24, s22, 571392
    buffer_load_dwordx4 v154, s[36:39], s24 offen offset:2048 lds
    s_waitcnt lgkmcnt(0)
    ds_read_b128 v[52:55], v127 offset:0
    ds_read_b128 v[56:59], v127 offset:11088
    ds_read_b128 v[60:63], v127 offset:32
    ds_read_b128 v[64:67], v127 offset:11120
    ds_read_b128 v[68:71], v127 offset:64
    ds_read_b128 v[72:75], v127 offset:11152
    ds_read_b128 v[76:79], v127 offset:96
    ds_read_b128 v[80:83], v127 offset:11184
    ds_read_b128 v[84:87], v127 offset:128
    ds_read_b128 v[88:91], v127 offset:11216
    ds_read_b128 v[92:95], v127 offset:160
    ds_read_b128 v[96:99], v127 offset:11248
    ds_read_b128 v[100:103], v127 offset:192
    ds_read_b128 v[104:107], v127 offset:11280
    ds_read_b128 v[108:111], v127 offset:224
    ds_read_b128 v[112:115], v127 offset:11312
    s_waitcnt lgkmcnt(14)
    v_mfma_f32_32x32x16_f16 v[128:143], v[52:55], v[56:59], 0
    s_add_u32 s24, s22, 627712
    buffer_load_dwordx4 v154, s[36:39], s24 offen offset:3072 lds
    s_waitcnt lgkmcnt(12)
    v_mfma_f32_32x32x16_f16 v[128:143], v[60:63], v[64:67], v[128:143]
    s_waitcnt lgkmcnt(10)
    v_mfma_f32_32x32x16_f16 v[128:143], v[68:71], v[72:75], v[128:143]
    s_waitcnt lgkmcnt(8)
    v_mfma_f32_32x32x16_f16 v[128:143], v[76:79], v[80:83], v[128:143]
    s_add_u32 m0, s28, 12288
    s_add_u32 s24, s22, 688128
    buffer_load_dwordx4 v154, s[36:39], s24 offen offset:0 lds
    s_waitcnt lgkmcnt(6)
    v_mfma_f32_32x32x16_f16 v[128:143], v[84:87], v[88:91], v[128:143]
    s_waitcnt lgkmcnt(4)
    v_mfma_f32_32x32x16_f16 v[128:143], v[92:95], v[96:99], v[128:143]
    s_waitcnt lgkmcnt(2)
    v_mfma_f32_32x32x16_f16 v[128:143], v[100:103], v[104:107], v[128:143]
    s_add_u32 s24, s22, 744448
    buffer_load_dwordx4 v154, s[36:39], s24 offen offset:1024 lds
    s_waitcnt lgkmcnt(0)
    v_mfma_f32_32x32x16_f16 v[128:143], v[108:111], v[112:115], v[128:143]
    s_nop 11
    ds_write_b32 v48, v128 offset:0
    ds_write_b32 v48, v129 offset:128
    ds_write_b32 v48, v130 offset:256
    ds_write_b32 v48, v131 offset:384
    ds_write_b32 v28, v132 offset:1024
    ds_write_b32 v29, v133 offset:1024
    ds_write_b32 v30, v134 offset:1024
    ds_write_b32 v31, v135 offset:1024
    ds_write_b32 v49, v136 offset:4096
    s_mov_b32 exec_hi, 0
    ds_write_b32 v49, v137 offset:5120
    ds_write_b32 v49, v138 offset:6144
    ds_write_b32 v49, v139 offset:7168
    s_mov_b64 exec, -1
    v_lshlrev_b32 v11, 5, v0
    v_add_u32 v11, 16842752, v11
    s_waitcnt lgkmcnt(0)
    s_barrier
    global_load_dwordx2 v[40:41], v11, s[8:9] sc1
    ds_read_b32 v128, v16 offset:0
    ds_read_b32 v129, v17 offset:0
    ds_read_b32 v130, v18 offset:0
    ds_read_b32 v131, v19 offset:0
    ds_read_b32 v132, v20 offset:0
    ds_read_b32 v133, v21 offset:0
    ds_read_b32 v134, v22 offset:0
    ds_read_b32 v135, v23 offset:0
    ds_read_b32 v136, v24 offset:0
    ds_read_b32 v137, v25 offset:0
    ds_read_b32 v138, v26 offset:0
    ds_read_b32 v139, v27 offset:0
    ds_read_b32 v140, v16 offset:8320
    ds_read_b32 v141, v17 offset:8320
    ds_read_b32 v142, v18 offset:8320
    ds_read_b32 v143, v19 offset:8320
    ds_read_b32 v144, v20 offset:8320
    ds_read_b32 v145, v21 offset:8320
    ds_read_b32 v146, v22 offset:8320
    ds_read_b32 v147, v23 offset:8320
    ds_read_b32 v148, v24 offset:8320
    ds_read_b32 v149, v25 offset:8320
    ds_read_b32 v150, v26 offset:8320
    ds_read_b32 v151, v27 offset:8320
    ds_read_b32 v96, v16 offset:16640
    ds_read_b32 v97, v17 offset:16640
    ds_read_b32 v98, v18 offset:16640
    ds_read_b32 v99, v19 offset:16640
    ds_read_b32 v100, v20 offset:16640
    ds_read_b32 v101, v21 offset:16640
    ds_read_b32 v102, v22 offset:16640
    ds_read_b32 v103, v23 offset:16640
    ds_read_b32 v104, v24 offset:16640
    ds_read_b32 v105, v25 offset:16640
    ds_read_b32 v106, v26 offset:16640
    ds_read_b32 v107, v27 offset:16640
    ds_read_b32 v108, v16 offset:24960
    ds_read_b32 v109, v17 offset:24960
    ds_read_b32 v110, v18 offset:24960
    ds_read_b32 v111, v19 offset:24960
    ds_read_b32 v112, v20 offset:24960
    ds_read_b32 v113, v21 offset:24960
    ds_read_b32 v114, v22 offset:24960
    ds_read_b32 v115, v23 offset:24960
    ds_read_b32 v116, v24 offset:24960
    ds_read_b32 v117, v25 offset:24960
    ds_read_b32 v118, v26 offset:24960
    ds_read_b32 v119, v27 offset:24960
    v_mov_b32 v2, 89344
    ds_read_b64 v[2:3], v2
    s_add_u32 s24, s22, 800768
    buffer_load_dwordx4 v154, s[36:39], s24 offen offset:2048 lds
    s_add_u32 s24, s22, 857088
    buffer_load_dwordx4 v154, s[36:39], s24 offen offset:3072 lds
    v_mov_b32 v76, 0
    v_mov_b32 v77, 0
    v_mov_b32 v78, 0
    v_mov_b32 v79, 0
    v_min_u32 v90, 159, v0
    v_lshlrev_b32 v90, 4, v90
    ds_write_b128 v90, v[76:79] offset:33280
    ds_write_b128 v90, v[76:79] offset:40960
    v_bfe_u32 v90, v0, 2, 3
    v_mul_u32_u24 v90, 4160, v90
    v_and_b32 v91, 3, v0
    v_lshl_add_u32 v90, v91, 4, v90
    ds_write_b128 v90, v[76:79] offset:4096
    v_lshlrev_b32 v92, 4, v0
    s_movk_i32 s24, 255
    v_cmp_eq_u32 s[62:63], s24, v0
    s_lshl_b32 s14, s50, 5
    s_add_u32 s14, s14, 0
    v_lshrrev_b32 v5, 1, v0
    v_lshlrev_b32 v4, 13, v5
    v_and_b32 v5, 1, v0
    v_lshl_add_u32 v4, v5, 4, v4
    v_add_u32 v4, s14, v4
    v_lshlrev_b32 v5, 5, v0
    v_add_u32 v5, 16777216, v5
    v_add_u32 v6, 0x100000, v4
    v_add_u32 v7, 0x2000, v5
    s_waitcnt lgkmcnt(3)
    v_readfirstlane_b32 s54, v2
    v_readfirstlane_b32 s55, v3
    v_pk_add_f32 v[128:129], v[128:129], v[140:141]
    v_pk_add_f32 v[130:131], v[130:131], v[142:143]
    v_pk_add_f32 v[132:133], v[132:133], v[144:145]
    v_pk_add_f32 v[134:135], v[134:135], v[146:147]
    v_pk_add_f32 v[136:137], v[136:137], v[148:149]
    v_pk_add_f32 v[138:139], v[138:139], v[150:151]
    v_cvt_pk_f16_f32 v64, v128, v129
    v_cvt_pk_f16_f32 v65, v130, v131
    v_cvt_pk_f16_f32 v66, v132, v133
    v_cvt_pk_f16_f32 v67, v134, v135
    v_cvt_pk_f16_f32 v68, v136, v137
    v_cvt_pk_f16_f32 v69, v138, v139
    v_pk_add_f32 v[96:97], v[96:97], v[108:109]
    v_pk_add_f32 v[98:99], v[98:99], v[110:111]
    v_pk_add_f32 v[100:101], v[100:101], v[112:113]
    v_pk_add_f32 v[102:103], v[102:103], v[114:115]
    v_pk_add_f32 v[104:105], v[104:105], v[116:117]
    v_pk_add_f32 v[106:107], v[106:107], v[118:119]
    v_cvt_pk_f16_f32 v70, v96, v97
    v_cvt_pk_f16_f32 v71, v98, v99
    v_cvt_pk_f16_f32 v72, v100, v101
    v_cvt_pk_f16_f32 v73, v102, v103
    v_cvt_pk_f16_f32 v74, v104, v105
    v_cvt_pk_f16_f32 v75, v106, v107
    s_waitcnt vmcnt(2)
    v_cmp_ne_u64 vcc, s[66:67], v[40:41]
    s_nop 1
    s_cbranch_vccnz pollA
pollA_ok:
    s_barrier
    global_load_dwordx4 v[32:35], v5, s[8:9] sc1
    global_load_dwordx4 v[36:39], v5, s[8:9] offset:16 sc1
    global_load_dwordx4 v[16:19], v4, s[8:9] sc1
    v_cndmask_b32 v68, v68, 0, s[62:63]
    v_cndmask_b32 v69, v69, 0, s[62:63]
    ds_write_b128 v92, v[64:67] offset:0
    v_alignbit_b32 v76, v65, v64, 16
    v_alignbit_b32 v77, v66, v65, 16
    v_alignbit_b32 v78, v67, v66, 16
    v_alignbit_b32 v79, v68, v67, 16
    ds_write_b128 v92, v[76:79] offset:4160
    v_alignbit_b32 v80, v66, v65, 16
    v_alignbit_b32 v81, v67, v66, 16
    v_alignbit_b32 v82, v68, v67, 16
    v_alignbit_b32 v83, v69, v68, 16
    ds_write_b128 v92, v[80:83] offset:12480
    v_mov_b32 v84, v65
    v_mov_b32 v85, v66
    v_mov_b32 v86, v67
    v_mov_b32 v87, v68
    ds_write_b128 v92, v[84:87] offset:8320
    v_cndmask_b32 v74, v74, 0, s[62:63]
    v_cndmask_b32 v75, v75, 0, s[62:63]
    ds_write_b128 v92, v[70:73] offset:16640
    v_alignbit_b32 v76, v71, v70, 16
    v_alignbit_b32 v77, v72, v71, 16
    v_alignbit_b32 v78, v73, v72, 16
    v_alignbit_b32 v79, v74, v73, 16
    ds_write_b128 v92, v[76:79] offset:20800
    v_alignbit_b32 v80, v72, v71, 16
    v_alignbit_b32 v81, v73, v72, 16
    v_alignbit_b32 v82, v74, v73, 16
    v_alignbit_b32 v83, v75, v74, 16
    ds_write_b128 v92, v[80:83] offset:29120
    v_mov_b32 v84, v71
    v_mov_b32 v85, v72
    v_mov_b32 v86, v73
    v_mov_b32 v87, v74
    ds_write_b128 v92, v[84:87] offset:24960
    s_mul_i32 s14, s50, 12288
    s_add_u32 s14, s14, 13631488
    v_lshrrev_b32 v88, 6, v0
    v_mul_u32_u24 v88, 3072, v88
    v_lshl_add_u32 v88, v1, 4, v88
    v_add_u32 v88, s14, v88
    v_lshrrev_b32 v12, 3, v0
    v_and_b32 v3, 7, v0
    v_mul_u32_u24 v13, 80, v12
    v_lshl_add_u32 v13, v3, 3, v13
    v_add_u32 v13, 35840, v13
    v_mul_u32_u24 v14, 144, v12
    v_lshl_add_u32 v14, v3, 4, v14
    v_add_u32 v14, 48640, v14
    s_lshl_b32 s14, s50, 8
    s_add_u32 s14, s14, 2097152
    v_lshrrev_b32 v15, 4, v0
    v_lshlrev_b32 v15, 16, v15
    v_and_b32 v3, 15, v0
    v_lshl_add_u32 v15, v3, 3, v15
    v_add_u32 v15, s14, v15
    v_and_b32 v12, 31, v1
    v_lshrrev_b32 v3, 5, v1
    s_and_b32 s24, s10, 1
    s_lshr_b32 s15, s10, 1
    v_and_b32 v8, 3, v12
    v_sub_u32 v8, 3, v8
    v_mul_u32_u24 v8, 4160, v8
    v_and_b32 v9, 28, v12
    v_lshlrev_b32 v9, 1, v9
    v_sub_u32 v8, v8, v9
    v_lshl_add_u32 v8, v3, 4, v8
    s_mul_i32 s14, s15, 16640
    s_lshl_b32 s24, s24, 5
    s_add_u32 s14, s14, s24
    s_add_u32 s14, s14, 56
    v_add_u32 v8, s14, v8
    v_mul_u32_u24 v9, 80, v12
    v_lshl_add_u32 v9, v3, 4, v9
    s_mul_i32 s14, s15, 7680
    s_add_u32 s14, s14, s24
    s_add_u32 s14, s14, 33360
    v_add_u32 v9, s14, v9
    v_mul_u32_u24 v10, 144, v12
    v_lshl_add_u32 v10, v3, 4, v10
    s_mul_i32 s14, s10, 9216
    s_add_u32 s14, s14, 48640
    v_add_u32 v10, s14, v10
    v_add_u32 v12, 0x100000, v15
    ds_read_b64_tr_b16 v[160:161], v156 offset:0
    ds_read_b64_tr_b16 v[162:163], v156 offset:256
    ds_read_b64_tr_b16 v[164:165], v156 offset:1024
    ds_read_b64_tr_b16 v[166:167], v156 offset:1280
    ds_read_b64_tr_b16 v[168:169], v156 offset:2048
    ds_read_b64_tr_b16 v[170:171], v156 offset:2304
    ds_read_b64_tr_b16 v[172:173], v156 offset:3072
    ds_read_b64_tr_b16 v[174:175], v156 offset:3328
    ds_read_b64_tr_b16 v[176:177], v156 offset:4096
    ds_read_b64_tr_b16 v[178:179], v156 offset:4352
    ds_read_b64_tr_b16 v[180:181], v156 offset:5120
    ds_read_b64_tr_b16 v[182:183], v156 offset:5376
    ds_read_b64_tr_b16 v[184:185], v156 offset:6144
    ds_read_b64_tr_b16 v[186:187], v156 offset:6400
    ds_read_b64_tr_b16 v[188:189], v156 offset:7168
    ds_read_b64_tr_b16 v[190:191], v156 offset:7424
    ds_read_b64_tr_b16 v[192:193], v156 offset:8192
    ds_read_b64_tr_b16 v[194:195], v156 offset:8448
    ds_read_b64_tr_b16 v[196:197], v156 offset:9216
    ds_read_b64_tr_b16 v[198:199], v156 offset:9472
    ds_read_b64_tr_b16 v[200:201], v156 offset:10240
    ds_read_b64_tr_b16 v[202:203], v156 offset:10496
    ds_read_b64_tr_b16 v[204:205], v156 offset:11264
    ds_read_b64_tr_b16 v[206:207], v156 offset:11520
    ds_read_b64_tr_b16 v[208:209], v156 offset:12288
    ds_read_b64_tr_b16 v[210:211], v156 offset:12544
    ds_read_b64_tr_b16 v[212:213], v156 offset:13312
    ds_read_b64_tr_b16 v[214:215], v156 offset:13568
    s_waitcnt vmcnt(4)
    ds_read_b64_tr_b16 v[216:217], v156 offset:14336
    ds_read_b64_tr_b16 v[218:219], v156 offset:14592
    s_waitcnt vmcnt(3)
    ds_read_b64_tr_b16 v[220:221], v156 offset:15360
    ds_read_b64_tr_b16 v[222:223], v156 offset:15616
    s_waitcnt lgkmcnt(0)
    s_waitcnt vmcnt(1)
    s_waitcnt vmcnt(0)
    global_store_dwordx4 v88, v[64:67], s[8:9] offset:0 sc1
    global_store_dwordx4 v88, v[68:71], s[8:9] offset:1024 sc1
    global_store_dwordx4 v88, v[72:75], s[8:9] offset:2048 sc1
    s_add_u32 m0, s28, 0
    s_add_u32 s24, s22, 917504
    buffer_load_dwordx4 v154, s[36:39], s24 offen offset:0 lds
    s_add_u32 s24, s22, 973824
    buffer_load_dwordx4 v154, s[36:39], s24 offen offset:1024 lds
    v_lshlrev_b32 v96, 16, v16
    v_and_b32 v97, 0xffff0000, v16
    v_lshlrev_b32 v98, 16, v17
    v_and_b32 v99, 0xffff0000, v17
    v_lshlrev_b32 v100, 16, v18
    v_and_b32 v101, 0xffff0000, v18
    v_lshlrev_b32 v102, 16, v19
    v_and_b32 v103, 0xffff0000, v19
    v_pk_add_f32 v[112:113], v[96:97], v[32:33] op_sel:[0,0] op_sel_hi:[1,0] neg_lo:[0,1] neg_hi:[0,1]
    v_pk_add_f32 v[114:115], v[98:99], v[34:35] op_sel:[0,0] op_sel_hi:[1,0] neg_lo:[0,1] neg_hi:[0,1]
    v_pk_add_f32 v[116:117], v[100:101], v[36:37] op_sel:[0,0] op_sel_hi:[1,0] neg_lo:[0,1] neg_hi:[0,1]
    v_pk_add_f32 v[118:119], v[102:103], v[38:39] op_sel:[0,0] op_sel_hi:[1,0] neg_lo:[0,1] neg_hi:[0,1]
    v_cvt_pk_bf16_f32 v112, 0, v112
    v_cvt_pk_bf16_f32 v113, 0, v113
    v_cvt_pk_bf16_f32 v114, 0, v114
    v_cvt_pk_bf16_f32 v115, 0, v115
    v_cvt_pk_bf16_f32 v116, 0, v116
    v_cvt_pk_bf16_f32 v117, 0, v117
    v_cvt_pk_bf16_f32 v118, 0, v118
    v_cvt_pk_bf16_f32 v119, 0, v119
    v_pk_mul_f32 v[112:113], v[112:113], v[32:33] op_sel:[0,1] op_sel_hi:[1,1]
    v_pk_mul_f32 v[114:115], v[114:115], v[34:35] op_sel:[0,1] op_sel_hi:[1,1]
    v_pk_mul_f32 v[116:117], v[116:117], v[36:37] op_sel:[0,1] op_sel_hi:[1,1]
    v_pk_mul_f32 v[118:119], v[118:119], v[38:39] op_sel:[0,1] op_sel_hi:[1,1]
    s_add_u32 s24, s22, 1030144
    buffer_load_dwordx4 v154, s[36:39], s24 offen offset:2048 lds
    s_add_u32 s24, s22, 1086464
    buffer_load_dwordx4 v154, s[36:39], s24 offen offset:3072 lds
    s_add_u32 m0, s28, 4096
    s_add_u32 s24, s22, 1146880
    buffer_load_dwordx4 v154, s[36:39], s24 offen offset:0 lds
    v_cvt_pk_bf16_f32 v112, 0, v112
    v_cvt_pk_bf16_f32 v113, 0, v113
    v_cvt_pk_bf16_f32 v114, 0, v114
    v_cvt_pk_bf16_f32 v115, 0, v115
    v_cvt_pk_bf16_f32 v116, 0, v116
    v_cvt_pk_bf16_f32 v117, 0, v117
    v_cvt_pk_bf16_f32 v118, 0, v118
    v_cvt_pk_bf16_f32 v119, 0, v119
    v_cvt_pk_f16_f32 v20, v112, v114
    v_cvt_pk_f16_f32 v21, v116, v118
    v_cvt_pk_f16_f32 v22, v113, v115
    v_cvt_pk_f16_f32 v23, v117, v119
    ds_write_b64 v13, v[20:21] offset:0
    ds_write_b64 v13, v[22:23] offset:7680
    s_waitcnt lgkmcnt(0)
    s_barrier
    ds_read_b64 v[128:129], v8 offset:4032
    ds_read_b64 v[130:131], v8 offset:4040
    ds_read_b128 v[132:135], v9 offset:2480
    ds_read_b64 v[136:137], v8 offset:3968
    ds_read_b64 v[138:139], v8 offset:3976
    ds_read_b128 v[140:143], v9 offset:2400
    ds_read_b64 v[144:145], v8 offset:3904
    ds_read_b64 v[146:147], v8 offset:3912
    ds_read_b128 v[148:151], v9 offset:2320
    ds_read_b64 v[48:49], v8 offset:3840
    ds_read_b64 v[50:51], v8 offset:3848
    ds_read_b128 v[52:55], v9 offset:2240
    s_waitcnt lgkmcnt(9)
    v_mfma_f32_32x32x16_f16 v[64:79], v[128:131], v[132:135], 0
    ds_read_b64 v[56:57], v8 offset:3776
    ds_read_b64 v[58:59], v8 offset:3784
    ds_read_b128 v[60:63], v9 offset:2160
    s_add_u32 s24, s22, 1203200
    buffer_load_dwordx4 v154, s[36:39], s24 offen offset:1024 lds
    v_mul_f32 v112, s52, v112
    v_mul_f32 v113, s53, v113
    s_waitcnt lgkmcnt(9)
    v_mfma_f32_32x32x16_f16 v[64:79], v[136:139], v[140:143], v[64:79]
    ds_read_b64 v[128:129], v8 offset:3712
    ds_read_b64 v[130:131], v8 offset:3720
    ds_read_b128 v[132:135], v9 offset:2080
    v_mul_f32 v114, s52, v114
    v_mul_f32 v115, s53, v115
    s_waitcnt lgkmcnt(9)
    v_mfma_f32_32x32x16_f16 v[64:79], v[144:147], v[148:151], v[64:79]
    ds_read_b64 v[136:137], v8 offset:3648
    ds_read_b64 v[138:139], v8 offset:3656
    ds_read_b128 v[140:143], v9 offset:2000
    s_add_u32 s24, s22, 1259520
    buffer_load_dwordx4 v154, s[36:39], s24 offen offset:2048 lds
    v_mul_f32 v116, s52, v116
    v_mul_f32 v117, s53, v117
    s_waitcnt lgkmcnt(9)
    v_mfma_f32_32x32x16_f16 v[64:79], v[48:51], v[52:55], v[64:79]
    ds_read_b64 v[144:145], v8 offset:3584
    ds_read_b64 v[146:147], v8 offset:3592
    ds_read_b128 v[148:151], v9 offset:1920
    v_mul_f32 v118, s52, v118
    v_mul_f32 v119, s53, v119
    s_waitcnt lgkmcnt(9)
    v_mfma_f32_32x32x16_f16 v[64:79], v[56:59], v[60:63], v[64:79]
    ds_read_b64 v[48:49], v8 offset:3520
    ds_read_b64 v[50:51], v8 offset:3528
    ds_read_b128 v[52:55], v9 offset:1840
    v_cvt_pk_bf16_f32 v112, 0, v112
    v_cvt_pk_bf16_f32 v113, 0, v113
    s_waitcnt lgkmcnt(9)
    v_mfma_f32_32x32x16_f16 v[64:79], v[128:131], v[132:135], v[64:79]
    ds_read_b64 v[56:57], v8 offset:3456
    ds_read_b64 v[58:59], v8 offset:3464
    ds_read_b128 v[60:63], v9 offset:1760
    s_add_u32 s24, s22, 1315840
    buffer_load_dwordx4 v154, s[36:39], s24 offen offset:3072 lds
    v_cvt_pk_bf16_f32 v114, 0, v114
    v_cvt_pk_bf16_f32 v115, 0, v115
    s_waitcnt lgkmcnt(9)
    v_mfma_f32_32x32x16_f16 v[64:79], v[136:139], v[140:143], v[64:79]
    ds_read_b64 v[128:129], v8 offset:3392
    ds_read_b64 v[130:131], v8 offset:3400
    ds_read_b128 v[132:135], v9 offset:1680
    v_cvt_pk_bf16_f32 v116, 0, v116
    v_cvt_pk_bf16_f32 v117, 0, v117
    s_waitcnt lgkmcnt(9)
    v_mfma_f32_32x32x16_f16 v[64:79], v[144:147], v[148:151], v[64:79]
    ds_read_b64 v[136:137], v8 offset:3328
    ds_read_b64 v[138:139], v8 offset:3336
    ds_read_b128 v[140:143], v9 offset:1600
    s_add_u32 m0, s28, 8192
    s_add_u32 s24, s22, 1376256
    buffer_load_dwordx4 v154, s[36:39], s24 offen offset:0 lds
    v_cvt_pk_bf16_f32 v118, 0, v118
    v_cvt_pk_bf16_f32 v119, 0, v119
    s_waitcnt lgkmcnt(9)
    v_mfma_f32_32x32x16_f16 v[64:79], v[48:51], v[52:55], v[64:79]
    ds_read_b64 v[144:145], v8 offset:3264
    ds_read_b64 v[146:147], v8 offset:3272
    ds_read_b128 v[148:151], v9 offset:1520
    s_waitcnt lgkmcnt(9)
    v_mfma_f32_32x32x16_f16 v[64:79], v[56:59], v[60:63], v[64:79]
    ds_read_b64 v[48:49], v8 offset:3200
    ds_read_b64 v[50:51], v8 offset:3208
    ds_read_b128 v[52:55], v9 offset:1440
    s_waitcnt lgkmcnt(9)
    v_mfma_f32_32x32x16_f16 v[64:79], v[128:131], v[132:135], v[64:79]
    ds_read_b64 v[56:57], v8 offset:3136
    ds_read_b64 v[58:59], v8 offset:3144
    ds_read_b128 v[60:63], v9 offset:1360
    s_add_u32 s24, s22, 1432576
    buffer_load_dwordx4 v154, s[36:39], s24 offen offset:1024 lds
    s_waitcnt lgkmcnt(9)
    v_mfma_f32_32x32x16_f16 v[64:79], v[136:139], v[140:143], v[64:79]
    ds_read_b64 v[128:129], v8 offset:3072
    ds_read_b64 v[130:131], v8 offset:3080
    ds_read_b128 v[132:135], v9 offset:1280
    s_waitcnt lgkmcnt(9)
    v_mfma_f32_32x32x16_f16 v[64:79], v[144:147], v[148:151], v[64:79]
    ds_read_b64 v[136:137], v8 offset:3008
    ds_read_b64 v[138:139], v8 offset:3016
    ds_read_b128 v[140:143], v9 offset:1200
    s_add_u32 s24, s22, 1488896
    buffer_load_dwordx4 v154, s[36:39], s24 offen offset:2048 lds
    s_waitcnt lgkmcnt(9)
    v_mfma_f32_32x32x16_f16 v[64:79], v[48:51], v[52:55], v[64:79]
    ds_read_b64 v[144:145], v8 offset:2944
    ds_read_b64 v[146:147], v8 offset:2952
    ds_read_b128 v[148:151], v9 offset:1120
    s_waitcnt lgkmcnt(9)
    v_mfma_f32_32x32x16_f16 v[64:79], v[56:59], v[60:63], v[64:79]
    ds_read_b64 v[48:49], v8 offset:2880
    ds_read_b64 v[50:51], v8 offset:2888
    ds_read_b128 v[52:55], v9 offset:1040
    s_waitcnt lgkmcnt(9)
    v_mfma_f32_32x32x16_f16 v[64:79], v[128:131], v[132:135], v[64:79]
    ds_read_b64 v[56:57], v8 offset:2816
    ds_read_b64 v[58:59], v8 offset:2824
    ds_read_b128 v[60:63], v9 offset:960
    s_add_u32 s24, s22, 1545216
    buffer_load_dwordx4 v154, s[36:39], s24 offen offset:3072 lds
    s_waitcnt lgkmcnt(9)
    v_mfma_f32_32x32x16_f16 v[64:79], v[136:139], v[140:143], v[64:79]
    ds_read_b64 v[128:129], v8 offset:2752
    ds_read_b64 v[130:131], v8 offset:2760
    ds_read_b128 v[132:135], v9 offset:880
    s_waitcnt lgkmcnt(9)
    v_mfma_f32_32x32x16_f16 v[64:79], v[144:147], v[148:151], v[64:79]
    ds_read_b64 v[136:137], v8 offset:2688
    ds_read_b64 v[138:139], v8 offset:2696
    ds_read_b128 v[140:143], v9 offset:800
    s_add_u32 m0, s28, 12288
    s_add_u32 s24, s22, 1605632
    buffer_load_dwordx4 v154, s[36:39], s24 offen offset:0 lds
    s_waitcnt vmcnt(11)
    ds_read_b64_tr_b16 v[224:225], v156 offset:0
    ds_read_b64_tr_b16 v[226:227], v156 offset:256
    s_waitcnt lgkmcnt(9)
    v_mfma_f32_32x32x16_f16 v[64:79], v[48:51], v[52:55], v[64:79]
    ds_read_b64 v[144:145], v8 offset:2624
    ds_read_b64 v[146:147], v8 offset:2632
    ds_read_b128 v[148:151], v9 offset:720
    s_waitcnt lgkmcnt(9)
    v_mfma_f32_32x32x16_f16 v[64:79], v[56:59], v[60:63], v[64:79]
    ds_read_b64 v[48:49], v8 offset:2560
    ds_read_b64 v[50:51], v8 offset:2568
    ds_read_b128 v[52:55], v9 offset:640
    s_waitcnt lgkmcnt(9)
    v_mfma_f32_32x32x16_f16 v[64:79], v[128:131], v[132:135], v[64:79]
    ds_read_b64 v[56:57], v8 offset:2496
    ds_read_b64 v[58:59], v8 offset:2504
    ds_read_b128 v[60:63], v9 offset:560
    s_add_u32 s24, s22, 1661952
    buffer_load_dwordx4 v154, s[36:39], s24 offen offset:1024 lds
    ds_read_b64_tr_b16 v[228:229], v156 offset:1024
    ds_read_b64_tr_b16 v[230:231], v156 offset:1280
    s_waitcnt lgkmcnt(9)
    v_mfma_f32_32x32x16_f16 v[64:79], v[136:139], v[140:143], v[64:79]
    ds_read_b64 v[128:129], v8 offset:2432
    ds_read_b64 v[130:131], v8 offset:2440
    ds_read_b128 v[132:135], v9 offset:480
    global_load_dwordx4 v[40:43], v7, s[8:9] sc1
    global_load_dwordx4 v[44:47], v7, s[8:9] offset:16 sc1
    global_load_dwordx4 v[24:27], v6, s[8:9] sc1
    s_waitcnt lgkmcnt(9)
    v_mfma_f32_32x32x16_f16 v[64:79], v[144:147], v[148:151], v[64:79]
    ds_read_b64 v[136:137], v8 offset:2368
    ds_read_b64 v[138:139], v8 offset:2376
    ds_read_b128 v[140:143], v9 offset:400
    s_add_u32 s24, s22, 1718272
    buffer_load_dwordx4 v154, s[36:39], s24 offen offset:2048 lds
    s_waitcnt vmcnt(14)
    ds_read_b64_tr_b16 v[232:233], v156 offset:2048
    ds_read_b64_tr_b16 v[234:235], v156 offset:2304
    s_waitcnt lgkmcnt(9)
    v_mfma_f32_32x32x16_f16 v[64:79], v[48:51], v[52:55], v[64:79]
    ds_read_b64 v[144:145], v8 offset:2304
    ds_read_b64 v[146:147], v8 offset:2312
    ds_read_b128 v[148:151], v9 offset:320
    s_waitcnt lgkmcnt(9)
    v_mfma_f32_32x32x16_f16 v[64:79], v[56:59], v[60:63], v[64:79]
    ds_read_b64 v[48:49], v8 offset:2240
    ds_read_b64 v[50:51], v8 offset:2248
    ds_read_b128 v[52:55], v9 offset:240
    s_waitcnt lgkmcnt(9)
    v_mfma_f32_32x32x16_f16 v[64:79], v[128:131], v[132:135], v[64:79]
    ds_read_b64 v[56:57], v8 offset:2176
    ds_read_b64 v[58:59], v8 offset:2184
    ds_read_b128 v[60:63], v9 offset:160
    s_add_u32 s24, s22, 1774592
    buffer_load_dwordx4 v154, s[36:39], s24 offen offset:3072 lds
    ds_read_b64_tr_b16 v[236:237], v156 offset:3072
    ds_read_b64_tr_b16 v[238:239], v156 offset:3328
    s_waitcnt lgkmcnt(9)
    v_mfma_f32_32x32x16_f16 v[64:79], v[136:139], v[140:143], v[64:79]
    ds_read_b64 v[128:129], v8 offset:2112
    ds_read_b64 v[130:131], v8 offset:2120
    ds_read_b128 v[132:135], v9 offset:80
    s_waitcnt lgkmcnt(9)
    v_mfma_f32_32x32x16_f16 v[64:79], v[144:147], v[148:151], v[64:79]
    ds_read_b64 v[136:137], v8 offset:2048
    ds_read_b64 v[138:139], v8 offset:2056
    ds_read_b128 v[140:143], v9 offset:0
    s_waitcnt lgkmcnt(9)
    v_mfma_f32_32x32x16_f16 v[64:79], v[48:51], v[52:55], v[64:79]
    ds_read_b64 v[144:145], v8 offset:1984
    ds_read_b64 v[146:147], v8 offset:1992
    ds_read_b128 v[148:151], v9 offset:2480
    s_waitcnt lgkmcnt(9)
    v_mfma_f32_32x32x16_f16 v[64:79], v[56:59], v[60:63], v[64:79]
    ds_read_b64 v[48:49], v8 offset:1920
    ds_read_b64 v[50:51], v8 offset:1928
    ds_read_b128 v[52:55], v9 offset:2400
    s_waitcnt lgkmcnt(9)
    v_mfma_f32_32x32x16_f16 v[64:79], v[128:131], v[132:135], v[64:79]
    ds_read_b64 v[56:57], v8 offset:1856
    ds_read_b64 v[58:59], v8 offset:1864
    ds_read_b128 v[60:63], v9 offset:2320
    s_add_u32 m0, s28, 0
    s_add_u32 s24, s23, 0
    buffer_load_dwordx4 v155, s[68:71], s24 offen offset:0 lds
    s_waitcnt vmcnt(14)
    ds_read_b64_tr_b16 v[240:241], v156 offset:4096
    ds_read_b64_tr_b16 v[242:243], v156 offset:4352
    s_waitcnt lgkmcnt(9)
    v_mfma_f32_32x32x16_f16 v[64:79], v[136:139], v[140:143], v[64:79]
    ds_read_b64 v[128:129], v8 offset:1792
    ds_read_b64 v[130:131], v8 offset:1800
    ds_read_b128 v[132:135], v9 offset:2240
    s_waitcnt lgkmcnt(9)
    v_mfma_f32_32x32x16_f16 v[80:95], v[144:147], v[148:151], 0
    ds_read_b64 v[136:137], v8 offset:1728
    ds_read_b64 v[138:139], v8 offset:1736
    ds_read_b128 v[140:143], v9 offset:2160
    s_add_u32 s24, s23, 7168
    buffer_load_dwordx4 v155, s[68:71], s24 offen offset:1024 lds
    ds_read_b64_tr_b16 v[244:245], v156 offset:5120
    ds_read_b64_tr_b16 v[246:247], v156 offset:5376
    s_waitcnt lgkmcnt(9)
    v_mfma_f32_32x32x16_f16 v[80:95], v[48:51], v[52:55], v[80:95]
    ds_read_b64 v[144:145], v8 offset:1664
    ds_read_b64 v[146:147], v8 offset:1672
    ds_read_b128 v[148:151], v9 offset:2080
    ds_write_b128 v10, v[64:67] offset:0
    ds_write_b128 v10, v[68:71] offset:32
    s_waitcnt lgkmcnt(9)
    v_mfma_f32_32x32x16_f16 v[80:95], v[56:59], v[60:63], v[80:95]
    ds_read_b64 v[48:49], v8 offset:1600
    ds_read_b64 v[50:51], v8 offset:1608
    ds_read_b128 v[52:55], v9 offset:2000
    ds_write_b128 v10, v[72:75] offset:64
    ds_write_b128 v10, v[76:79] offset:96
    s_waitcnt lgkmcnt(9)
    v_mfma_f32_32x32x16_f16 v[80:95], v[128:131], v[132:135], v[80:95]
    ds_read_b64 v[56:57], v8 offset:1536
    ds_read_b64 v[58:59], v8 offset:1544
    ds_read_b128 v[60:63], v9 offset:1920
    s_add_u32 s24, s23, 14336
    buffer_load_dwordx4 v155, s[68:71], s24 offen offset:2048 lds
    s_waitcnt vmcnt(14)
    ds_read_b64_tr_b16 v[248:249], v156 offset:6144
    ds_read_b64_tr_b16 v[250:251], v156 offset:6400
    s_waitcnt lgkmcnt(9)
    v_mfma_f32_32x32x16_f16 v[80:95], v[136:139], v[140:143], v[80:95]
    ds_read_b64 v[128:129], v8 offset:1472
    ds_read_b64 v[130:131], v8 offset:1480
    ds_read_b128 v[132:135], v9 offset:1840
    s_waitcnt lgkmcnt(0)
    s_barrier
    ds_read_b128 v[16:19], v14 offset:0
    ds_read_b128 v[20:23], v14 offset:9216
    ds_read_b128 v[32:35], v14 offset:18432
    ds_read_b128 v[36:39], v14 offset:27648
    s_waitcnt lgkmcnt(9)
    v_mfma_f32_32x32x16_f16 v[80:95], v[144:147], v[148:151], v[80:95]
    ds_read_b64 v[136:137], v8 offset:1408
    ds_read_b64 v[138:139], v8 offset:1416
    ds_read_b128 v[140:143], v9 offset:1760
    s_add_u32 s24, s23, 21504
    buffer_load_dwordx4 v155, s[68:71], s24 offen offset:3072 lds
    ds_read_b64_tr_b16 v[252:253], v156 offset:7168
    ds_read_b64_tr_b16 v[254:255], v156 offset:7424
    s_waitcnt lgkmcnt(9)
    v_mfma_f32_32x32x16_f16 v[80:95], v[48:51], v[52:55], v[80:95]
    ds_read_b64 v[144:145], v8 offset:1344
    ds_read_b64 v[146:147], v8 offset:1352
    ds_read_b128 v[148:151], v9 offset:1680
    s_waitcnt lgkmcnt(6)
    v_add_f32 v16, v16, v20
    v_add_f32 v17, v17, v21
    v_add_f32 v18, v18, v22
    v_add_f32 v19, v19, v23
    v_mul_f32 v16, s54, v16
    s_waitcnt lgkmcnt(9)
    v_mfma_f32_32x32x16_f16 v[80:95], v[56:59], v[60:63], v[80:95]
    ds_read_b64 v[48:49], v8 offset:1280
    ds_read_b64 v[50:51], v8 offset:1288
    ds_read_b128 v[52:55], v9 offset:1600
    v_mul_f32 v17, s54, v17
    v_mul_f32 v18, s54, v18
    v_mul_f32 v19, s54, v19
    v_cvt_pk_bf16_f32 v16, 0, v16
    v_cvt_pk_bf16_f32 v17, 0, v17
    s_waitcnt lgkmcnt(9)
    v_mfma_f32_32x32x16_f16 v[80:95], v[128:131], v[132:135], v[80:95]
    ds_read_b64 v[56:57], v8 offset:1216
    ds_read_b64 v[58:59], v8 offset:1224
    ds_read_b128 v[60:63], v9 offset:1520
    v_cvt_pk_bf16_f32 v18, 0, v18
    v_cvt_pk_bf16_f32 v19, 0, v19
    v_add_f32 v16, v16, v112
    v_add_f32 v17, v17, v114
    v_add_f32 v18, v18, v116
    s_waitcnt lgkmcnt(9)
    v_mfma_f32_32x32x16_f16 v[80:95], v[136:139], v[140:143], v[80:95]
    ds_read_b64 v[128:129], v8 offset:1152
    ds_read_b64 v[130:131], v8 offset:1160
    ds_read_b128 v[132:135], v9 offset:1440
    v_add_f32 v19, v19, v118
    v_cvt_pk_bf16_f32 v16, 0, v16
    v_cvt_pk_bf16_f32 v17, 0, v17
    v_cvt_pk_bf16_f32 v18, 0, v18
    v_cvt_pk_bf16_f32 v19, 0, v19
    s_waitcnt lgkmcnt(9)
    v_mfma_f32_32x32x16_f16 v[80:95], v[144:147], v[148:151], v[80:95]
    ds_read_b64 v[136:137], v8 offset:1088
    ds_read_b64 v[138:139], v8 offset:1096
    ds_read_b128 v[140:143], v9 offset:1360
    s_add_u32 m0, s28, 4096
    s_add_u32 s24, s23, 32768
    buffer_load_dwordx4 v155, s[68:71], s24 offen offset:0 lds
    s_waitcnt vmcnt(14)
    ds_read_b64_tr_b16 a[224:225], v156 offset:8192
    ds_read_b64_tr_b16 a[226:227], v156 offset:8448
    v_add_f32 v16, v16, v96
    v_add_f32 v17, v17, v98
    v_add_f32 v18, v18, v100
    v_add_f32 v19, v19, v102
    v_cvt_pk_bf16_f32 v20, v16, v17
    s_waitcnt lgkmcnt(9)
    v_mfma_f32_32x32x16_f16 v[80:95], v[48:51], v[52:55], v[80:95]
    ds_read_b64 v[144:145], v8 offset:1024
    ds_read_b64 v[146:147], v8 offset:1032
    ds_read_b128 v[148:151], v9 offset:1280
    v_cvt_pk_bf16_f32 v21, v18, v19
    global_store_dwordx2 v15, v[20:21], s[8:9] offset:0 sc1
    v_add_f32 v32, v32, v36
    v_add_f32 v33, v33, v37
    v_add_f32 v34, v34, v38
    s_waitcnt lgkmcnt(9)
    v_mfma_f32_32x32x16_f16 v[80:95], v[56:59], v[60:63], v[80:95]
    ds_read_b64 v[48:49], v8 offset:960
    ds_read_b64 v[50:51], v8 offset:968
    ds_read_b128 v[52:55], v9 offset:1200
    v_add_f32 v35, v35, v39
    v_mul_f32 v32, s55, v32
    v_mul_f32 v33, s55, v33
    v_mul_f32 v34, s55, v34
    v_mul_f32 v35, s55, v35
    s_waitcnt lgkmcnt(9)
    v_mfma_f32_32x32x16_f16 v[80:95], v[128:131], v[132:135], v[80:95]
    ds_read_b64 v[56:57], v8 offset:896
    ds_read_b64 v[58:59], v8 offset:904
    ds_read_b128 v[60:63], v9 offset:1120
    s_add_u32 s24, s23, 39936
    buffer_load_dwordx4 v155, s[68:71], s24 offen offset:1024 lds
    ds_read_b64_tr_b16 a[228:229], v156 offset:9216
    ds_read_b64_tr_b16 a[230:231], v156 offset:9472
    v_cvt_pk_bf16_f32 v32, 0, v32
    v_cvt_pk_bf16_f32 v33, 0, v33
    v_cvt_pk_bf16_f32 v34, 0, v34
    v_cvt_pk_bf16_f32 v35, 0, v35
    v_add_f32 v32, v32, v113
    s_waitcnt lgkmcnt(9)
    v_mfma_f32_32x32x16_f16 v[80:95], v[136:139], v[140:143], v[80:95]
    ds_read_b64 v[128:129], v8 offset:832
    ds_read_b64 v[130:131], v8 offset:840
    ds_read_b128 v[132:135], v9 offset:1040
    v_add_f32 v33, v33, v115
    v_add_f32 v34, v34, v117
    v_add_f32 v35, v35, v119
    v_cvt_pk_bf16_f32 v32, 0, v32
    v_cvt_pk_bf16_f32 v33, 0, v33
    s_waitcnt lgkmcnt(9)
    v_mfma_f32_32x32x16_f16 v[80:95], v[144:147], v[148:151], v[80:95]
    ds_read_b64 v[136:137], v8 offset:768
    ds_read_b64 v[138:139], v8 offset:776
    ds_read_b128 v[140:143], v9 offset:960
    s_add_u32 s24, s23, 47104
    buffer_load_dwordx4 v155, s[68:71], s24 offen offset:2048 lds
    s_waitcnt vmcnt(15)
    ds_read_b64_tr_b16 a[232:233], v156 offset:10240
    ds_read_b64_tr_b16 a[234:235], v156 offset:10496
    v_cvt_pk_bf16_f32 v34, 0, v34
    v_cvt_pk_bf16_f32 v35, 0, v35
    v_add_f32 v32, v32, v97
    v_add_f32 v33, v33, v99
    v_add_f32 v34, v34, v101
    s_waitcnt lgkmcnt(9)
    v_mfma_f32_32x32x16_f16 v[80:95], v[48:51], v[52:55], v[80:95]
    ds_read_b64 v[144:145], v8 offset:704
    ds_read_b64 v[146:147], v8 offset:712
    ds_read_b128 v[148:151], v9 offset:880
    v_add_f32 v35, v35, v103
    v_cvt_pk_bf16_f32 v36, v32, v33
    v_cvt_pk_bf16_f32 v37, v34, v35
    global_store_dwordx2 v15, v[36:37], s[8:9] offset:128 sc1
    s_waitcnt lgkmcnt(9)
    v_mfma_f32_32x32x16_f16 v[80:95], v[56:59], v[60:63], v[80:95]
    ds_read_b64 v[48:49], v8 offset:640
    ds_read_b64 v[50:51], v8 offset:648
    ds_read_b128 v[52:55], v9 offset:800
    s_waitcnt lgkmcnt(9)
    v_mfma_f32_32x32x16_f16 v[80:95], v[128:131], v[132:135], v[80:95]
    ds_read_b64 v[56:57], v8 offset:576
    ds_read_b64 v[58:59], v8 offset:584
    ds_read_b128 v[60:63], v9 offset:720
    s_add_u32 s24, s23, 54272
    buffer_load_dwordx4 v155, s[68:71], s24 offen offset:3072 lds
    ds_read_b64_tr_b16 a[236:237], v156 offset:11264
    ds_read_b64_tr_b16 a[238:239], v156 offset:11520
    s_waitcnt lgkmcnt(9)
    v_mfma_f32_32x32x16_f16 v[80:95], v[136:139], v[140:143], v[80:95]
    ds_read_b64 v[128:129], v8 offset:512
    ds_read_b64 v[130:131], v8 offset:520
    ds_read_b128 v[132:135], v9 offset:640
    s_waitcnt lgkmcnt(9)
    v_mfma_f32_32x32x16_f16 v[80:95], v[144:147], v[148:151], v[80:95]
    ds_read_b64 v[136:137], v8 offset:448
    ds_read_b64 v[138:139], v8 offset:456
    ds_read_b128 v[140:143], v9 offset:560
    s_waitcnt lgkmcnt(9)
    v_mfma_f32_32x32x16_f16 v[80:95], v[48:51], v[52:55], v[80:95]
    ds_read_b64 v[144:145], v8 offset:384
    ds_read_b64 v[146:147], v8 offset:392
    ds_read_b128 v[148:151], v9 offset:480
    s_waitcnt lgkmcnt(9)
    v_mfma_f32_32x32x16_f16 v[80:95], v[56:59], v[60:63], v[80:95]
    ds_read_b64 v[48:49], v8 offset:320
    ds_read_b64 v[50:51], v8 offset:328
    ds_read_b128 v[52:55], v9 offset:400
    s_waitcnt lgkmcnt(9)
    v_mfma_f32_32x32x16_f16 v[80:95], v[128:131], v[132:135], v[80:95]
    ds_read_b64 v[56:57], v8 offset:256
    ds_read_b64 v[58:59], v8 offset:264
    ds_read_b128 v[60:63], v9 offset:320
    s_add_u32 m0, s28, 8192
    s_add_u32 s24, s23, 65536
    buffer_load_dwordx4 v155, s[68:71], s24 offen offset:0 lds
    s_waitcnt vmcnt(16)
    ds_read_b64_tr_b16 a[240:241], v156 offset:12288
    ds_read_b64_tr_b16 a[242:243], v156 offset:12544
    s_waitcnt lgkmcnt(9)
    v_mfma_f32_32x32x16_f16 v[80:95], v[136:139], v[140:143], v[80:95]
    ds_read_b64 v[128:129], v8 offset:192
    ds_read_b64 v[130:131], v8 offset:200
    ds_read_b128 v[132:135], v9 offset:240
    s_waitcnt lgkmcnt(9)
    v_mfma_f32_32x32x16_f16 v[80:95], v[144:147], v[148:151], v[80:95]
    ds_read_b64 v[136:137], v8 offset:128
    ds_read_b64 v[138:139], v8 offset:136
    ds_read_b128 v[140:143], v9 offset:160
    s_add_u32 s24, s23, 72704
    buffer_load_dwordx4 v155, s[68:71], s24 offen offset:1024 lds
    ds_read_b64_tr_b16 a[244:245], v156 offset:13312
    ds_read_b64_tr_b16 a[246:247], v156 offset:13568
    s_waitcnt lgkmcnt(9)
    v_mfma_f32_32x32x16_f16 v[80:95], v[48:51], v[52:55], v[80:95]
    ds_read_b64 v[144:145], v8 offset:64
    ds_read_b64 v[146:147], v8 offset:72
    ds_read_b128 v[148:151], v9 offset:80
    s_waitcnt lgkmcnt(9)
    v_mfma_f32_32x32x16_f16 v[80:95], v[56:59], v[60:63], v[80:95]
    ds_read_b64 v[48:49], v8 offset:0
    ds_read_b64 v[50:51], v8 offset:8
    ds_read_b128 v[52:55], v9 offset:0
    s_waitcnt lgkmcnt(9)
    v_mfma_f32_32x32x16_f16 v[80:95], v[128:131], v[132:135], v[80:95]
    s_add_u32 s24, s23, 79872
    buffer_load_dwordx4 v155, s[68:71], s24 offen offset:2048 lds
    s_waitcnt vmcnt(13)
    ds_read_b64_tr_b16 a[248:249], v156 offset:14336
    ds_read_b64_tr_b16 a[250:251], v156 offset:14592
    s_waitcnt lgkmcnt(6)
    v_mfma_f32_32x32x16_f16 v[80:95], v[136:139], v[140:143], v[80:95]
    s_waitcnt lgkmcnt(3)
    v_mfma_f32_32x32x16_f16 v[80:95], v[144:147], v[148:151], v[80:95]
    s_waitcnt lgkmcnt(0)
    v_mfma_f32_32x32x16_f16 v[80:95], v[48:51], v[52:55], v[80:95]
    s_waitcnt vmcnt(4)
    s_barrier
    s_mov_b64 exec, 1
    v_mov_b32 v153, 1
    global_store_dword v152, v153, s[8:9] offset:0 sc1
    s_mov_b64 exec, -1
    v_lshlrev_b32 v104, 16, v24
    v_and_b32 v105, 0xffff0000, v24
    v_lshlrev_b32 v106, 16, v25
    v_and_b32 v107, 0xffff0000, v25
    v_lshlrev_b32 v108, 16, v26
    v_and_b32 v109, 0xffff0000, v26
    v_lshlrev_b32 v110, 16, v27
    v_and_b32 v111, 0xffff0000, v27
    v_pk_add_f32 v[120:121], v[104:105], v[40:41] op_sel:[0,0] op_sel_hi:[1,0] neg_lo:[0,1] neg_hi:[0,1]
    v_pk_add_f32 v[122:123], v[106:107], v[42:43] op_sel:[0,0] op_sel_hi:[1,0] neg_lo:[0,1] neg_hi:[0,1]
    v_pk_add_f32 v[124:125], v[108:109], v[44:45] op_sel:[0,0] op_sel_hi:[1,0] neg_lo:[0,1] neg_hi:[0,1]
    v_pk_add_f32 v[126:127], v[110:111], v[46:47] op_sel:[0,0] op_sel_hi:[1,0] neg_lo:[0,1] neg_hi:[0,1]
    v_cvt_pk_bf16_f32 v120, 0, v120
    v_cvt_pk_bf16_f32 v121, 0, v121
    v_cvt_pk_bf16_f32 v122, 0, v122
    v_cvt_pk_bf16_f32 v123, 0, v123
    v_cvt_pk_bf16_f32 v124, 0, v124
    v_cvt_pk_bf16_f32 v125, 0, v125
    v_cvt_pk_bf16_f32 v126, 0, v126
    v_cvt_pk_bf16_f32 v127, 0, v127
    v_pk_mul_f32 v[120:121], v[120:121], v[40:41] op_sel:[0,1] op_sel_hi:[1,1]
    v_pk_mul_f32 v[122:123], v[122:123], v[42:43] op_sel:[0,1] op_sel_hi:[1,1]
    v_pk_mul_f32 v[124:125], v[124:125], v[44:45] op_sel:[0,1] op_sel_hi:[1,1]
    v_pk_mul_f32 v[126:127], v[126:127], v[46:47] op_sel:[0,1] op_sel_hi:[1,1]
    v_cvt_pk_bf16_f32 v120, 0, v120
    v_cvt_pk_bf16_f32 v121, 0, v121
    v_cvt_pk_bf16_f32 v122, 0, v122
    v_cvt_pk_bf16_f32 v123, 0, v123
    v_cvt_pk_bf16_f32 v124, 0, v124
    v_cvt_pk_bf16_f32 v125, 0, v125
    v_cvt_pk_bf16_f32 v126, 0, v126
    v_cvt_pk_bf16_f32 v127, 0, v127
    v_cvt_pk_f16_f32 v28, v120, v122
    v_cvt_pk_f16_f32 v29, v124, v126
    v_cvt_pk_f16_f32 v30, v121, v123
    v_cvt_pk_f16_f32 v31, v125, v127
    ds_write_b64 v13, v[28:29] offset:2560
    ds_write_b64 v13, v[30:31] offset:10240
    s_waitcnt lgkmcnt(0)
    s_barrier
    ds_read_b64 v[56:57], v8 offset:4032
    ds_read_b64 v[58:59], v8 offset:4040
    ds_read_b128 v[60:63], v9 offset:5040
    ds_read_b64 v[128:129], v8 offset:3968
    ds_read_b64 v[130:131], v8 offset:3976
    ds_read_b128 v[132:135], v9 offset:4960
    ds_read_b64 v[136:137], v8 offset:3904
    ds_read_b64 v[138:139], v8 offset:3912
    ds_read_b128 v[140:143], v9 offset:4880
    ds_read_b64 v[144:145], v8 offset:3840
    ds_read_b64 v[146:147], v8 offset:3848
    ds_read_b128 v[148:151], v9 offset:4800
    s_waitcnt lgkmcnt(9)
    v_mfma_f32_32x32x16_f16 v[80:95], v[56:59], v[60:63], v[80:95]
    ds_read_b64 v[48:49], v8 offset:3776
    ds_read_b64 v[50:51], v8 offset:3784
    ds_read_b128 v[52:55], v9 offset:4720
    s_add_u32 s24, s23, 87040
    buffer_load_dwordx4 v155, s[68:71], s24 offen offset:3072 lds
    ds_read_b64_tr_b16 a[252:253], v156 offset:15360
    ds_read_b64_tr_b16 a[254:255], v156 offset:15616
    v_lshrrev_b32 v2, 2, v1
    v_lshlrev_b32 v13, 9, v2
    s_waitcnt lgkmcnt(9)
    v_mfma_f32_32x32x16_f16 v[80:95], v[128:131], v[132:135], v[80:95]
    ds_read_b64 v[56:57], v8 offset:3712
    ds_read_b64 v[58:59], v8 offset:3720
    ds_read_b128 v[60:63], v9 offset:4640
    v_and_b32 v2, 3, v1
    v_lshl_add_u32 v13, v2, 5, v13
    s_waitcnt lgkmcnt(9)
    v_mfma_f32_32x32x16_f16 v[80:95], v[136:139], v[140:143], v[80:95]
    ds_read_b64 v[128:129], v8 offset:3648
    ds_read_b64 v[130:131], v8 offset:3656
    ds_read_b128 v[132:135], v9 offset:4560
    s_add_u32 m0, s28, 12288
    s_add_u32 s24, s23, 98304
    buffer_load_dwordx4 v155, s[68:71], s24 offen offset:0 lds
    ds_read_b64_tr_b16 a[0:1], v157 offset:0
    ds_read_b64_tr_b16 a[4:5], v158 offset:0
    s_lshl_b32 s14, s10, 7
    s_add_u32 s14, s14, 17137664
    s_waitcnt lgkmcnt(9)
    v_mfma_f32_32x32x16_f16 v[80:95], v[144:147], v[148:151], v[80:95]
    ds_read_b64 v[136:137], v8 offset:3584
    ds_read_b64 v[138:139], v8 offset:3592
    ds_read_b128 v[140:143], v9 offset:4480
    s_add_u32 s24, s23, 105472
    buffer_load_dwordx4 v155, s[68:71], s24 offen offset:1024 lds
    ds_read_b64_tr_b16 a[2:3], v157 offset:1024
    ds_read_b64_tr_b16 a[6:7], v158 offset:1024
    v_add_u32 v13, s14, v13
    s_add_u32 s16, s8, 2097152
    s_addc_u32 s17, s9, 0
    s_waitcnt lgkmcnt(9)
    v_mfma_f32_32x32x16_f16 v[80:95], v[48:51], v[52:55], v[80:95]
    ds_read_b64 v[144:145], v8 offset:3520
    ds_read_b64 v[146:147], v8 offset:3528
    ds_read_b128 v[148:151], v9 offset:4400
    v_lshrrev_b32 v2, 3, v1
    v_and_b32 v3, 7, v1
    s_waitcnt lgkmcnt(9)
    v_mfma_f32_32x32x16_f16 v[80:95], v[56:59], v[60:63], v[80:95]
    ds_read_b64 v[48:49], v8 offset:3456
    ds_read_b64 v[50:51], v8 offset:3464
    ds_read_b128 v[52:55], v9 offset:4320
    s_add_u32 s24, s23, 112640
    buffer_load_dwordx4 v155, s[68:71], s24 offen offset:2048 lds
    ds_read_b64_tr_b16 a[8:9], v157 offset:2048
    ds_read_b64_tr_b16 a[12:13], v158 offset:2048
    v_bfe_u32 v4, v1, 4, 1
    v_lshlrev_b32 v4, 2, v4
    s_waitcnt lgkmcnt(9)
    v_mfma_f32_32x32x16_f16 v[80:95], v[128:131], v[132:135], v[80:95]
    ds_read_b64 v[56:57], v8 offset:3392
    ds_read_b64 v[58:59], v8 offset:3400
    ds_read_b128 v[60:63], v9 offset:4240
    v_xor_b32 v4, v4, v3
    v_lshlrev_b32 v4, 4, v4
    s_waitcnt lgkmcnt(9)
    v_mfma_f32_32x32x16_f16 v[80:95], v[136:139], v[140:143], v[80:95]
    ds_read_b64 v[128:129], v8 offset:3328
    ds_read_b64 v[130:131], v8 offset:3336
    ds_read_b128 v[132:135], v9 offset:4160
    v_lshl_add_u32 v4, v2, 7, v4
    s_lshl_b32 s14, s11, 16
    s_waitcnt lgkmcnt(9)
    v_mfma_f32_32x32x16_f16 v[80:95], v[144:147], v[148:151], v[80:95]
    ds_read_b64 v[136:137], v8 offset:3264
    ds_read_b64 v[138:139], v8 offset:3272
    ds_read_b128 v[140:143], v9 offset:4080
    v_add_u32 v4, s14, v4
    v_lshlrev_b32 v5, 4, v1
    s_waitcnt lgkmcnt(9)
    v_mfma_f32_32x32x16_f16 v[80:95], v[48:51], v[52:55], v[80:95]
    ds_read_b64 v[144:145], v8 offset:3200
    ds_read_b64 v[146:147], v8 offset:3208
    ds_read_b128 v[148:151], v9 offset:4000
    s_add_u32 s24, s23, 119808
    buffer_load_dwordx4 v155, s[68:71], s24 offen offset:3072 lds
    ds_read_b64_tr_b16 a[10:11], v157 offset:3072
    ds_read_b64_tr_b16 a[14:15], v158 offset:3072
    v_mov_b32 v7, v5
    v_add_u32 v6, 114688, v5
    s_waitcnt lgkmcnt(9)
    v_mfma_f32_32x32x16_f16 v[80:95], v[56:59], v[60:63], v[80:95]
    ds_read_b64 v[48:49], v8 offset:3136
    ds_read_b64 v[50:51], v8 offset:3144
    ds_read_b128 v[52:55], v9 offset:3920
    v_mul_f32 v120, s52, v120
    v_mul_f32 v121, s53, v121
    s_waitcnt lgkmcnt(9)
    v_mfma_f32_32x32x16_f16 v[80:95], v[128:131], v[132:135], v[80:95]
    ds_read_b64 v[56:57], v8 offset:3072
    ds_read_b64 v[58:59], v8 offset:3080
    ds_read_b128 v[60:63], v9 offset:3840
    s_add_u32 m0, s28, 0
    s_add_u32 s24, s23, 131072
    buffer_load_dwordx4 v155, s[68:71], s24 offen offset:0 lds
    ds_read_b64_tr_b16 a[16:17], v157 offset:4096
    ds_read_b64_tr_b16 a[20:21], v158 offset:4096
    v_mul_f32 v122, s52, v122
    v_mul_f32 v123, s53, v123
    s_waitcnt lgkmcnt(9)
    v_mfma_f32_32x32x16_f16 v[80:95], v[136:139], v[140:143], v[80:95]
    ds_read_b64 v[128:129], v8 offset:3008
    ds_read_b64 v[130:131], v8 offset:3016
    ds_read_b128 v[132:135], v9 offset:3760
    s_add_u32 s24, s23, 138240
    buffer_load_dwordx4 v155, s[68:71], s24 offen offset:1024 lds
    ds_read_b64_tr_b16 a[18:19], v157 offset:5120
    ds_read_b64_tr_b16 a[22:23], v158 offset:5120
    v_mul_f32 v124, s52, v124
    v_mul_f32 v125, s53, v125
    s_waitcnt lgkmcnt(9)
    v_mfma_f32_32x32x16_f16 v[80:95], v[144:147], v[148:151], v[80:95]
    ds_read_b64 v[136:137], v8 offset:2944
    ds_read_b64 v[138:139], v8 offset:2952
    ds_read_b128 v[140:143], v9 offset:3680
    v_mul_f32 v126, s52, v126
    v_mul_f32 v127, s53, v127
    s_waitcnt lgkmcnt(9)
    v_mfma_f32_32x32x16_f16 v[80:95], v[48:51], v[52:55], v[80:95]
    ds_read_b64 v[144:145], v8 offset:2880
    ds_read_b64 v[146:147], v8 offset:2888
    ds_read_b128 v[148:151], v9 offset:3600
    s_add_u32 s24, s23, 145408
    buffer_load_dwordx4 v155, s[68:71], s24 offen offset:2048 lds
    s_waitcnt vmcnt(12)
    ds_read_b64_tr_b16 a[24:25], v157 offset:6144
    ds_read_b64_tr_b16 a[28:29], v158 offset:6144
    v_cvt_pk_bf16_f32 v120, 0, v120
    v_cvt_pk_bf16_f32 v121, 0, v121
    s_waitcnt lgkmcnt(9)
    v_mfma_f32_32x32x16_f16 v[80:95], v[56:59], v[60:63], v[80:95]
    ds_read_b64 v[48:49], v8 offset:2816
    ds_read_b64 v[50:51], v8 offset:2824
    ds_read_b128 v[52:55], v9 offset:3520
    v_cvt_pk_bf16_f32 v122, 0, v122
    v_cvt_pk_bf16_f32 v123, 0, v123
    s_waitcnt lgkmcnt(9)
    v_mfma_f32_32x32x16_f16 v[80:95], v[128:131], v[132:135], v[80:95]
    ds_read_b64 v[56:57], v8 offset:2752
    ds_read_b64 v[58:59], v8 offset:2760
    ds_read_b128 v[60:63], v9 offset:3440
    v_cvt_pk_bf16_f32 v124, 0, v124
    v_cvt_pk_bf16_f32 v125, 0, v125
    s_waitcnt lgkmcnt(9)
    v_mfma_f32_32x32x16_f16 v[80:95], v[136:139], v[140:143], v[80:95]
    ds_read_b64 v[128:129], v8 offset:2688
    ds_read_b64 v[130:131], v8 offset:2696
    ds_read_b128 v[132:135], v9 offset:3360
    v_cvt_pk_bf16_f32 v126, 0, v126
    v_cvt_pk_bf16_f32 v127, 0, v127
    s_waitcnt lgkmcnt(9)
    v_mfma_f32_32x32x16_f16 v[80:95], v[144:147], v[148:151], v[80:95]
    ds_read_b64 v[136:137], v8 offset:2624
    ds_read_b64 v[138:139], v8 offset:2632
    ds_read_b128 v[140:143], v9 offset:3280
    s_add_u32 s24, s23, 152576
    buffer_load_dwordx4 v155, s[68:71], s24 offen offset:3072 lds
    ds_read_b64_tr_b16 a[26:27], v157 offset:7168
    ds_read_b64_tr_b16 a[30:31], v158 offset:7168
    s_waitcnt lgkmcnt(9)
    v_mfma_f32_32x32x16_f16 v[80:95], v[48:51], v[52:55], v[80:95]
    ds_read_b64 v[144:145], v8 offset:2560
    ds_read_b64 v[146:147], v8 offset:2568
    ds_read_b128 v[148:151], v9 offset:3200
    s_waitcnt lgkmcnt(9)
    v_mfma_f32_32x32x16_f16 v[80:95], v[56:59], v[60:63], v[80:95]
    ds_read_b64 v[48:49], v8 offset:2496
    ds_read_b64 v[50:51], v8 offset:2504
    ds_read_b128 v[52:55], v9 offset:3120
    s_add_u32 m0, s28, 4096
    s_add_u32 s24, s23, 163840
    buffer_load_dwordx4 v155, s[68:71], s24 offen offset:0 lds
    s_waitcnt vmcnt(12)
    ds_read_b64_tr_b16 a[32:33], v157 offset:8192
    ds_read_b64_tr_b16 a[36:37], v158 offset:8192
    s_waitcnt lgkmcnt(9)
    v_mfma_f32_32x32x16_f16 v[80:95], v[128:131], v[132:135], v[80:95]
    ds_read_b64 v[56:57], v8 offset:2432
    ds_read_b64 v[58:59], v8 offset:2440
    ds_read_b128 v[60:63], v9 offset:3040
    s_add_u32 s24, s23, 171008
    buffer_load_dwordx4 v155, s[68:71], s24 offen offset:1024 lds
    ds_read_b64_tr_b16 a[34:35], v157 offset:9216
    ds_read_b64_tr_b16 a[38:39], v158 offset:9216
    s_waitcnt lgkmcnt(9)
    v_mfma_f32_32x32x16_f16 v[80:95], v[136:139], v[140:143], v[80:95]
    ds_read_b64 v[128:129], v8 offset:2368
    ds_read_b64 v[130:131], v8 offset:2376
    ds_read_b128 v[132:135], v9 offset:2960
    global_load_dword v16, v13, s[8:9] offset:0 sc1
    s_waitcnt lgkmcnt(9)
    v_mfma_f32_32x32x16_f16 v[80:95], v[144:147], v[148:151], v[80:95]
    ds_read_b64 v[136:137], v8 offset:2304
    ds_read_b64 v[138:139], v8 offset:2312
    ds_read_b128 v[140:143], v9 offset:2880
    s_add_u32 s24, s23, 178176
    buffer_load_dwordx4 v155, s[68:71], s24 offen offset:2048 lds
    s_waitcnt vmcnt(12)
    ds_read_b64_tr_b16 a[40:41], v157 offset:10240
    ds_read_b64_tr_b16 a[44:45], v158 offset:10240
    s_waitcnt lgkmcnt(9)
    v_mfma_f32_32x32x16_f16 v[80:95], v[48:51], v[52:55], v[80:95]
    ds_read_b64 v[144:145], v8 offset:2240
    ds_read_b64 v[146:147], v8 offset:2248
    ds_read_b128 v[148:151], v9 offset:2800
    s_waitcnt lgkmcnt(9)
    v_mfma_f32_32x32x16_f16 v[80:95], v[56:59], v[60:63], v[80:95]
    ds_read_b64 v[48:49], v8 offset:2176
    ds_read_b64 v[50:51], v8 offset:2184
    ds_read_b128 v[52:55], v9 offset:2720
    s_waitcnt lgkmcnt(9)
    v_mfma_f32_32x32x16_f16 v[80:95], v[128:131], v[132:135], v[80:95]
    ds_read_b64 v[56:57], v8 offset:2112
    ds_read_b64 v[58:59], v8 offset:2120
    ds_read_b128 v[60:63], v9 offset:2640
    s_waitcnt lgkmcnt(9)
    v_mfma_f32_32x32x16_f16 v[80:95], v[136:139], v[140:143], v[80:95]
    ds_read_b64 v[128:129], v8 offset:2048
    ds_read_b64 v[130:131], v8 offset:2056
    ds_read_b128 v[132:135], v9 offset:2560
    s_add_u32 s24, s23, 185344
    buffer_load_dwordx4 v155, s[68:71], s24 offen offset:3072 lds
    ds_read_b64_tr_b16 a[42:43], v157 offset:11264
    ds_read_b64_tr_b16 a[46:47], v158 offset:11264
    s_waitcnt lgkmcnt(9)
    v_mfma_f32_32x32x16_f16 v[80:95], v[144:147], v[148:151], v[80:95]
    s_waitcnt lgkmcnt(6)
    v_mfma_f32_32x32x16_f16 v[80:95], v[48:51], v[52:55], v[80:95]
    s_waitcnt lgkmcnt(3)
    v_mfma_f32_32x32x16_f16 v[80:95], v[56:59], v[60:63], v[80:95]
    s_waitcnt lgkmcnt(0)
    v_mfma_f32_32x32x16_f16 v[80:95], v[128:131], v[132:135], v[80:95]
    s_waitcnt vmcnt(11)
    ds_read_b64_tr_b16 a[48:49], v157 offset:12288
    ds_read_b64_tr_b16 a[52:53], v158 offset:12288
    ds_read_b64_tr_b16 a[50:51], v157 offset:13312
    ds_read_b64_tr_b16 a[54:55], v158 offset:13312
    s_waitcnt vmcnt(9)
    ds_read_b64_tr_b16 a[56:57], v157 offset:14336
    ds_read_b64_tr_b16 a[60:61], v158 offset:14336
    ds_read_b64_tr_b16 a[58:59], v157 offset:15360
    ds_read_b64_tr_b16 a[62:63], v158 offset:15360
    s_waitcnt vmcnt(8)
    ds_read_b64_tr_b16 a[64:65], v157 offset:0
    ds_read_b64_tr_b16 a[68:69], v158 offset:0
    s_waitcnt vmcnt(7)
    ds_read_b64_tr_b16 a[66:67], v157 offset:1024
    ds_read_b64_tr_b16 a[70:71], v158 offset:1024
    s_waitcnt vmcnt(6)
    ds_read_b64_tr_b16 a[72:73], v157 offset:2048
    ds_read_b64_tr_b16 a[76:77], v158 offset:2048
    s_waitcnt vmcnt(5)
    ds_read_b64_tr_b16 a[74:75], v157 offset:3072
    ds_read_b64_tr_b16 a[78:79], v158 offset:3072
    s_waitcnt vmcnt(4)
    ds_read_b64_tr_b16 a[80:81], v157 offset:4096
    ds_read_b64_tr_b16 a[84:85], v158 offset:4096
    s_waitcnt vmcnt(3)
    ds_read_b64_tr_b16 a[82:83], v157 offset:5120
    ds_read_b64_tr_b16 a[86:87], v158 offset:5120
    s_waitcnt vmcnt(1)
    ds_read_b64_tr_b16 a[88:89], v157 offset:6144
    ds_read_b64_tr_b16 a[92:93], v158 offset:6144
    s_waitcnt vmcnt(0)
    ds_read_b64_tr_b16 a[90:91], v157 offset:7168
    ds_read_b64_tr_b16 a[94:95], v158 offset:7168
    ds_write_b128 v10, v[80:83] offset:4608
    ds_write_b128 v10, v[84:87] offset:4640
    ds_write_b128 v10, v[88:91] offset:4672
    ds_write_b128 v10, v[92:95] offset:4704
    s_waitcnt lgkmcnt(0)
    s_barrier
    ds_read_b128 v[24:27], v14 offset:4608
    ds_read_b128 v[28:31], v14 offset:13824
    ds_read_b128 v[40:43], v14 offset:23040
    ds_read_b128 v[44:47], v14 offset:32256
    v_cmp_gt_u32 vcc, 1, v16
    s_nop 1
    s_cbranch_vccnz pollXE_0
pollXE_0_ok:
    s_add_u32 m0, s21, 98304
    s_add_u32 s24, s21, 0
    buffer_load_dwordx4 v4, s[16:19], s24 offen sc1 lds
    s_add_u32 m0, s21, 102400
    s_add_u32 s24, s21, 4096
    buffer_load_dwordx4 v4, s[16:19], s24 offen sc1 lds
    s_add_u32 m0, s21, 106496
    s_add_u32 s24, s21, 8192
    buffer_load_dwordx4 v4, s[16:19], s24 offen sc1 lds
    s_waitcnt lgkmcnt(0)
    v_add_f32 v24, v24, v28
    v_add_f32 v25, v25, v29
    v_add_f32 v26, v26, v30
    v_add_f32 v27, v27, v31
    v_mul_f32 v24, s54, v24
    v_mul_f32 v25, s54, v25
    v_mul_f32 v26, s54, v26
    v_mul_f32 v27, s54, v27
    v_cvt_pk_bf16_f32 v24, 0, v24
    v_cvt_pk_bf16_f32 v25, 0, v25
    v_cvt_pk_bf16_f32 v26, 0, v26
    v_cvt_pk_bf16_f32 v27, 0, v27
    s_add_u32 m0, s21, 110592
    s_add_u32 s24, s21, 12288
    buffer_load_dwordx4 v4, s[16:19], s24 offen sc1 lds
    v_add_f32 v24, v24, v120
    v_add_f32 v25, v25, v122
    v_add_f32 v26, v26, v124
    v_add_f32 v27, v27, v126
    v_cvt_pk_bf16_f32 v24, 0, v24
    v_cvt_pk_bf16_f32 v25, 0, v25
    v_cvt_pk_bf16_f32 v26, 0, v26
    v_cvt_pk_bf16_f32 v27, 0, v27
    v_add_f32 v24, v24, v104
    v_add_f32 v25, v25, v106
    v_add_f32 v26, v26, v108
    v_add_f32 v27, v27, v110
    s_add_u32 m0, s21, 114688
    s_add_u32 s24, s21, 16384
    buffer_load_dwordx4 v4, s[16:19], s24 offen sc1 lds
    v_cvt_pk_bf16_f32 v28, v24, v25
    v_cvt_pk_bf16_f32 v29, v26, v27
    global_store_dwordx2 v12, v[28:29], s[8:9] offset:0 sc1
    v_add_f32 v40, v40, v44
    v_add_f32 v41, v41, v45
    v_add_f32 v42, v42, v46
    v_add_f32 v43, v43, v47
    v_mul_f32 v40, s55, v40
    v_mul_f32 v41, s55, v41
    v_mul_f32 v42, s55, v42
    v_mul_f32 v43, s55, v43
    v_cvt_pk_bf16_f32 v40, 0, v40
    s_add_u32 m0, s21, 118784
    s_add_u32 s24, s21, 20480
    buffer_load_dwordx4 v4, s[16:19], s24 offen sc1 lds
    v_cvt_pk_bf16_f32 v41, 0, v41
    v_cvt_pk_bf16_f32 v42, 0, v42
    v_cvt_pk_bf16_f32 v43, 0, v43
    v_add_f32 v40, v40, v121
    v_add_f32 v41, v41, v123
    v_add_f32 v42, v42, v125
    v_add_f32 v43, v43, v127
    v_cvt_pk_bf16_f32 v40, 0, v40
    v_cvt_pk_bf16_f32 v41, 0, v41
    v_cvt_pk_bf16_f32 v42, 0, v42
    v_cvt_pk_bf16_f32 v43, 0, v43
    v_add_f32 v40, v40, v105
    s_add_u32 m0, s21, 122880
    s_add_u32 s24, s21, 24576
    buffer_load_dwordx4 v4, s[16:19], s24 offen sc1 lds
    v_add_f32 v41, v41, v107
    v_add_f32 v42, v42, v109
    v_add_f32 v43, v43, v111
    v_cvt_pk_bf16_f32 v44, v40, v41
    v_cvt_pk_bf16_f32 v45, v42, v43
    global_store_dwordx2 v12, v[44:45], s[8:9] offset:128 sc1
    s_add_u32 m0, s21, 126976
    s_add_u32 s24, s21, 28672
    buffer_load_dwordx4 v4, s[16:19], s24 offen sc1 lds
    v_mov_b32 v14, s59
    v_and_b32 v15, 3, v1
    v_lshl_add_u32 v15, v15, 7, s60
    v_bfe_u32 v2, v1, 2, 2
    s_xor_b32 s21, s21, 0x8000
    s_add_u32 m0, s21, 98304
    s_add_u32 s24, s21, 0
    buffer_load_dwordx4 v4, s[16:19], s24 offen sc1 lds
    v_lshlrev_b32 v10, 7, v2
    v_bfe_u32 v3, v1, 4, 1
    v_lshl_add_u32 v10, v3, 5, v10
    v_and_b32 v3, 3, v1
    s_add_u32 m0, s21, 102400
    s_add_u32 s24, s21, 4096
    buffer_load_dwordx4 v4, s[16:19], s24 offen sc1 lds
    v_lshl_add_u32 v10, v3, 3, v10
    v_lshrrev_b32 v2, 1, v2
    v_lshrrev_b32 v3, 5, v1
    v_lshl_add_u32 v9, v3, 10, v10
    s_add_u32 m0, s21, 106496
    s_add_u32 s24, s21, 8192
    buffer_load_dwordx4 v4, s[16:19], s24 offen sc1 lds
    v_lshl_add_u32 v10, v3, 9, v10
    v_add_u32 v9, 98304, v9
    v_lshl_add_u32 v8, v2, 6, v9
    v_xor_b32 v3, 1, v2
    s_add_u32 m0, s21, 110592
    s_add_u32 s24, s21, 12288
    buffer_load_dwordx4 v4, s[16:19], s24 offen sc1 lds
    v_lshl_add_u32 v9, v3, 6, v9
    v_xor_b32 v2, s35, v2
    v_lshl_add_u32 v10, v2, 6, v10
    s_lshl_b32 s14, s46, 7
    s_add_u32 m0, s21, 114688
    s_add_u32 s24, s21, 16384
    buffer_load_dwordx4 v4, s[16:19], s24 offen sc1 lds
    v_add_u32 v10, s14, v10
    v_add_u32 v11, 98304, v10
    v_and_b32 v2, 31, v1
    s_lshl_b32 s14, s11, 10
    s_add_u32 m0, s21, 118784
    s_add_u32 s24, s21, 20480
    buffer_load_dwordx4 v4, s[16:19], s24 offen sc1 lds
    s_add_u32 s14, s14, 17170432
    v_lshl_add_u32 v12, v2, 4, s14
    v_subrev_u32 v29, 98304, v157
    v_subrev_u32 v154, 98304, v158
    s_add_u32 m0, s21, 122880
    s_add_u32 s24, s21, 24576
    buffer_load_dwordx4 v4, s[16:19], s24 offen sc1 lds
    s_add_u32 m0, s21, 126976
    s_add_u32 s24, s21, 28672
    s_xor_b32 s21, s21, 0x8000
    buffer_load_dwordx4 v4, s[16:19], s24 offen sc1 lds
    s_cmp_ge_u32 s12, 14
    s_cbranch_scc1 ffn_helper_0
    v_mov_b32 v2, 0
    v_mov_b32 v3, 0
    v_dot2c_f32_bf16 v2, s25, v160
    v_dot2c_f32_bf16 v3, s25, v161
    v_dot2c_f32_bf16 v2, s25, v162
    v_dot2c_f32_bf16 v3, s25, v163
    v_dot2c_f32_bf16 v2, s25, v164
    v_dot2c_f32_bf16 v3, s25, v165
    v_dot2c_f32_bf16 v2, s25, v166
    v_dot2c_f32_bf16 v3, s25, v167
    v_dot2c_f32_bf16 v2, s25, v168
    v_dot2c_f32_bf16 v3, s25, v169
    v_dot2c_f32_bf16 v2, s25, v170
    v_dot2c_f32_bf16 v3, s25, v171
    v_dot2c_f32_bf16 v2, s25, v172
    v_dot2c_f32_bf16 v3, s25, v173
    v_dot2c_f32_bf16 v2, s25, v174
    v_dot2c_f32_bf16 v3, s25, v175
    v_dot2c_f32_bf16 v2, s25, v176
    v_dot2c_f32_bf16 v3, s25, v177
    v_dot2c_f32_bf16 v2, s25, v178
    v_dot2c_f32_bf16 v3, s25, v179
    v_dot2c_f32_bf16 v2, s25, v180
    v_dot2c_f32_bf16 v3, s25, v181
    v_dot2c_f32_bf16 v2, s25, v182
    v_dot2c_f32_bf16 v3, s25, v183
    v_dot2c_f32_bf16 v2, s25, v184
    v_dot2c_f32_bf16 v3, s25, v185
    v_dot2c_f32_bf16 v2, s25, v186
    v_dot2c_f32_bf16 v3, s25, v187
    v_dot2c_f32_bf16 v2, s25, v188
    v_dot2c_f32_bf16 v3, s25, v189
    v_dot2c_f32_bf16 v2, s25, v190
    v_dot2c_f32_bf16 v3, s25, v191
    v_dot2c_f32_bf16 v2, s25, v192
    v_dot2c_f32_bf16 v3, s25, v193
    v_dot2c_f32_bf16 v2, s25, v194
    v_dot2c_f32_bf16 v3, s25, v195
    v_dot2c_f32_bf16 v2, s25, v196
    v_dot2c_f32_bf16 v3, s25, v197
    v_dot2c_f32_bf16 v2, s25, v198
    v_dot2c_f32_bf16 v3, s25, v199
    v_dot2c_f32_bf16 v2, s25, v200
    v_dot2c_f32_bf16 v3, s25, v201
    v_dot2c_f32_bf16 v2, s25, v202
    v_dot2c_f32_bf16 v3, s25, v203
    v_dot2c_f32_bf16 v2, s25, v204
    v_dot2c_f32_bf16 v3, s25, v205
    v_dot2c_f32_bf16 v2, s25, v206
    v_dot2c_f32_bf16 v3, s25, v207
    v_dot2c_f32_bf16 v2, s25, v208
    v_dot2c_f32_bf16 v3, s25, v209
    v_dot2c_f32_bf16 v2, s25, v210
    v_dot2c_f32_bf16 v3, s25, v211
    v_dot2c_f32_bf16 v2, s25, v212
    v_dot2c_f32_bf16 v3, s25, v213
    v_dot2c_f32_bf16 v2, s25, v214
    v_dot2c_f32_bf16 v3, s25, v215
    v_dot2c_f32_bf16 v2, s25, v216
    v_dot2c_f32_bf16 v3, s25, v217
    v_dot2c_f32_bf16 v2, s25, v218
    v_dot2c_f32_bf16 v3, s25, v219
    v_dot2c_f32_bf16 v2, s25, v220
    v_dot2c_f32_bf16 v3, s25, v221
    v_dot2c_f32_bf16 v2, s25, v222
    v_dot2c_f32_bf16 v3, s25, v223
    v_dot2c_f32_bf16 v2, s25, v224
    v_dot2c_f32_bf16 v3, s25, v225
    v_dot2c_f32_bf16 v2, s25, v226
    v_dot2c_f32_bf16 v3, s25, v227
    v_dot2c_f32_bf16 v2, s25, v228
    v_dot2c_f32_bf16 v3, s25, v229
    v_dot2c_f32_bf16 v2, s25, v230
    v_dot2c_f32_bf16 v3, s25, v231
    v_dot2c_f32_bf16 v2, s25, v232
    v_dot2c_f32_bf16 v3, s25, v233
    v_dot2c_f32_bf16 v2, s25, v234
    v_dot2c_f32_bf16 v3, s25, v235
    v_dot2c_f32_bf16 v2, s25, v236
    v_dot2c_f32_bf16 v3, s25, v237
    v_dot2c_f32_bf16 v2, s25, v238
    v_dot2c_f32_bf16 v3, s25, v239
    v_dot2c_f32_bf16 v2, s25, v240
    v_dot2c_f32_bf16 v3, s25, v241
    v_dot2c_f32_bf16 v2, s25, v242
    v_dot2c_f32_bf16 v3, s25, v243
    v_dot2c_f32_bf16 v2, s25, v244
    v_dot2c_f32_bf16 v3, s25, v245
    v_dot2c_f32_bf16 v2, s25, v246
    v_dot2c_f32_bf16 v3, s25, v247
    v_dot2c_f32_bf16 v2, s25, v248
    v_dot2c_f32_bf16 v3, s25, v249
    v_dot2c_f32_bf16 v2, s25, v250
    v_dot2c_f32_bf16 v3, s25, v251
    v_dot2c_f32_bf16 v2, s25, v252
    v_dot2c_f32_bf16 v3, s25, v253
    v_dot2c_f32_bf16 v2, s25, v254
    v_dot2c_f32_bf16 v3, s25, v255
    v_accvgpr_read_b32 v32, a224
    v_accvgpr_read_b32 v33, a225
    s_waitcnt vmcnt(9)
    s_barrier
    s_mov_b64 exec, 1
    v_mov_b32 v153, 2
    global_store_dword v152, v153, s[8:9] offset:0 sc1
    s_mov_b64 exec, -1
    v_accvgpr_read_b32 v34, a226
    v_accvgpr_read_b32 v35, a227
    v_accvgpr_read_b32 v36, a228
    v_accvgpr_read_b32 v37, a229
    v_accvgpr_read_b32 v38, a230
    v_accvgpr_read_b32 v39, a231
    v_accvgpr_read_b32 v40, a232
    v_accvgpr_read_b32 v41, a233
    v_accvgpr_read_b32 v42, a234
    v_accvgpr_read_b32 v43, a235
    v_accvgpr_read_b32 v44, a236
    v_accvgpr_read_b32 v45, a237
    v_accvgpr_read_b32 v46, a238
    v_accvgpr_read_b32 v47, a239
    v_accvgpr_read_b32 v48, a240
    v_accvgpr_read_b32 v49, a241
    v_accvgpr_read_b32 v50, a242
    v_accvgpr_read_b32 v51, a243
    v_accvgpr_read_b32 v52, a244
    v_accvgpr_read_b32 v53, a245
    v_accvgpr_read_b32 v54, a246
    v_accvgpr_read_b32 v55, a247
    v_accvgpr_read_b32 v56, a248
    v_accvgpr_read_b32 v57, a249
    v_accvgpr_read_b32 v58, a250
    v_accvgpr_read_b32 v59, a251
    v_accvgpr_read_b32 v60, a252
    v_accvgpr_read_b32 v61, a253
    v_accvgpr_read_b32 v62, a254
    v_accvgpr_read_b32 v63, a255
    v_dot2c_f32_bf16 v2, s25, v32
    v_dot2c_f32_bf16 v3, s25, v33
    v_dot2c_f32_bf16 v2, s25, v34
    v_dot2c_f32_bf16 v3, s25, v35
    v_dot2c_f32_bf16 v2, s25, v36
    v_dot2c_f32_bf16 v3, s25, v37
    v_dot2c_f32_bf16 v2, s25, v38
    v_dot2c_f32_bf16 v3, s25, v39
    v_dot2c_f32_bf16 v2, s25, v40
    v_dot2c_f32_bf16 v3, s25, v41
    v_dot2c_f32_bf16 v2, s25, v42
    v_dot2c_f32_bf16 v3, s25, v43
    v_dot2c_f32_bf16 v2, s25, v44
    v_dot2c_f32_bf16 v3, s25, v45
    v_dot2c_f32_bf16 v2, s25, v46
    v_dot2c_f32_bf16 v3, s25, v47
    v_dot2c_f32_bf16 v2, s25, v48
    v_dot2c_f32_bf16 v3, s25, v49
    v_dot2c_f32_bf16 v2, s25, v50
    v_dot2c_f32_bf16 v3, s25, v51
    v_dot2c_f32_bf16 v2, s25, v52
    v_dot2c_f32_bf16 v3, s25, v53
    v_dot2c_f32_bf16 v2, s25, v54
    v_dot2c_f32_bf16 v3, s25, v55
    v_dot2c_f32_bf16 v2, s25, v56
    v_dot2c_f32_bf16 v3, s25, v57
    v_dot2c_f32_bf16 v2, s25, v58
    v_dot2c_f32_bf16 v3, s25, v59
    v_dot2c_f32_bf16 v2, s25, v60
    v_dot2c_f32_bf16 v3, s25, v61
    v_dot2c_f32_bf16 v2, s25, v62
    v_dot2c_f32_bf16 v3, s25, v63
    s_nop 2
    v_add_f32 v2, v2, v3
    v_cvt_pk_bf16_f32 v3, v2, v2
    v_lshlrev_b32 v3, 16, v3
    v_sub_f32 v2, v2, v3
    v_cvt_pk_bf16_f32 v16, v2, v2
    v_lshlrev_b32 v16, 16, v16
    v_sub_f32 v2, v2, v16
    v_cvt_pk_bf16_f32 v156, v3, v16
    v_cvt_pk_bf16_f32 v157, v2, 0
    v_mov_b32 v158, 0
    v_mov_b32 v159, 0
    s_barrier
    ds_read_b64_tr_b16 v[32:33], v8 offset:0
    ds_read_b64_tr_b16 v[34:35], v8 offset:512
    ds_read_b64_tr_b16 v[36:37], v9 offset:0
    ds_read_b64_tr_b16 v[38:39], v9 offset:512
    ds_read_b64_tr_b16 v[40:41], v8 offset:2048
    ds_read_b64_tr_b16 v[42:43], v8 offset:2560
    ds_read_b64_tr_b16 v[44:45], v9 offset:2048
    ds_read_b64_tr_b16 v[46:47], v9 offset:2560
    s_waitcnt lgkmcnt(6)
    v_mfma_f32_32x32x16_bf16 v[64:79], v[160:163], v[32:35], 0
    ds_read_b64_tr_b16 v[48:49], v8 offset:4096
    ds_read_b64_tr_b16 v[50:51], v8 offset:4608
    s_waitcnt lgkmcnt(6)
    v_mfma_f32_32x32x16_bf16 v[80:95], v[160:163], v[36:39], 0
    ds_read_b64_tr_b16 v[52:53], v9 offset:4096
    ds_read_b64_tr_b16 v[54:55], v9 offset:4608
    s_add_u32 m0, s28, 4294868992
    s_add_u32 s24, s23, 196608
    buffer_load_dwordx4 v155, s[68:71], s24 offen offset:0 lds
    s_waitcnt lgkmcnt(6)
    v_mfma_f32_32x32x16_bf16 v[64:79], v[164:167], v[40:43], v[64:79]
    ds_read_b64_tr_b16 v[32:33], v8 offset:6144
    ds_read_b64_tr_b16 v[34:35], v8 offset:6656
    s_waitcnt lgkmcnt(6)
    v_mfma_f32_32x32x16_bf16 v[80:95], v[164:167], v[44:47], v[80:95]
    ds_read_b64_tr_b16 v[36:37], v9 offset:6144
    ds_read_b64_tr_b16 v[38:39], v9 offset:6656
    s_add_u32 s24, s23, 203776
    buffer_load_dwordx4 v155, s[68:71], s24 offen offset:1024 lds
    s_waitcnt lgkmcnt(6)
    v_mfma_f32_32x32x16_bf16 v[64:79], v[168:171], v[48:51], v[64:79]
    s_barrier
    ds_read_b64_tr_b16 v[40:41], v8 offset:8192
    ds_read_b64_tr_b16 v[42:43], v8 offset:8704
    s_waitcnt lgkmcnt(6)
    v_mfma_f32_32x32x16_bf16 v[80:95], v[168:171], v[52:55], v[80:95]
    ds_read_b64_tr_b16 v[44:45], v9 offset:8192
    ds_read_b64_tr_b16 v[46:47], v9 offset:8704
    s_add_u32 s24, s23, 210944
    buffer_load_dwordx4 v155, s[68:71], s24 offen offset:2048 lds
    s_waitcnt lgkmcnt(6)
    v_mfma_f32_32x32x16_bf16 v[64:79], v[172:175], v[32:35], v[64:79]
    ds_read_b64_tr_b16 v[48:49], v8 offset:10240
    ds_read_b64_tr_b16 v[50:51], v8 offset:10752
    s_waitcnt lgkmcnt(6)
    v_mfma_f32_32x32x16_bf16 v[80:95], v[172:175], v[36:39], v[80:95]
    ds_read_b64_tr_b16 v[52:53], v9 offset:10240
    ds_read_b64_tr_b16 v[54:55], v9 offset:10752
    s_add_u32 s24, s23, 218112
    buffer_load_dwordx4 v155, s[68:71], s24 offen offset:3072 lds
    s_waitcnt lgkmcnt(6)
    v_mfma_f32_32x32x16_bf16 v[64:79], v[176:179], v[40:43], v[64:79]
    ds_read_b64_tr_b16 v[32:33], v8 offset:12288
    ds_read_b64_tr_b16 v[34:35], v8 offset:12800
    s_waitcnt lgkmcnt(6)
    v_mfma_f32_32x32x16_bf16 v[80:95], v[176:179], v[44:47], v[80:95]
    ds_read_b64_tr_b16 v[36:37], v9 offset:12288
    ds_read_b64_tr_b16 v[38:39], v9 offset:12800
    s_add_u32 m0, s28, 4294873088
    s_add_u32 s24, s23, 229376
    buffer_load_dwordx4 v155, s[68:71], s24 offen offset:0 lds
    s_waitcnt lgkmcnt(6)
    v_mfma_f32_32x32x16_bf16 v[64:79], v[180:183], v[48:51], v[64:79]
    ds_read_b64_tr_b16 v[40:41], v8 offset:14336
    ds_read_b64_tr_b16 v[42:43], v8 offset:14848
    s_waitcnt lgkmcnt(6)
    v_mfma_f32_32x32x16_bf16 v[80:95], v[180:183], v[52:55], v[80:95]
    ds_read_b64_tr_b16 v[44:45], v9 offset:14336
    ds_read_b64_tr_b16 v[46:47], v9 offset:14848
    s_add_u32 s24, s23, 236544
    buffer_load_dwordx4 v155, s[68:71], s24 offen offset:1024 lds
    s_waitcnt lgkmcnt(6)
    v_mfma_f32_32x32x16_bf16 v[64:79], v[184:187], v[32:35], v[64:79]
    s_waitcnt vmcnt(15)
    s_barrier
    ds_read_b64_tr_b16 v[48:49], v8 offset:16384
    ds_read_b64_tr_b16 v[50:51], v8 offset:16896
    s_waitcnt lgkmcnt(6)
    v_mfma_f32_32x32x16_bf16 v[80:95], v[184:187], v[36:39], v[80:95]
    ds_read_b64_tr_b16 v[52:53], v9 offset:16384
    ds_read_b64_tr_b16 v[54:55], v9 offset:16896
    s_add_u32 s24, s23, 243712
    buffer_load_dwordx4 v155, s[68:71], s24 offen offset:2048 lds
    s_waitcnt lgkmcnt(6)
    v_mfma_f32_32x32x16_bf16 v[64:79], v[188:191], v[40:43], v[64:79]
    ds_read_b64_tr_b16 v[32:33], v8 offset:18432
    ds_read_b64_tr_b16 v[34:35], v8 offset:18944
    s_waitcnt lgkmcnt(6)
    v_mfma_f32_32x32x16_bf16 v[80:95], v[188:191], v[44:47], v[80:95]
    ds_read_b64_tr_b16 v[36:37], v9 offset:18432
    ds_read_b64_tr_b16 v[38:39], v9 offset:18944
    s_add_u32 s24, s23, 250880
    buffer_load_dwordx4 v155, s[68:71], s24 offen offset:3072 lds
    s_waitcnt lgkmcnt(6)
    v_mfma_f32_32x32x16_bf16 v[64:79], v[192:195], v[48:51], v[64:79]
    ds_read_b64_tr_b16 v[40:41], v8 offset:20480
    ds_read_b64_tr_b16 v[42:43], v8 offset:20992
    s_waitcnt lgkmcnt(6)
    v_mfma_f32_32x32x16_bf16 v[80:95], v[192:195], v[52:55], v[80:95]
    ds_read_b64_tr_b16 v[44:45], v9 offset:20480
    ds_read_b64_tr_b16 v[46:47], v9 offset:20992
    s_add_u32 m0, s28, 4294877184
    s_add_u32 s24, s23, 262144
    buffer_load_dwordx4 v155, s[68:71], s24 offen offset:0 lds
    s_waitcnt lgkmcnt(6)
    v_mfma_f32_32x32x16_bf16 v[64:79], v[196:199], v[32:35], v[64:79]
    ds_read_b64_tr_b16 v[48:49], v8 offset:22528
    ds_read_b64_tr_b16 v[50:51], v8 offset:23040
    s_waitcnt lgkmcnt(6)
    v_mfma_f32_32x32x16_bf16 v[80:95], v[196:199], v[36:39], v[80:95]
    ds_read_b64_tr_b16 v[52:53], v9 offset:22528
    ds_read_b64_tr_b16 v[54:55], v9 offset:23040
    s_add_u32 s24, s23, 269312
    buffer_load_dwordx4 v155, s[68:71], s24 offen offset:1024 lds
    s_waitcnt lgkmcnt(6)
    v_mfma_f32_32x32x16_bf16 v[64:79], v[200:203], v[40:43], v[64:79]
    ds_read_b64_tr_b16 v[32:33], v8 offset:24576
    ds_read_b64_tr_b16 v[34:35], v8 offset:25088
    s_waitcnt lgkmcnt(6)
    v_mfma_f32_32x32x16_bf16 v[80:95], v[200:203], v[44:47], v[80:95]
    ds_read_b64_tr_b16 v[36:37], v9 offset:24576
    ds_read_b64_tr_b16 v[38:39], v9 offset:25088
    s_add_u32 s24, s23, 276480
    buffer_load_dwordx4 v155, s[68:71], s24 offen offset:2048 lds
    s_waitcnt lgkmcnt(6)
    v_mfma_f32_32x32x16_bf16 v[64:79], v[204:207], v[48:51], v[64:79]
    ds_read_b64_tr_b16 v[40:41], v8 offset:26624
    ds_read_b64_tr_b16 v[42:43], v8 offset:27136
    s_waitcnt lgkmcnt(6)
    v_mfma_f32_32x32x16_bf16 v[80:95], v[204:207], v[52:55], v[80:95]
    ds_read_b64_tr_b16 v[44:45], v9 offset:26624
    ds_read_b64_tr_b16 v[46:47], v9 offset:27136
    s_add_u32 s24, s23, 283648
    buffer_load_dwordx4 v155, s[68:71], s24 offen offset:3072 lds
    s_waitcnt lgkmcnt(6)
    v_mfma_f32_32x32x16_bf16 v[64:79], v[208:211], v[32:35], v[64:79]
    ds_read_b64_tr_b16 v[48:49], v8 offset:28672
    ds_read_b64_tr_b16 v[50:51], v8 offset:29184
    s_waitcnt lgkmcnt(6)
    v_mfma_f32_32x32x16_bf16 v[80:95], v[208:211], v[36:39], v[80:95]
    ds_read_b64_tr_b16 v[52:53], v9 offset:28672
    ds_read_b64_tr_b16 v[54:55], v9 offset:29184
    s_add_u32 m0, s28, 4294881280
    s_add_u32 s24, s23, 294912
    buffer_load_dwordx4 v155, s[68:71], s24 offen offset:0 lds
    s_waitcnt lgkmcnt(6)
    v_mfma_f32_32x32x16_bf16 v[64:79], v[212:215], v[40:43], v[64:79]
    ds_read_b64_tr_b16 v[32:33], v8 offset:30720
    ds_read_b64_tr_b16 v[34:35], v8 offset:31232
    s_waitcnt lgkmcnt(6)
    v_mfma_f32_32x32x16_bf16 v[80:95], v[212:215], v[44:47], v[80:95]
    ds_read_b64_tr_b16 v[36:37], v9 offset:30720
    ds_read_b64_tr_b16 v[38:39], v9 offset:31232
    s_add_u32 s24, s23, 302080
    buffer_load_dwordx4 v155, s[68:71], s24 offen offset:1024 lds
    s_waitcnt lgkmcnt(6)
    v_mfma_f32_32x32x16_bf16 v[64:79], v[216:219], v[48:51], v[64:79]
    s_waitcnt vmcnt(15)
    s_barrier
    ds_read_b64_tr_b16 v[40:41], v8 offset:32768
    ds_read_b64_tr_b16 v[42:43], v8 offset:33280
    s_waitcnt lgkmcnt(6)
    v_mfma_f32_32x32x16_bf16 v[80:95], v[216:219], v[52:55], v[80:95]
    ds_read_b64_tr_b16 v[44:45], v9 offset:32768
    ds_read_b64_tr_b16 v[46:47], v9 offset:33280
    s_add_u32 s24, s23, 309248
    buffer_load_dwordx4 v155, s[68:71], s24 offen offset:2048 lds
    s_waitcnt lgkmcnt(6)
    v_mfma_f32_32x32x16_bf16 v[64:79], v[220:223], v[32:35], v[64:79]
    ds_read_b64_tr_b16 v[48:49], v8 offset:34816
    ds_read_b64_tr_b16 v[50:51], v8 offset:35328
    s_waitcnt lgkmcnt(6)
    v_mfma_f32_32x32x16_bf16 v[80:95], v[220:223], v[36:39], v[80:95]
    ds_read_b64_tr_b16 v[52:53], v9 offset:34816
    ds_read_b64_tr_b16 v[54:55], v9 offset:35328
    s_add_u32 s24, s23, 316416
    buffer_load_dwordx4 v155, s[68:71], s24 offen offset:3072 lds
    s_waitcnt lgkmcnt(6)
    v_mfma_f32_32x32x16_bf16 v[64:79], v[224:227], v[40:43], v[64:79]
    ds_read_b64_tr_b16 v[32:33], v8 offset:36864
    ds_read_b64_tr_b16 v[34:35], v8 offset:37376
    s_waitcnt lgkmcnt(6)
    v_mfma_f32_32x32x16_bf16 v[80:95], v[224:227], v[44:47], v[80:95]
    ds_read_b64_tr_b16 v[36:37], v9 offset:36864
    ds_read_b64_tr_b16 v[38:39], v9 offset:37376
    s_waitcnt lgkmcnt(6)
    v_mfma_f32_32x32x16_bf16 v[64:79], v[228:231], v[48:51], v[64:79]
    ds_read_b64_tr_b16 v[40:41], v8 offset:38912
    ds_read_b64_tr_b16 v[42:43], v8 offset:39424
    s_waitcnt lgkmcnt(6)
    v_mfma_f32_32x32x16_bf16 v[80:95], v[228:231], v[52:55], v[80:95]
    ds_read_b64_tr_b16 v[44:45], v9 offset:38912
    ds_read_b64_tr_b16 v[46:47], v9 offset:39424
    s_waitcnt lgkmcnt(6)
    v_mfma_f32_32x32x16_bf16 v[64:79], v[232:235], v[32:35], v[64:79]
    ds_read_b64_tr_b16 v[48:49], v8 offset:40960
    ds_read_b64_tr_b16 v[50:51], v8 offset:41472
    s_waitcnt lgkmcnt(6)
    v_mfma_f32_32x32x16_bf16 v[80:95], v[232:235], v[36:39], v[80:95]
    ds_read_b64_tr_b16 v[52:53], v9 offset:40960
    ds_read_b64_tr_b16 v[54:55], v9 offset:41472
    s_waitcnt lgkmcnt(6)
    v_mfma_f32_32x32x16_bf16 v[64:79], v[236:239], v[40:43], v[64:79]
    ds_read_b64_tr_b16 v[32:33], v8 offset:43008
    ds_read_b64_tr_b16 v[34:35], v8 offset:43520
    s_waitcnt lgkmcnt(6)
    v_mfma_f32_32x32x16_bf16 v[80:95], v[236:239], v[44:47], v[80:95]
    ds_read_b64_tr_b16 v[36:37], v9 offset:43008
    ds_read_b64_tr_b16 v[38:39], v9 offset:43520
    s_waitcnt lgkmcnt(6)
    v_mfma_f32_32x32x16_bf16 v[64:79], v[240:243], v[48:51], v[64:79]
    ds_read_b64_tr_b16 v[40:41], v8 offset:45056
    ds_read_b64_tr_b16 v[42:43], v8 offset:45568
    s_waitcnt lgkmcnt(6)
    v_mfma_f32_32x32x16_bf16 v[80:95], v[240:243], v[52:55], v[80:95]
    ds_read_b64_tr_b16 v[44:45], v9 offset:45056
    ds_read_b64_tr_b16 v[46:47], v9 offset:45568
    s_waitcnt vmcnt(14)
    ds_read_b64_tr_b16 a[96:97], v29 offset:0
    ds_read_b64_tr_b16 a[100:101], v154 offset:0
    ds_read_b64_tr_b16 a[98:99], v29 offset:1024
    ds_read_b64_tr_b16 a[102:103], v154 offset:1024
    s_waitcnt lgkmcnt(6)
    v_mfma_f32_32x32x16_bf16 v[64:79], v[244:247], v[32:35], v[64:79]
    ds_read_b64_tr_b16 v[48:49], v8 offset:47104
    ds_read_b64_tr_b16 v[50:51], v8 offset:47616
    s_waitcnt lgkmcnt(6)
    v_mfma_f32_32x32x16_bf16 v[80:95], v[244:247], v[36:39], v[80:95]
    ds_read_b64_tr_b16 v[52:53], v9 offset:47104
    ds_read_b64_tr_b16 v[54:55], v9 offset:47616
    s_waitcnt vmcnt(12)
    ds_read_b64_tr_b16 a[104:105], v29 offset:2048
    ds_read_b64_tr_b16 a[108:109], v154 offset:2048
    ds_read_b64_tr_b16 a[106:107], v29 offset:3072
    ds_read_b64_tr_b16 a[110:111], v154 offset:3072
    global_load_dwordx4 v[56:59], v12, s[8:9] offset:0 sc1
    global_load_dwordx4 v[60:63], v12, s[8:9] offset:512 sc1
    s_waitcnt lgkmcnt(6)
    v_mfma_f32_32x32x16_bf16 v[64:79], v[248:251], v[40:43], v[64:79]
    ds_read_b64_tr_b16 v[32:33], v8 offset:49152
    ds_read_b64_tr_b16 v[34:35], v8 offset:49664
    s_waitcnt lgkmcnt(6)
    v_mfma_f32_32x32x16_bf16 v[80:95], v[248:251], v[44:47], v[80:95]
    ds_read_b64_tr_b16 v[36:37], v9 offset:49152
    ds_read_b64_tr_b16 v[38:39], v9 offset:49664
    s_waitcnt vmcnt(12)
    ds_read_b64_tr_b16 a[112:113], v29 offset:4096
    ds_read_b64_tr_b16 a[116:117], v154 offset:4096
    ds_read_b64_tr_b16 a[114:115], v29 offset:5120
    ds_read_b64_tr_b16 a[118:119], v154 offset:5120
    s_waitcnt lgkmcnt(6)
    v_mfma_f32_32x32x16_bf16 v[64:79], v[252:255], v[48:51], v[64:79]
    ds_read_b64_tr_b16 v[40:41], v8 offset:51200
    ds_read_b64_tr_b16 v[42:43], v8 offset:51712
    s_waitcnt lgkmcnt(6)
    v_mfma_f32_32x32x16_bf16 v[80:95], v[252:255], v[52:55], v[80:95]
    ds_read_b64_tr_b16 v[44:45], v9 offset:51200
    ds_read_b64_tr_b16 v[46:47], v9 offset:51712
    s_waitcnt vmcnt(10)
    ds_read_b64_tr_b16 a[120:121], v29 offset:6144
    ds_read_b64_tr_b16 a[124:125], v154 offset:6144
    ds_read_b64_tr_b16 a[122:123], v29 offset:7168
    ds_read_b64_tr_b16 a[126:127], v154 offset:7168
    s_waitcnt lgkmcnt(6)
    v_mfma_f32_32x32x16_bf16 v[64:79], a[224:227], v[32:35], v[64:79]
    ds_read_b64_tr_b16 v[48:49], v8 offset:53248
    ds_read_b64_tr_b16 v[50:51], v8 offset:53760
    s_waitcnt lgkmcnt(6)
    v_mfma_f32_32x32x16_bf16 v[80:95], a[224:227], v[36:39], v[80:95]
    ds_read_b64_tr_b16 v[52:53], v9 offset:53248
    ds_read_b64_tr_b16 v[54:55], v9 offset:53760
    s_waitcnt vmcnt(9)
    ds_read_b64_tr_b16 a[128:129], v29 offset:8192
    ds_read_b64_tr_b16 a[132:133], v154 offset:8192
    s_waitcnt vmcnt(8)
    ds_read_b64_tr_b16 a[130:131], v29 offset:9216
    ds_read_b64_tr_b16 a[134:135], v154 offset:9216
    s_waitcnt lgkmcnt(6)
    v_mfma_f32_32x32x16_bf16 v[64:79], a[228:231], v[40:43], v[64:79]
    ds_read_b64_tr_b16 v[32:33], v8 offset:55296
    ds_read_b64_tr_b16 v[34:35], v8 offset:55808
    s_waitcnt lgkmcnt(6)
    v_mfma_f32_32x32x16_bf16 v[80:95], a[228:231], v[44:47], v[80:95]
    ds_read_b64_tr_b16 v[36:37], v9 offset:55296
    ds_read_b64_tr_b16 v[38:39], v9 offset:55808
    s_waitcnt vmcnt(7)
    ds_read_b64_tr_b16 a[136:137], v29 offset:10240
    ds_read_b64_tr_b16 a[140:141], v154 offset:10240
    s_waitcnt vmcnt(6)
    ds_read_b64_tr_b16 a[138:139], v29 offset:11264
    ds_read_b64_tr_b16 a[142:143], v154 offset:11264
    global_load_dword v31, v13, s[8:9] offset:0 sc1
    s_waitcnt lgkmcnt(6)
    v_mfma_f32_32x32x16_bf16 v[64:79], a[232:235], v[48:51], v[64:79]
    ds_read_b64_tr_b16 v[40:41], v8 offset:57344
    ds_read_b64_tr_b16 v[42:43], v8 offset:57856
    s_waitcnt lgkmcnt(6)
    v_mfma_f32_32x32x16_bf16 v[80:95], a[232:235], v[52:55], v[80:95]
    ds_read_b64_tr_b16 v[44:45], v9 offset:57344
    ds_read_b64_tr_b16 v[46:47], v9 offset:57856
    s_waitcnt vmcnt(6)
    ds_read_b64_tr_b16 a[144:145], v29 offset:12288
    ds_read_b64_tr_b16 a[148:149], v154 offset:12288
    s_waitcnt vmcnt(5)
    ds_read_b64_tr_b16 a[146:147], v29 offset:13312
    ds_read_b64_tr_b16 a[150:151], v154 offset:13312
    s_waitcnt lgkmcnt(6)
    v_mfma_f32_32x32x16_bf16 v[64:79], a[236:239], v[32:35], v[64:79]
    ds_read_b64_tr_b16 v[48:49], v8 offset:59392
    ds_read_b64_tr_b16 v[50:51], v8 offset:59904
    s_waitcnt lgkmcnt(6)
    v_mfma_f32_32x32x16_bf16 v[80:95], a[236:239], v[36:39], v[80:95]
    ds_read_b64_tr_b16 v[52:53], v9 offset:59392
    ds_read_b64_tr_b16 v[54:55], v9 offset:59904
    s_waitcnt vmcnt(4)
    ds_read_b64_tr_b16 a[152:153], v29 offset:14336
    ds_read_b64_tr_b16 a[156:157], v154 offset:14336
    s_waitcnt vmcnt(3)
    ds_read_b64_tr_b16 a[154:155], v29 offset:15360
    ds_read_b64_tr_b16 a[158:159], v154 offset:15360
    s_waitcnt lgkmcnt(6)
    v_mfma_f32_32x32x16_bf16 v[64:79], a[240:243], v[40:43], v[64:79]
    ds_read_b64_tr_b16 v[32:33], v8 offset:61440
    ds_read_b64_tr_b16 v[34:35], v8 offset:61952
    s_waitcnt lgkmcnt(6)
    v_mfma_f32_32x32x16_bf16 v[80:95], a[240:243], v[44:47], v[80:95]
    ds_read_b64_tr_b16 v[36:37], v9 offset:61440
    ds_read_b64_tr_b16 v[38:39], v9 offset:61952
    s_waitcnt vmcnt(1)
ffn_chk0_0:
    v_min_u32 v2, v57, v59
    v_min3_u32 v2, v2, v61, v63
    v_cmp_eq_u32 vcc, 0, v2
    s_nop 1
    s_cbranch_vccnz ffn_retry0_0
    v_add_f32 v16, v56, v58
    v_add_f32 v18, v60, v62
    v_add_f32 v17, v57, v59
    v_add_f32 v19, v61, v63
    v_mul_f32 v16, s26, v16
    v_mul_f32 v18, s26, v18
    s_waitcnt lgkmcnt(6)
    v_mfma_f32_32x32x16_bf16 v[64:79], a[244:247], v[48:51], v[64:79]
    ds_read_b64_tr_b16 v[40:41], v8 offset:63488
    ds_read_b64_tr_b16 v[42:43], v8 offset:64000
    v_mul_f32 v17, s26, v17
    v_mul_f32 v19, s26, v19
    v_cvt_pk_bf16_f32 v56, -v16, -v16
    v_cvt_pk_bf16_f32 v60, -v18, -v18
    v_mov_b32 v58, 0
    v_mov_b32 v59, 0
    s_waitcnt lgkmcnt(6)
    v_mfma_f32_32x32x16_bf16 v[80:95], a[244:247], v[52:55], v[80:95]
    ds_read_b64_tr_b16 v[44:45], v9 offset:63488
    ds_read_b64_tr_b16 v[46:47], v9 offset:64000
    v_mov_b32 v57, v56
    v_mov_b32 v61, v60
    v_mov_b32 v62, 0
    v_mov_b32 v63, 0
    v_fma_f32 v17, -v16, v16, v17
    v_fma_f32 v19, -v18, v18, v19
    s_waitcnt lgkmcnt(6)
    v_mfma_f32_32x32x16_bf16 v[64:79], a[248:251], v[32:35], v[64:79]
    v_max_f32 v17, 0, v17
    v_max_f32 v19, 0, v19
    v_cvt_pk_bf16_f32 v17, 0, v17
    v_cvt_pk_bf16_f32 v19, 0, v19
    v_add_f32 v17, s27, v17
    v_add_f32 v19, s27, v19
    s_waitcnt lgkmcnt(4)
    v_mfma_f32_32x32x16_bf16 v[80:95], a[248:251], v[36:39], v[80:95]
    v_cvt_pk_bf16_f32 v17, 0, v17
    v_cvt_pk_bf16_f32 v19, 0, v19
    v_sqrt_f32 v17, v17
    v_sqrt_f32 v19, v19
    v_cvt_pk_bf16_f32 v17, 0, v17
    v_cvt_pk_bf16_f32 v19, 0, v19
    s_waitcnt lgkmcnt(2)
    v_mfma_f32_32x32x16_bf16 v[64:79], a[252:255], v[40:43], v[64:79]
    v_mfma_f32_32x32x16_bf16 v[64:79], v[156:159], v[56:59], v[64:79]
    v_rcp_f32 v16, v17
    v_rcp_f32 v18, v19
    v_mul_f32 v16, s31, v16
    v_mul_f32 v18, s31, v18
    s_waitcnt lgkmcnt(0)
    v_mfma_f32_32x32x16_bf16 v[80:95], a[252:255], v[44:47], v[80:95]
    v_mfma_f32_32x32x16_bf16 v[80:95], v[156:159], v[60:63], v[80:95]
    ds_read_b64_tr_b16 v[20:21], v11 offset:0
    ds_read_b64_tr_b16 v[22:23], v11 offset:1024
    s_waitcnt vmcnt(0)
    v_cmp_gt_u32 vcc, 2, v31
    s_nop 1
    s_cbranch_vccnz pollXL_0
pollXL_0_ok:
    v_add_u32 v29, 98304, v29
    v_add_u32 v154, 98304, v154
    s_waitcnt lgkmcnt(0)
    s_barrier
    s_add_u32 m0, s21, 0
    s_add_u32 s24, s21, 1048576
    buffer_load_dwordx4 v4, s[16:19], s24 offen sc1 lds
    s_add_u32 m0, s21, 4096
    s_add_u32 s24, s21, 1052672
    buffer_load_dwordx4 v4, s[16:19], s24 offen sc1 lds
    s_add_u32 m0, s21, 8192
    s_add_u32 s24, s21, 1056768
    buffer_load_dwordx4 v4, s[16:19], s24 offen sc1 lds
    v_pk_mul_f32 v[48:49], v[64:65], v[16:17] op_sel:[0,0] op_sel_hi:[1,0]
    v_pk_mul_f32 v[50:51], v[66:67], v[16:17] op_sel:[0,0] op_sel_hi:[1,0]
    v_pk_mul_f32 v[52:53], v[68:69], v[16:17] op_sel:[0,0] op_sel_hi:[1,0]
    v_pk_mul_f32 v[54:55], v[70:71], v[16:17] op_sel:[0,0] op_sel_hi:[1,0]
    v_pk_mul_f32 v[56:57], v[72:73], v[16:17] op_sel:[0,0] op_sel_hi:[1,0]
    v_pk_mul_f32 v[58:59], v[74:75], v[16:17] op_sel:[0,0] op_sel_hi:[1,0]
    v_pk_mul_f32 v[60:61], v[76:77], v[16:17] op_sel:[0,0] op_sel_hi:[1,0]
    v_pk_mul_f32 v[62:63], v[78:79], v[16:17] op_sel:[0,0] op_sel_hi:[1,0]
    v_exp_f32 v48, v48
    v_exp_f32 v49, v49
    v_exp_f32 v50, v50
    v_exp_f32 v51, v51
    v_exp_f32 v52, v52
    v_exp_f32 v53, v53
    s_add_u32 m0, s21, 12288
    s_add_u32 s24, s21, 1060864
    buffer_load_dwordx4 v4, s[16:19], s24 offen sc1 lds
    v_exp_f32 v54, v54
    v_exp_f32 v55, v55
    v_exp_f32 v56, v56
    v_exp_f32 v57, v57
    v_exp_f32 v58, v58
    v_exp_f32 v59, v59
    v_exp_f32 v60, v60
    v_exp_f32 v61, v61
    v_exp_f32 v62, v62
    v_exp_f32 v63, v63
    v_pk_fma_f32 v[48:49], v[48:49], v[16:17], v[16:17] op_sel:[0,1,1] op_sel_hi:[1,1,1]
    v_pk_fma_f32 v[50:51], v[50:51], v[16:17], v[16:17] op_sel:[0,1,1] op_sel_hi:[1,1,1]
    v_pk_fma_f32 v[52:53], v[52:53], v[16:17], v[16:17] op_sel:[0,1,1] op_sel_hi:[1,1,1]
    v_pk_fma_f32 v[54:55], v[54:55], v[16:17], v[16:17] op_sel:[0,1,1] op_sel_hi:[1,1,1]
    s_add_u32 m0, s21, 16384
    s_add_u32 s24, s21, 1064960
    buffer_load_dwordx4 v4, s[16:19], s24 offen sc1 lds
    v_pk_fma_f32 v[56:57], v[56:57], v[16:17], v[16:17] op_sel:[0,1,1] op_sel_hi:[1,1,1]
    v_pk_fma_f32 v[58:59], v[58:59], v[16:17], v[16:17] op_sel:[0,1,1] op_sel_hi:[1,1,1]
    v_pk_fma_f32 v[60:61], v[60:61], v[16:17], v[16:17] op_sel:[0,1,1] op_sel_hi:[1,1,1]
    v_pk_fma_f32 v[62:63], v[62:63], v[16:17], v[16:17] op_sel:[0,1,1] op_sel_hi:[1,1,1]
    v_rcp_f32 v48, v48
    v_rcp_f32 v49, v49
    v_rcp_f32 v50, v50
    v_rcp_f32 v51, v51
    v_rcp_f32 v52, v52
    v_rcp_f32 v53, v53
    v_rcp_f32 v54, v54
    v_rcp_f32 v55, v55
    v_rcp_f32 v56, v56
    v_rcp_f32 v57, v57
    s_add_u32 m0, s21, 20480
    s_add_u32 s24, s21, 1069056
    buffer_load_dwordx4 v4, s[16:19], s24 offen sc1 lds
    v_rcp_f32 v58, v58
    v_rcp_f32 v59, v59
    v_rcp_f32 v60, v60
    v_rcp_f32 v61, v61
    v_rcp_f32 v62, v62
    v_rcp_f32 v63, v63
    v_pk_mul_f32 v[64:65], v[64:65], v[48:49]
    v_pk_mul_f32 v[66:67], v[66:67], v[50:51]
    v_pk_mul_f32 v[68:69], v[68:69], v[52:53]
    v_pk_mul_f32 v[70:71], v[70:71], v[54:55]
    v_pk_mul_f32 v[72:73], v[72:73], v[56:57]
    v_pk_mul_f32 v[74:75], v[74:75], v[58:59]
    v_pk_mul_f32 v[76:77], v[76:77], v[60:61]
    v_pk_mul_f32 v[78:79], v[78:79], v[62:63]
    s_add_u32 m0, s21, 24576
    s_add_u32 s24, s21, 1073152
    buffer_load_dwordx4 v4, s[16:19], s24 offen sc1 lds
    v_cvt_pk_bf16_f32 v64, v64, v65
    v_cvt_pk_bf16_f32 v65, v66, v67
    v_cvt_pk_bf16_f32 v66, v68, v69
    v_cvt_pk_bf16_f32 v67, v70, v71
    v_cvt_pk_bf16_f32 v68, v72, v73
    v_cvt_pk_bf16_f32 v69, v74, v75
    v_cvt_pk_bf16_f32 v70, v76, v77
    v_cvt_pk_bf16_f32 v71, v78, v79
    global_store_dwordx4 v5, v[64:67], s[40:41] sc1
    global_store_dwordx4 v5, v[68:71], s[40:41] offset:1024 sc1
    v_pk_mul_f32 v[48:49], v[80:81], v[18:19] op_sel:[0,0] op_sel_hi:[1,0]
    v_pk_mul_f32 v[50:51], v[82:83], v[18:19] op_sel:[0,0] op_sel_hi:[1,0]
    v_pk_mul_f32 v[52:53], v[84:85], v[18:19] op_sel:[0,0] op_sel_hi:[1,0]
    v_pk_mul_f32 v[54:55], v[86:87], v[18:19] op_sel:[0,0] op_sel_hi:[1,0]
    s_add_u32 m0, s21, 28672
    s_add_u32 s24, s21, 1077248
    buffer_load_dwordx4 v4, s[16:19], s24 offen sc1 lds
    v_pk_mul_f32 v[56:57], v[88:89], v[18:19] op_sel:[0,0] op_sel_hi:[1,0]
    v_pk_mul_f32 v[58:59], v[90:91], v[18:19] op_sel:[0,0] op_sel_hi:[1,0]
    v_pk_mul_f32 v[60:61], v[92:93], v[18:19] op_sel:[0,0] op_sel_hi:[1,0]
    v_pk_mul_f32 v[62:63], v[94:95], v[18:19] op_sel:[0,0] op_sel_hi:[1,0]
    v_exp_f32 v48, v48
    v_exp_f32 v49, v49
    v_exp_f32 v50, v50
    v_exp_f32 v51, v51
    v_exp_f32 v52, v52
    v_exp_f32 v53, v53
    v_exp_f32 v54, v54
    v_exp_f32 v55, v55
    v_exp_f32 v56, v56
    v_exp_f32 v57, v57
    s_xor_b32 s21, s21, 0x8000
    s_add_u32 m0, s21, 0
    s_add_u32 s24, s21, 1048576
    buffer_load_dwordx4 v4, s[16:19], s24 offen sc1 lds
    v_exp_f32 v58, v58
    v_exp_f32 v59, v59
    v_exp_f32 v60, v60
    v_exp_f32 v61, v61
    v_exp_f32 v62, v62
    v_exp_f32 v63, v63
    v_pk_fma_f32 v[48:49], v[48:49], v[18:19], v[18:19] op_sel:[0,1,1] op_sel_hi:[1,1,1]
    v_pk_fma_f32 v[50:51], v[50:51], v[18:19], v[18:19] op_sel:[0,1,1] op_sel_hi:[1,1,1]
    v_pk_fma_f32 v[52:53], v[52:53], v[18:19], v[18:19] op_sel:[0,1,1] op_sel_hi:[1,1,1]
    v_pk_fma_f32 v[54:55], v[54:55], v[18:19], v[18:19] op_sel:[0,1,1] op_sel_hi:[1,1,1]
    v_pk_fma_f32 v[56:57], v[56:57], v[18:19], v[18:19] op_sel:[0,1,1] op_sel_hi:[1,1,1]
    v_pk_fma_f32 v[58:59], v[58:59], v[18:19], v[18:19] op_sel:[0,1,1] op_sel_hi:[1,1,1]
    v_pk_fma_f32 v[60:61], v[60:61], v[18:19], v[18:19] op_sel:[0,1,1] op_sel_hi:[1,1,1]
    v_pk_fma_f32 v[62:63], v[62:63], v[18:19], v[18:19] op_sel:[0,1,1] op_sel_hi:[1,1,1]
    s_add_u32 m0, s21, 4096
    s_add_u32 s24, s21, 1052672
    buffer_load_dwordx4 v4, s[16:19], s24 offen sc1 lds
    v_rcp_f32 v48, v48
    v_rcp_f32 v49, v49
    v_rcp_f32 v50, v50
    v_rcp_f32 v51, v51
    v_rcp_f32 v52, v52
    v_rcp_f32 v53, v53
    v_rcp_f32 v54, v54
    v_rcp_f32 v55, v55
    v_rcp_f32 v56, v56
    v_rcp_f32 v57, v57
    v_rcp_f32 v58, v58
    v_rcp_f32 v59, v59
    v_rcp_f32 v60, v60
    v_rcp_f32 v61, v61
    v_rcp_f32 v62, v62
    v_rcp_f32 v63, v63
    v_pk_mul_f32 v[80:81], v[80:81], v[48:49]
    v_pk_mul_f32 v[82:83], v[82:83], v[50:51]
    v_pk_mul_f32 v[84:85], v[84:85], v[52:53]
    v_pk_mul_f32 v[86:87], v[86:87], v[54:55]
    v_pk_mul_f32 v[88:89], v[88:89], v[56:57]
    v_pk_mul_f32 v[90:91], v[90:91], v[58:59]
    v_pk_mul_f32 v[92:93], v[92:93], v[60:61]
    v_pk_mul_f32 v[94:95], v[94:95], v[62:63]
    v_cvt_pk_bf16_f32 v80, v80, v81
    v_cvt_pk_bf16_f32 v81, v82, v83
    v_cvt_pk_bf16_f32 v82, v84, v85
    v_cvt_pk_bf16_f32 v83, v86, v87
    v_cvt_pk_bf16_f32 v84, v88, v89
    v_cvt_pk_bf16_f32 v85, v90, v91
    v_cvt_pk_bf16_f32 v86, v92, v93
    v_cvt_pk_bf16_f32 v87, v94, v95
    global_store_dwordx4 v6, v[80:83], s[40:41] sc1
    global_store_dwordx4 v6, v[84:87], s[40:41] offset:1024 sc1
    v_add_u32 v12, 0x4000, v12
    v_subrev_u32 v8, 98304, v8
    v_subrev_u32 v9, 98304, v9
    s_add_u32 s40, s40, 3670016
    s_addc_u32 s41, s41, 0
    s_waitcnt vmcnt(10)
    s_barrier
    ds_read_b64_tr_b16 v[32:33], v8 offset:0
    ds_read_b64_tr_b16 v[34:35], v8 offset:512
    ds_read_b64_tr_b16 v[36:37], v9 offset:0
    ds_read_b64_tr_b16 v[38:39], v9 offset:512
    ds_read_b64_tr_b16 v[40:41], v8 offset:2048
    ds_read_b64_tr_b16 v[42:43], v8 offset:2560
    ds_read_b64_tr_b16 v[44:45], v9 offset:2048
    ds_read_b64_tr_b16 v[46:47], v9 offset:2560
    s_waitcnt lgkmcnt(6)
    v_mfma_f32_32x32x16_bf16 v[96:111], v[160:163], v[32:35], 0
    ds_read_b64_tr_b16 v[48:49], v8 offset:4096
    ds_read_b64_tr_b16 v[50:51], v8 offset:4608
    s_waitcnt lgkmcnt(6)
    v_mfma_f32_32x32x16_bf16 v[112:127], v[160:163], v[36:39], 0
    ds_read_b64_tr_b16 v[52:53], v9 offset:4096
    ds_read_b64_tr_b16 v[54:55], v9 offset:4608
    s_add_u32 m0, s21, 8192
    s_add_u32 s24, s21, 1056768
    buffer_load_dwordx4 v4, s[16:19], s24 offen sc1 lds
    s_waitcnt lgkmcnt(6)
    v_mfma_f32_32x32x16_bf16 v[96:111], v[164:167], v[40:43], v[96:111]
    ds_read_b64_tr_b16 v[32:33], v8 offset:6144
    ds_read_b64_tr_b16 v[34:35], v8 offset:6656
    s_waitcnt lgkmcnt(6)
    v_mfma_f32_32x32x16_bf16 v[112:127], v[164:167], v[44:47], v[112:127]
    ds_read_b64_tr_b16 v[36:37], v9 offset:6144
    ds_read_b64_tr_b16 v[38:39], v9 offset:6656
    s_add_u32 m0, s21, 12288
    s_add_u32 s24, s21, 1060864
    buffer_load_dwordx4 v4, s[16:19], s24 offen sc1 lds
    s_waitcnt lgkmcnt(6)
    v_mfma_f32_32x32x16_bf16 v[96:111], v[168:171], v[48:51], v[96:111]
    ds_read_b64_tr_b16 v[40:41], v8 offset:8192
    ds_read_b64_tr_b16 v[42:43], v8 offset:8704
    s_waitcnt lgkmcnt(6)
    v_mfma_f32_32x32x16_bf16 v[112:127], v[168:171], v[52:55], v[112:127]
    ds_read_b64_tr_b16 v[44:45], v9 offset:8192
    ds_read_b64_tr_b16 v[46:47], v9 offset:8704
    s_add_u32 m0, s21, 16384
    s_add_u32 s24, s21, 1064960
    buffer_load_dwordx4 v4, s[16:19], s24 offen sc1 lds
    s_waitcnt lgkmcnt(6)
    v_mfma_f32_32x32x16_bf16 v[96:111], v[172:175], v[32:35], v[96:111]
    ds_read_b64_tr_b16 v[48:49], v8 offset:10240
    ds_read_b64_tr_b16 v[50:51], v8 offset:10752
    s_waitcnt lgkmcnt(6)
    v_mfma_f32_32x32x16_bf16 v[112:127], v[172:175], v[36:39], v[112:127]
    ds_read_b64_tr_b16 v[52:53], v9 offset:10240
    ds_read_b64_tr_b16 v[54:55], v9 offset:10752
    s_add_u32 m0, s21, 20480
    s_add_u32 s24, s21, 1069056
    buffer_load_dwordx4 v4, s[16:19], s24 offen sc1 lds
    s_waitcnt lgkmcnt(6)
    v_mfma_f32_32x32x16_bf16 v[96:111], v[176:179], v[40:43], v[96:111]
    ds_read_b64_tr_b16 v[32:33], v8 offset:12288
    ds_read_b64_tr_b16 v[34:35], v8 offset:12800
    s_waitcnt lgkmcnt(6)
    v_mfma_f32_32x32x16_bf16 v[112:127], v[176:179], v[44:47], v[112:127]
    ds_read_b64_tr_b16 v[36:37], v9 offset:12288
    ds_read_b64_tr_b16 v[38:39], v9 offset:12800
    s_add_u32 m0, s21, 24576
    s_add_u32 s24, s21, 1073152
    buffer_load_dwordx4 v4, s[16:19], s24 offen sc1 lds
    s_waitcnt lgkmcnt(6)
    v_mfma_f32_32x32x16_bf16 v[96:111], v[180:183], v[48:51], v[96:111]
    ds_read_b64_tr_b16 v[40:41], v8 offset:14336
    ds_read_b64_tr_b16 v[42:43], v8 offset:14848
    s_waitcnt lgkmcnt(6)
    v_mfma_f32_32x32x16_bf16 v[112:127], v[180:183], v[52:55], v[112:127]
    ds_read_b64_tr_b16 v[44:45], v9 offset:14336
    ds_read_b64_tr_b16 v[46:47], v9 offset:14848
    s_add_u32 m0, s21, 28672
    s_add_u32 s24, s21, 1077248
    s_xor_b32 s21, s21, 0x8000
    buffer_load_dwordx4 v4, s[16:19], s24 offen sc1 lds
    s_waitcnt lgkmcnt(6)
    v_mfma_f32_32x32x16_bf16 v[96:111], v[184:187], v[32:35], v[96:111]
    s_waitcnt vmcnt(8)
    s_barrier
    ds_read_b64_tr_b16 v[48:49], v8 offset:16384
    ds_read_b64_tr_b16 v[50:51], v8 offset:16896
    s_waitcnt lgkmcnt(6)
    v_mfma_f32_32x32x16_bf16 v[112:127], v[184:187], v[36:39], v[112:127]
    ds_read_b64_tr_b16 v[52:53], v9 offset:16384
    ds_read_b64_tr_b16 v[54:55], v9 offset:16896
    s_add_u32 m0, s28, 0
    s_add_u32 s24, s23, 327680
    buffer_load_dwordx4 v155, s[68:71], s24 offen offset:0 lds
    s_add_u32 s24, s23, 334848
    buffer_load_dwordx4 v155, s[68:71], s24 offen offset:1024 lds
    s_waitcnt lgkmcnt(6)
    v_mfma_f32_32x32x16_bf16 v[96:111], v[188:191], v[40:43], v[96:111]
    ds_read_b64_tr_b16 v[32:33], v8 offset:18432
    ds_read_b64_tr_b16 v[34:35], v8 offset:18944
    s_waitcnt lgkmcnt(6)
    v_mfma_f32_32x32x16_bf16 v[112:127], v[188:191], v[44:47], v[112:127]
    ds_read_b64_tr_b16 v[36:37], v9 offset:18432
    ds_read_b64_tr_b16 v[38:39], v9 offset:18944
    s_add_u32 s24, s23, 342016
    buffer_load_dwordx4 v155, s[68:71], s24 offen offset:2048 lds
    s_add_u32 s24, s23, 349184
    buffer_load_dwordx4 v155, s[68:71], s24 offen offset:3072 lds
    s_waitcnt lgkmcnt(6)
    v_mfma_f32_32x32x16_bf16 v[96:111], v[192:195], v[48:51], v[96:111]
    ds_read_b64_tr_b16 v[40:41], v8 offset:20480
    ds_read_b64_tr_b16 v[42:43], v8 offset:20992
    s_waitcnt lgkmcnt(6)
    v_mfma_f32_32x32x16_bf16 v[112:127], v[192:195], v[52:55], v[112:127]
    ds_read_b64_tr_b16 v[44:45], v9 offset:20480
    ds_read_b64_tr_b16 v[46:47], v9 offset:20992
    s_add_u32 m0, s28, 4096
    s_add_u32 s24, s23, 360448
    buffer_load_dwordx4 v155, s[68:71], s24 offen offset:0 lds
    s_waitcnt lgkmcnt(6)
    v_mfma_f32_32x32x16_bf16 v[96:111], v[196:199], v[32:35], v[96:111]
    ds_read_b64_tr_b16 v[48:49], v8 offset:22528
    ds_read_b64_tr_b16 v[50:51], v8 offset:23040
    s_waitcnt lgkmcnt(6)
    v_mfma_f32_32x32x16_bf16 v[112:127], v[196:199], v[36:39], v[112:127]
    ds_read_b64_tr_b16 v[52:53], v9 offset:22528
    ds_read_b64_tr_b16 v[54:55], v9 offset:23040
    s_add_u32 s24, s23, 367616
    buffer_load_dwordx4 v155, s[68:71], s24 offen offset:1024 lds
    s_add_u32 s24, s23, 374784
    buffer_load_dwordx4 v155, s[68:71], s24 offen offset:2048 lds
    s_waitcnt lgkmcnt(6)
    v_mfma_f32_32x32x16_bf16 v[96:111], v[200:203], v[40:43], v[96:111]
    ds_read_b64_tr_b16 v[32:33], v8 offset:24576
    ds_read_b64_tr_b16 v[34:35], v8 offset:25088
    s_waitcnt lgkmcnt(6)
    v_mfma_f32_32x32x16_bf16 v[112:127], v[200:203], v[44:47], v[112:127]
    ds_read_b64_tr_b16 v[36:37], v9 offset:24576
    ds_read_b64_tr_b16 v[38:39], v9 offset:25088
    s_add_u32 s24, s23, 381952
    buffer_load_dwordx4 v155, s[68:71], s24 offen offset:3072 lds
    s_waitcnt vmcnt(14)
    s_barrier
    s_mov_b64 exec, 1
    v_mov_b32 v153, 1
    global_store_dword v14, v153, s[8:9] offset:0 sc1
    s_mov_b64 exec, -1
    s_waitcnt lgkmcnt(6)
    v_mfma_f32_32x32x16_bf16 v[96:111], v[204:207], v[48:51], v[96:111]
    ds_read_b64_tr_b16 v[40:41], v8 offset:26624
    ds_read_b64_tr_b16 v[42:43], v8 offset:27136
    s_waitcnt lgkmcnt(6)
    v_mfma_f32_32x32x16_bf16 v[112:127], v[204:207], v[52:55], v[112:127]
    ds_read_b64_tr_b16 v[44:45], v9 offset:26624
    ds_read_b64_tr_b16 v[46:47], v9 offset:27136
    s_add_u32 m0, s28, 8192
    s_add_u32 s24, s23, 393216
    buffer_load_dwordx4 v155, s[68:71], s24 offen offset:0 lds
    s_add_u32 s24, s23, 400384
    buffer_load_dwordx4 v155, s[68:71], s24 offen offset:1024 lds
    s_waitcnt lgkmcnt(6)
    v_mfma_f32_32x32x16_bf16 v[96:111], v[208:211], v[32:35], v[96:111]
    ds_read_b64_tr_b16 v[48:49], v8 offset:28672
    ds_read_b64_tr_b16 v[50:51], v8 offset:29184
    s_waitcnt lgkmcnt(6)
    v_mfma_f32_32x32x16_bf16 v[112:127], v[208:211], v[36:39], v[112:127]
    ds_read_b64_tr_b16 v[52:53], v9 offset:28672
    ds_read_b64_tr_b16 v[54:55], v9 offset:29184
    s_add_u32 s24, s23, 407552
    buffer_load_dwordx4 v155, s[68:71], s24 offen offset:2048 lds
    s_add_u32 s24, s23, 414720
    buffer_load_dwordx4 v155, s[68:71], s24 offen offset:3072 lds
    s_waitcnt lgkmcnt(6)
    v_mfma_f32_32x32x16_bf16 v[96:111], v[212:215], v[40:43], v[96:111]
    ds_read_b64_tr_b16 v[32:33], v8 offset:30720
    ds_read_b64_tr_b16 v[34:35], v8 offset:31232
    s_waitcnt lgkmcnt(6)
    v_mfma_f32_32x32x16_bf16 v[112:127], v[212:215], v[44:47], v[112:127]
    ds_read_b64_tr_b16 v[36:37], v9 offset:30720
    ds_read_b64_tr_b16 v[38:39], v9 offset:31232
    s_add_u32 m0, s28, 12288
    s_add_u32 s24, s23, 425984
    buffer_load_dwordx4 v155, s[68:71], s24 offen offset:0 lds
    s_waitcnt lgkmcnt(6)
    v_mfma_f32_32x32x16_bf16 v[96:111], v[216:219], v[48:51], v[96:111]
    ds_read_b64_tr_b16 v[40:41], v8 offset:32768
    ds_read_b64_tr_b16 v[42:43], v8 offset:33280
    s_waitcnt lgkmcnt(6)
    v_mfma_f32_32x32x16_bf16 v[112:127], v[216:219], v[52:55], v[112:127]
    ds_read_b64_tr_b16 v[44:45], v9 offset:32768
    ds_read_b64_tr_b16 v[46:47], v9 offset:33280
    s_add_u32 s24, s23, 433152
    buffer_load_dwordx4 v155, s[68:71], s24 offen offset:1024 lds
    s_add_u32 s24, s23, 440320
    buffer_load_dwordx4 v155, s[68:71], s24 offen offset:2048 lds
    s_waitcnt lgkmcnt(6)
    v_mfma_f32_32x32x16_bf16 v[96:111], v[220:223], v[32:35], v[96:111]
    ds_read_b64_tr_b16 v[48:49], v8 offset:34816
    ds_read_b64_tr_b16 v[50:51], v8 offset:35328
    s_waitcnt lgkmcnt(6)
    v_mfma_f32_32x32x16_bf16 v[112:127], v[220:223], v[36:39], v[112:127]
    ds_read_b64_tr_b16 v[52:53], v9 offset:34816
    ds_read_b64_tr_b16 v[54:55], v9 offset:35328
    s_add_u32 s24, s23, 447488
    buffer_load_dwordx4 v155, s[68:71], s24 offen offset:3072 lds
    s_waitcnt lgkmcnt(6)
    v_mfma_f32_32x32x16_bf16 v[96:111], v[224:227], v[40:43], v[96:111]
    s_waitcnt vmcnt(17)
    s_barrier
    ds_read_b64_tr_b16 v[32:33], v8 offset:36864
    ds_read_b64_tr_b16 v[34:35], v8 offset:37376
    s_waitcnt lgkmcnt(6)
    v_mfma_f32_32x32x16_bf16 v[112:127], v[224:227], v[44:47], v[112:127]
    ds_read_b64_tr_b16 v[36:37], v9 offset:36864
    ds_read_b64_tr_b16 v[38:39], v9 offset:37376
    s_waitcnt lgkmcnt(6)
    v_mfma_f32_32x32x16_bf16 v[96:111], v[228:231], v[48:51], v[96:111]
    ds_read_b64_tr_b16 v[40:41], v8 offset:38912
    ds_read_b64_tr_b16 v[42:43], v8 offset:39424
    s_waitcnt lgkmcnt(6)
    v_mfma_f32_32x32x16_bf16 v[112:127], v[228:231], v[52:55], v[112:127]
    ds_read_b64_tr_b16 v[44:45], v9 offset:38912
    ds_read_b64_tr_b16 v[46:47], v9 offset:39424
    s_waitcnt lgkmcnt(6)
    v_mfma_f32_32x32x16_bf16 v[96:111], v[232:235], v[32:35], v[96:111]
    ds_read_b64_tr_b16 v[48:49], v8 offset:40960
    ds_read_b64_tr_b16 v[50:51], v8 offset:41472
    s_waitcnt lgkmcnt(6)
    v_mfma_f32_32x32x16_bf16 v[112:127], v[232:235], v[36:39], v[112:127]
    ds_read_b64_tr_b16 v[52:53], v9 offset:40960
    ds_read_b64_tr_b16 v[54:55], v9 offset:41472
    s_waitcnt lgkmcnt(6)
    v_mfma_f32_32x32x16_bf16 v[96:111], v[236:239], v[40:43], v[96:111]
    ds_read_b64_tr_b16 v[32:33], v8 offset:43008
    ds_read_b64_tr_b16 v[34:35], v8 offset:43520
    s_waitcnt lgkmcnt(6)
    v_mfma_f32_32x32x16_bf16 v[112:127], v[236:239], v[44:47], v[112:127]
    ds_read_b64_tr_b16 v[36:37], v9 offset:43008
    ds_read_b64_tr_b16 v[38:39], v9 offset:43520
    s_waitcnt lgkmcnt(6)
    v_mfma_f32_32x32x16_bf16 v[96:111], v[240:243], v[48:51], v[96:111]
    ds_read_b64_tr_b16 v[40:41], v8 offset:45056
    ds_read_b64_tr_b16 v[42:43], v8 offset:45568
    s_waitcnt lgkmcnt(6)
    v_mfma_f32_32x32x16_bf16 v[112:127], v[240:243], v[52:55], v[112:127]
    ds_read_b64_tr_b16 v[44:45], v9 offset:45056
    ds_read_b64_tr_b16 v[46:47], v9 offset:45568
    s_waitcnt vmcnt(15)
    ds_read_b64_tr_b16 a[160:161], v29 offset:0
    ds_read_b64_tr_b16 a[164:165], v154 offset:0
    ds_read_b64_tr_b16 a[162:163], v29 offset:1024
    ds_read_b64_tr_b16 a[166:167], v154 offset:1024
    global_load_dword v31, v15, s[8:9] offset:0 sc1
    s_waitcnt lgkmcnt(6)
    v_mfma_f32_32x32x16_bf16 v[96:111], v[244:247], v[32:35], v[96:111]
    ds_read_b64_tr_b16 v[48:49], v8 offset:47104
    ds_read_b64_tr_b16 v[50:51], v8 offset:47616
    s_waitcnt lgkmcnt(6)
    v_mfma_f32_32x32x16_bf16 v[112:127], v[244:247], v[36:39], v[112:127]
    ds_read_b64_tr_b16 v[52:53], v9 offset:47104
    ds_read_b64_tr_b16 v[54:55], v9 offset:47616
    s_waitcnt vmcnt(14)
    ds_read_b64_tr_b16 a[168:169], v29 offset:2048
    ds_read_b64_tr_b16 a[172:173], v154 offset:2048
    ds_read_b64_tr_b16 a[170:171], v29 offset:3072
    ds_read_b64_tr_b16 a[174:175], v154 offset:3072
    global_load_dwordx4 v[56:59], v12, s[8:9] offset:0 sc1
    global_load_dwordx4 v[60:63], v12, s[8:9] offset:512 sc1
    s_waitcnt lgkmcnt(6)
    v_mfma_f32_32x32x16_bf16 v[96:111], v[248:251], v[40:43], v[96:111]
    ds_read_b64_tr_b16 v[32:33], v8 offset:49152
    ds_read_b64_tr_b16 v[34:35], v8 offset:49664
    s_waitcnt lgkmcnt(6)
    v_mfma_f32_32x32x16_bf16 v[112:127], v[248:251], v[44:47], v[112:127]
    ds_read_b64_tr_b16 v[36:37], v9 offset:49152
    ds_read_b64_tr_b16 v[38:39], v9 offset:49664
    s_waitcnt vmcnt(14)
    ds_read_b64_tr_b16 a[176:177], v29 offset:4096
    ds_read_b64_tr_b16 a[180:181], v154 offset:4096
    ds_read_b64_tr_b16 a[178:179], v29 offset:5120
    ds_read_b64_tr_b16 a[182:183], v154 offset:5120
    s_waitcnt lgkmcnt(6)
    v_mfma_f32_32x32x16_bf16 v[96:111], v[252:255], v[48:51], v[96:111]
    ds_read_b64_tr_b16 v[40:41], v8 offset:51200
    ds_read_b64_tr_b16 v[42:43], v8 offset:51712
    s_waitcnt lgkmcnt(6)
    v_mfma_f32_32x32x16_bf16 v[112:127], v[252:255], v[52:55], v[112:127]
    ds_read_b64_tr_b16 v[44:45], v9 offset:51200
    ds_read_b64_tr_b16 v[46:47], v9 offset:51712
    s_waitcnt vmcnt(12)
    ds_read_b64_tr_b16 a[184:185], v29 offset:6144
    ds_read_b64_tr_b16 a[188:189], v154 offset:6144
    ds_read_b64_tr_b16 a[186:187], v29 offset:7168
    ds_read_b64_tr_b16 a[190:191], v154 offset:7168
    s_waitcnt lgkmcnt(6)
    v_mfma_f32_32x32x16_bf16 v[96:111], a[224:227], v[32:35], v[96:111]
    ds_read_b64_tr_b16 v[48:49], v8 offset:53248
    ds_read_b64_tr_b16 v[50:51], v8 offset:53760
    s_waitcnt lgkmcnt(6)
    v_mfma_f32_32x32x16_bf16 v[112:127], a[224:227], v[36:39], v[112:127]
    ds_read_b64_tr_b16 v[52:53], v9 offset:53248
    ds_read_b64_tr_b16 v[54:55], v9 offset:53760
    s_waitcnt vmcnt(10)
    ds_read_b64_tr_b16 a[192:193], v29 offset:8192
    ds_read_b64_tr_b16 a[196:197], v154 offset:8192
    s_waitcnt vmcnt(9)
    ds_read_b64_tr_b16 a[194:195], v29 offset:9216
    ds_read_b64_tr_b16 a[198:199], v154 offset:9216
    s_waitcnt lgkmcnt(6)
    v_mfma_f32_32x32x16_bf16 v[96:111], a[228:231], v[40:43], v[96:111]
    ds_read_b64_tr_b16 v[32:33], v8 offset:55296
    ds_read_b64_tr_b16 v[34:35], v8 offset:55808
    s_waitcnt lgkmcnt(6)
    v_mfma_f32_32x32x16_bf16 v[112:127], a[228:231], v[44:47], v[112:127]
    ds_read_b64_tr_b16 v[36:37], v9 offset:55296
    ds_read_b64_tr_b16 v[38:39], v9 offset:55808
    s_waitcnt vmcnt(8)
    ds_read_b64_tr_b16 a[200:201], v29 offset:10240
    ds_read_b64_tr_b16 a[204:205], v154 offset:10240
    s_waitcnt vmcnt(7)
    ds_read_b64_tr_b16 a[202:203], v29 offset:11264
    ds_read_b64_tr_b16 a[206:207], v154 offset:11264
    s_waitcnt vmcnt(2)
    v_cmp_gt_u32 vcc, 1, v31
    s_nop 1
    s_cbranch_vccnz pollHE_0
pollHE_0_ok:
    global_load_dwordx4 v[128:131], v7, s[42:43] offset:0 sc1
    s_waitcnt lgkmcnt(6)
    v_mfma_f32_32x32x16_bf16 v[96:111], a[232:235], v[48:51], v[96:111]
    ds_read_b64_tr_b16 v[40:41], v8 offset:57344
    ds_read_b64_tr_b16 v[42:43], v8 offset:57856
    s_waitcnt lgkmcnt(6)
    v_mfma_f32_32x32x16_bf16 v[112:127], a[232:235], v[52:55], v[112:127]
    ds_read_b64_tr_b16 v[44:45], v9 offset:57344
    ds_read_b64_tr_b16 v[46:47], v9 offset:57856
    ds_read_b64_tr_b16 a[208:209], v29 offset:12288
    ds_read_b64_tr_b16 a[212:213], v154 offset:12288
    ds_read_b64_tr_b16 a[210:211], v29 offset:13312
    ds_read_b64_tr_b16 a[214:215], v154 offset:13312
    global_load_dwordx4 v[132:135], v7, s[42:43] offset:1024 sc1
    s_waitcnt lgkmcnt(6)
    v_mfma_f32_32x32x16_bf16 v[96:111], a[236:239], v[32:35], v[96:111]
    ds_read_b64_tr_b16 v[48:49], v8 offset:59392
    ds_read_b64_tr_b16 v[50:51], v8 offset:59904
    s_waitcnt lgkmcnt(6)
    v_mfma_f32_32x32x16_bf16 v[112:127], a[236:239], v[36:39], v[112:127]
    ds_read_b64_tr_b16 v[52:53], v9 offset:59392
    ds_read_b64_tr_b16 v[54:55], v9 offset:59904
    ds_read_b64_tr_b16 a[216:217], v29 offset:14336
    ds_read_b64_tr_b16 a[220:221], v154 offset:14336
    ds_read_b64_tr_b16 a[218:219], v29 offset:15360
    ds_read_b64_tr_b16 a[222:223], v154 offset:15360
    global_load_dwordx4 v[136:139], v7, s[42:43] offset:2048 sc1
    s_waitcnt lgkmcnt(6)
    v_mfma_f32_32x32x16_bf16 v[96:111], a[240:243], v[40:43], v[96:111]
    ds_read_b64_tr_b16 v[32:33], v8 offset:61440
    ds_read_b64_tr_b16 v[34:35], v8 offset:61952
    s_waitcnt lgkmcnt(6)
    v_mfma_f32_32x32x16_bf16 v[112:127], a[240:243], v[44:47], v[112:127]
    ds_read_b64_tr_b16 v[36:37], v9 offset:61440
    ds_read_b64_tr_b16 v[38:39], v9 offset:61952
    global_load_dwordx4 v[140:143], v7, s[42:43] offset:3072 sc1
    v_add_u32 v7, 4096, v7
    s_waitcnt vmcnt(4)
ffn_chk1_0:
    v_min_u32 v2, v57, v59
    v_min3_u32 v2, v2, v61, v63
    v_cmp_eq_u32 vcc, 0, v2
    s_nop 1
    s_cbranch_vccnz ffn_retry1_0
    v_add_f32 v16, v56, v58
    v_add_f32 v18, v60, v62
    v_add_f32 v17, v57, v59
    v_add_f32 v19, v61, v63
    v_mul_f32 v16, s26, v16
    v_mul_f32 v18, s26, v18
    s_waitcnt lgkmcnt(6)
    v_mfma_f32_32x32x16_bf16 v[96:111], a[244:247], v[48:51], v[96:111]
    ds_read_b64_tr_b16 v[40:41], v8 offset:63488
    ds_read_b64_tr_b16 v[42:43], v8 offset:64000
    v_mul_f32 v17, s26, v17
    v_mul_f32 v19, s26, v19
    v_cvt_pk_bf16_f32 v56, -v16, -v16
    v_cvt_pk_bf16_f32 v60, -v18, -v18
    v_mov_b32 v58, 0
    v_mov_b32 v59, 0
    s_waitcnt lgkmcnt(6)
    v_mfma_f32_32x32x16_bf16 v[112:127], a[244:247], v[52:55], v[112:127]
    ds_read_b64_tr_b16 v[44:45], v9 offset:63488
    ds_read_b64_tr_b16 v[46:47], v9 offset:64000
    global_load_dwordx4 v[144:147], v7, s[42:43] offset:0 sc1
    v_mov_b32 v57, v56
    v_mov_b32 v61, v60
    v_mov_b32 v62, 0
    v_mov_b32 v63, 0
    v_fma_f32 v17, -v16, v16, v17
    v_fma_f32 v19, -v18, v18, v19
    s_waitcnt lgkmcnt(6)
    v_mfma_f32_32x32x16_bf16 v[96:111], a[248:251], v[32:35], v[96:111]
    v_max_f32 v17, 0, v17
    v_max_f32 v19, 0, v19
    v_cvt_pk_bf16_f32 v17, 0, v17
    v_cvt_pk_bf16_f32 v19, 0, v19
    v_add_f32 v17, s27, v17
    v_add_f32 v19, s27, v19
    s_waitcnt lgkmcnt(4)
    v_mfma_f32_32x32x16_bf16 v[112:127], a[248:251], v[36:39], v[112:127]
    global_load_dwordx4 v[148:151], v7, s[42:43] offset:1024 sc1
    v_cvt_pk_bf16_f32 v17, 0, v17
    v_cvt_pk_bf16_f32 v19, 0, v19
    v_sqrt_f32 v17, v17
    v_sqrt_f32 v19, v19
    v_cvt_pk_bf16_f32 v17, 0, v17
    v_cvt_pk_bf16_f32 v19, 0, v19
    s_waitcnt lgkmcnt(2)
    v_mfma_f32_32x32x16_bf16 v[96:111], a[252:255], v[40:43], v[96:111]
    v_mfma_f32_32x32x16_bf16 v[96:111], v[156:159], v[56:59], v[96:111]
    v_rcp_f32 v16, v17
    v_rcp_f32 v18, v19
    v_mul_f32 v16, s31, v16
    v_mul_f32 v18, s31, v18
    s_waitcnt lgkmcnt(0)
    v_mfma_f32_32x32x16_bf16 v[112:127], a[252:255], v[44:47], v[112:127]
    v_mfma_f32_32x32x16_bf16 v[112:127], v[156:159], v[60:63], v[112:127]
    ds_read_b64_tr_b16 v[24:25], v10 offset:0
    ds_read_b64_tr_b16 v[26:27], v10 offset:1024
    global_load_dwordx4 v[32:35], v7, s[42:43] offset:2048 sc1
    global_load_dwordx4 v[36:39], v7, s[42:43] offset:3072 sc1
    v_add_u32 v7, 4096, v7
    global_load_dwordx4 v[40:43], v7, s[42:43] offset:0 sc1
    v_pk_mul_f32 v[48:49], v[96:97], v[16:17] op_sel:[0,0] op_sel_hi:[1,0]
    v_pk_mul_f32 v[50:51], v[98:99], v[16:17] op_sel:[0,0] op_sel_hi:[1,0]
    v_pk_mul_f32 v[52:53], v[100:101], v[16:17] op_sel:[0,0] op_sel_hi:[1,0]
    v_pk_mul_f32 v[54:55], v[102:103], v[16:17] op_sel:[0,0] op_sel_hi:[1,0]
    v_pk_mul_f32 v[56:57], v[104:105], v[16:17] op_sel:[0,0] op_sel_hi:[1,0]
    v_pk_mul_f32 v[58:59], v[106:107], v[16:17] op_sel:[0,0] op_sel_hi:[1,0]
    v_pk_mul_f32 v[60:61], v[108:109], v[16:17] op_sel:[0,0] op_sel_hi:[1,0]
    v_pk_mul_f32 v[62:63], v[110:111], v[16:17] op_sel:[0,0] op_sel_hi:[1,0]
    v_exp_f32 v48, v48
    v_exp_f32 v49, v49
    v_exp_f32 v50, v50
    v_exp_f32 v51, v51
    v_exp_f32 v52, v52
    v_exp_f32 v53, v53
    global_load_dwordx4 v[44:47], v7, s[42:43] offset:1024 sc1
    v_exp_f32 v54, v54
    v_exp_f32 v55, v55
    v_exp_f32 v56, v56
    v_exp_f32 v57, v57
    v_exp_f32 v58, v58
    v_exp_f32 v59, v59
    v_exp_f32 v60, v60
    v_exp_f32 v61, v61
    v_exp_f32 v62, v62
    v_exp_f32 v63, v63
    v_pk_fma_f32 v[48:49], v[48:49], v[16:17], v[16:17] op_sel:[0,1,1] op_sel_hi:[1,1,1]
    v_pk_fma_f32 v[50:51], v[50:51], v[16:17], v[16:17] op_sel:[0,1,1] op_sel_hi:[1,1,1]
    v_pk_fma_f32 v[52:53], v[52:53], v[16:17], v[16:17] op_sel:[0,1,1] op_sel_hi:[1,1,1]
    v_pk_fma_f32 v[54:55], v[54:55], v[16:17], v[16:17] op_sel:[0,1,1] op_sel_hi:[1,1,1]
    v_pk_fma_f32 v[56:57], v[56:57], v[16:17], v[16:17] op_sel:[0,1,1] op_sel_hi:[1,1,1]
    v_pk_fma_f32 v[58:59], v[58:59], v[16:17], v[16:17] op_sel:[0,1,1] op_sel_hi:[1,1,1]
    v_pk_fma_f32 v[60:61], v[60:61], v[16:17], v[16:17] op_sel:[0,1,1] op_sel_hi:[1,1,1]
    v_pk_fma_f32 v[62:63], v[62:63], v[16:17], v[16:17] op_sel:[0,1,1] op_sel_hi:[1,1,1]
    v_rcp_f32 v48, v48
    v_rcp_f32 v49, v49
    v_rcp_f32 v50, v50
    v_rcp_f32 v51, v51
    v_rcp_f32 v52, v52
    v_rcp_f32 v53, v53
    v_rcp_f32 v54, v54
    v_rcp_f32 v55, v55
    v_rcp_f32 v56, v56
    v_rcp_f32 v57, v57
    v_rcp_f32 v58, v58
    v_rcp_f32 v59, v59
    v_rcp_f32 v60, v60
    v_rcp_f32 v61, v61
    v_rcp_f32 v62, v62
    v_rcp_f32 v63, v63
    v_pk_mul_f32 v[96:97], v[96:97], v[48:49]
    v_pk_mul_f32 v[98:99], v[98:99], v[50:51]
    v_pk_mul_f32 v[100:101], v[100:101], v[52:53]
    v_pk_mul_f32 v[102:103], v[102:103], v[54:55]
    v_pk_mul_f32 v[104:105], v[104:105], v[56:57]
    v_pk_mul_f32 v[106:107], v[106:107], v[58:59]
    v_pk_mul_f32 v[108:109], v[108:109], v[60:61]
    v_pk_mul_f32 v[110:111], v[110:111], v[62:63]
    v_cvt_pk_bf16_f32 v96, v96, v97
    v_cvt_pk_bf16_f32 v97, v98, v99
    v_cvt_pk_bf16_f32 v98, v100, v101
    v_cvt_pk_bf16_f32 v99, v102, v103
    v_cvt_pk_bf16_f32 v100, v104, v105
    v_cvt_pk_bf16_f32 v101, v106, v107
    v_cvt_pk_bf16_f32 v102, v108, v109
    v_cvt_pk_bf16_f32 v103, v110, v111
    global_store_dwordx4 v5, v[96:99], s[40:41] sc1
    global_store_dwordx4 v5, v[100:103], s[40:41] offset:1024 sc1
    v_pk_mul_f32 v[48:49], v[112:113], v[18:19] op_sel:[0,0] op_sel_hi:[1,0]
    v_pk_mul_f32 v[50:51], v[114:115], v[18:19] op_sel:[0,0] op_sel_hi:[1,0]
    v_pk_mul_f32 v[52:53], v[116:117], v[18:19] op_sel:[0,0] op_sel_hi:[1,0]
    v_pk_mul_f32 v[54:55], v[118:119], v[18:19] op_sel:[0,0] op_sel_hi:[1,0]
    v_pk_mul_f32 v[56:57], v[120:121], v[18:19] op_sel:[0,0] op_sel_hi:[1,0]
    v_pk_mul_f32 v[58:59], v[122:123], v[18:19] op_sel:[0,0] op_sel_hi:[1,0]
    v_pk_mul_f32 v[60:61], v[124:125], v[18:19] op_sel:[0,0] op_sel_hi:[1,0]
    v_pk_mul_f32 v[62:63], v[126:127], v[18:19] op_sel:[0,0] op_sel_hi:[1,0]
    v_exp_f32 v48, v48
    v_exp_f32 v49, v49
    v_exp_f32 v50, v50
    v_exp_f32 v51, v51
    v_exp_f32 v52, v52
    v_exp_f32 v53, v53
    v_exp_f32 v54, v54
    v_exp_f32 v55, v55
    v_exp_f32 v56, v56
    v_exp_f32 v57, v57
    v_exp_f32 v58, v58
    v_exp_f32 v59, v59
    v_exp_f32 v60, v60
    v_exp_f32 v61, v61
    v_exp_f32 v62, v62
    v_exp_f32 v63, v63
    v_pk_fma_f32 v[48:49], v[48:49], v[18:19], v[18:19] op_sel:[0,1,1] op_sel_hi:[1,1,1]
    v_pk_fma_f32 v[50:51], v[50:51], v[18:19], v[18:19] op_sel:[0,1,1] op_sel_hi:[1,1,1]
    v_pk_fma_f32 v[52:53], v[52:53], v[18:19], v[18:19] op_sel:[0,1,1] op_sel_hi:[1,1,1]
    v_pk_fma_f32 v[54:55], v[54:55], v[18:19], v[18:19] op_sel:[0,1,1] op_sel_hi:[1,1,1]
    v_pk_fma_f32 v[56:57], v[56:57], v[18:19], v[18:19] op_sel:[0,1,1] op_sel_hi:[1,1,1]
    v_pk_fma_f32 v[58:59], v[58:59], v[18:19], v[18:19] op_sel:[0,1,1] op_sel_hi:[1,1,1]
    v_pk_fma_f32 v[60:61], v[60:61], v[18:19], v[18:19] op_sel:[0,1,1] op_sel_hi:[1,1,1]
    v_pk_fma_f32 v[62:63], v[62:63], v[18:19], v[18:19] op_sel:[0,1,1] op_sel_hi:[1,1,1]
    v_rcp_f32 v48, v48
    v_rcp_f32 v49, v49
    v_rcp_f32 v50, v50
    v_rcp_f32 v51, v51
    v_rcp_f32 v52, v52
    v_rcp_f32 v53, v53
    v_rcp_f32 v54, v54
    v_rcp_f32 v55, v55
    v_rcp_f32 v56, v56
    v_rcp_f32 v57, v57
    v_rcp_f32 v58, v58
    v_rcp_f32 v59, v59
    v_rcp_f32 v60, v60
    v_rcp_f32 v61, v61
    v_rcp_f32 v62, v62
    v_rcp_f32 v63, v63
    v_pk_mul_f32 v[112:113], v[112:113], v[48:49]
    v_pk_mul_f32 v[114:115], v[114:115], v[50:51]
    v_pk_mul_f32 v[116:117], v[116:117], v[52:53]
    v_pk_mul_f32 v[118:119], v[118:119], v[54:55]
    v_pk_mul_f32 v[120:121], v[120:121], v[56:57]
    v_pk_mul_f32 v[122:123], v[122:123], v[58:59]
    v_pk_mul_f32 v[124:125], v[124:125], v[60:61]
    v_pk_mul_f32 v[126:127], v[126:127], v[62:63]
    v_cvt_pk_bf16_f32 v112, v112, v113
    v_cvt_pk_bf16_f32 v113, v114, v115
    v_cvt_pk_bf16_f32 v114, v116, v117
    v_cvt_pk_bf16_f32 v115, v118, v119
    v_cvt_pk_bf16_f32 v116, v120, v121
    v_cvt_pk_bf16_f32 v117, v122, v123
    v_cvt_pk_bf16_f32 v118, v124, v125
    v_cvt_pk_bf16_f32 v119, v126, v127
    global_store_dwordx4 v6, v[112:115], s[40:41] sc1
    global_store_dwordx4 v6, v[116:119], s[40:41] offset:1024 sc1
    s_sub_u32 s40, s40, 3670016
    s_subb_u32 s41, s41, 0
    v_and_b32 v3, 31, v1
    v_lshrrev_b32 v4, 5, v1
    s_lshl_b32 s24, s32, 5
    v_add_u32 v3, s24, v3
    s_lshl_b32 s24, s46, 12
    s_add_u32 s24, s24, 0
    s_add_u32 s44, s8, s24
    s_addc_u32 s45, s9, 0
    v_lshlrev_b32 v28, 14, v4
    v_lshl_add_u32 v28, v3, 3, v28
    v_lshlrev_b32 v29, 2, v4
    v_lshl_add_u32 v29, v3, 3, v29
    v_add_u32 v29, 17039360, v29
    v_lshlrev_b32 v8, 2, v0
    v_add_u32 v8, 131072, v8
    v_lshlrev_b32 v30, 5, v0
    v_add_u32 v30, 17137664, v30
    s_lshl_b32 s24, s10, 13
    s_add_u32 s24, s24, 65536
    v_add_u32 v10, s24, v5
    v_xor_b32 v11, 0x2000, v10
    v_xor_b32 v13, 0x4000, v10
    v_xor_b32 v6, 0x6000, v10
    s_waitcnt lgkmcnt(0)
ffn_g2_0:
    global_load_dwordx4 v[48:51], v7, s[42:43] offset:2048 sc1
    global_load_dwordx4 v[52:55], v7, s[42:43] offset:3072 sc1
    v_add_u32 v7, 4096, v7
    global_load_dwordx4 v[56:59], v7, s[42:43] offset:0 sc1
    s_waitcnt vmcnt(16)
    v_mfma_f32_32x32x16_bf16 v[64:79], a[0:3], v[128:131], 0
    global_load_dwordx4 v[60:63], v7, s[42:43] offset:1024 sc1
    v_mfma_f32_32x32x16_bf16 v[80:95], a[4:7], v[128:131], 0
    s_waitcnt vmcnt(16)
    v_mfma_f32_32x32x16_bf16 v[64:79], a[8:11], v[132:135], v[64:79]
    global_load_dwordx4 v[128:131], v7, s[42:43] offset:2048 sc1
    v_mfma_f32_32x32x16_bf16 v[80:95], a[12:15], v[132:135], v[80:95]
    s_waitcnt vmcnt(16)
    v_mfma_f32_32x32x16_bf16 v[64:79], a[16:19], v[136:139], v[64:79]
    global_load_dwordx4 v[132:135], v7, s[42:43] offset:3072 sc1
    v_add_u32 v7, 4096, v7
    v_mfma_f32_32x32x16_bf16 v[80:95], a[20:23], v[136:139], v[80:95]
    s_waitcnt vmcnt(16)
    v_mfma_f32_32x32x16_bf16 v[64:79], a[24:27], v[140:143], v[64:79]
    global_load_dwordx4 v[136:139], v7, s[42:43] offset:0 sc1
    v_mfma_f32_32x32x16_bf16 v[80:95], a[28:31], v[140:143], v[80:95]
    s_waitcnt vmcnt(16)
    v_mfma_f32_32x32x16_bf16 v[64:79], a[32:35], v[144:147], v[64:79]
    global_load_dwordx4 v[140:143], v7, s[42:43] offset:1024 sc1
    v_mfma_f32_32x32x16_bf16 v[80:95], a[36:39], v[144:147], v[80:95]
    s_waitcnt vmcnt(16)
    v_mfma_f32_32x32x16_bf16 v[64:79], a[40:43], v[148:151], v[64:79]
    global_load_dwordx4 v[144:147], v7, s[42:43] offset:2048 sc1
    v_mfma_f32_32x32x16_bf16 v[80:95], a[44:47], v[148:151], v[80:95]
    s_waitcnt vmcnt(16)
    v_mfma_f32_32x32x16_bf16 v[64:79], a[48:51], v[32:35], v[64:79]
    global_load_dwordx4 v[148:151], v7, s[42:43] offset:3072 sc1
    v_add_u32 v7, 4096, v7
    v_mfma_f32_32x32x16_bf16 v[80:95], a[52:55], v[32:35], v[80:95]
    s_waitcnt vmcnt(16)
    v_mfma_f32_32x32x16_bf16 v[64:79], a[56:59], v[36:39], v[64:79]
    global_load_dwordx4 v[32:35], v7, s[42:43] offset:0 sc1
    v_mfma_f32_32x32x16_bf16 v[80:95], a[60:63], v[36:39], v[80:95]
    s_waitcnt vmcnt(16)
    v_mfma_f32_32x32x16_bf16 v[64:79], a[64:67], v[40:43], v[64:79]
    global_load_dwordx4 v[36:39], v7, s[42:43] offset:1024 sc1
    v_mfma_f32_32x32x16_bf16 v[80:95], a[68:71], v[40:43], v[80:95]
    s_waitcnt vmcnt(16)
    v_mfma_f32_32x32x16_bf16 v[64:79], a[72:75], v[44:47], v[64:79]
    global_load_dwordx4 v[40:43], v7, s[42:43] offset:2048 sc1
    v_mfma_f32_32x32x16_bf16 v[80:95], a[76:79], v[44:47], v[80:95]
    s_waitcnt vmcnt(12)
    v_mfma_f32_32x32x16_bf16 v[64:79], a[80:83], v[48:51], v[64:79]
    global_load_dwordx4 v[44:47], v7, s[42:43] offset:3072 sc1
    v_add_u32 v7, 4096, v7
    v_mfma_f32_32x32x16_bf16 v[80:95], a[84:87], v[48:51], v[80:95]
    s_barrier
    s_mov_b64 exec, 1
    v_mov_b32 v153, 1
    global_store_dword v14, v153, s[8:9] offset:4 sc1
    s_mov_b64 exec, -1
    s_waitcnt vmcnt(13)
    v_mfma_f32_32x32x16_bf16 v[64:79], a[88:91], v[52:55], v[64:79]
    global_load_dwordx4 v[48:51], v7, s[42:43] offset:0 sc1
    v_mfma_f32_32x32x16_bf16 v[80:95], a[92:95], v[52:55], v[80:95]
    s_waitcnt vmcnt(13)
    v_mfma_f32_32x32x16_bf16 v[64:79], a[96:99], v[56:59], v[64:79]
    global_load_dwordx4 v[52:55], v7, s[42:43] offset:1024 sc1
    v_mfma_f32_32x32x16_bf16 v[80:95], a[100:103], v[56:59], v[80:95]
    s_waitcnt vmcnt(13)
    v_mfma_f32_32x32x16_bf16 v[64:79], a[104:107], v[60:63], v[64:79]
    global_load_dwordx4 v[56:59], v7, s[42:43] offset:2048 sc1
    v_mfma_f32_32x32x16_bf16 v[80:95], a[108:111], v[60:63], v[80:95]
    s_waitcnt vmcnt(13)
    v_mfma_f32_32x32x16_bf16 v[64:79], a[112:115], v[128:131], v[64:79]
    global_load_dwordx4 v[60:63], v7, s[42:43] offset:3072 sc1
    v_add_u32 v7, 3670016, v5
    v_mfma_f32_32x32x16_bf16 v[80:95], a[116:119], v[128:131], v[80:95]
    s_waitcnt vmcnt(13)
    v_mfma_f32_32x32x16_bf16 v[64:79], a[120:123], v[132:135], v[64:79]
    v_mfma_f32_32x32x16_bf16 v[80:95], a[124:127], v[132:135], v[80:95]
    s_waitcnt vmcnt(12)
    v_mfma_f32_32x32x16_bf16 v[64:79], a[128:131], v[136:139], v[64:79]
    v_mfma_f32_32x32x16_bf16 v[80:95], a[132:135], v[136:139], v[80:95]
    s_waitcnt vmcnt(11)
    v_mfma_f32_32x32x16_bf16 v[64:79], a[136:139], v[140:143], v[64:79]
    v_mfma_f32_32x32x16_bf16 v[80:95], a[140:143], v[140:143], v[80:95]
    s_waitcnt vmcnt(10)
    v_mfma_f32_32x32x16_bf16 v[64:79], a[144:147], v[144:147], v[64:79]
    v_mfma_f32_32x32x16_bf16 v[80:95], a[148:151], v[144:147], v[80:95]
    s_waitcnt vmcnt(9)
    v_mfma_f32_32x32x16_bf16 v[64:79], a[152:155], v[148:151], v[64:79]
    v_mfma_f32_32x32x16_bf16 v[80:95], a[156:159], v[148:151], v[80:95]
    s_waitcnt vmcnt(8)
    v_mfma_f32_32x32x16_bf16 v[64:79], a[160:163], v[32:35], v[64:79]
    v_mfma_f32_32x32x16_bf16 v[80:95], a[164:167], v[32:35], v[80:95]
    s_waitcnt vmcnt(7)
    v_mfma_f32_32x32x16_bf16 v[64:79], a[168:171], v[36:39], v[64:79]
    v_mfma_f32_32x32x16_bf16 v[80:95], a[172:175], v[36:39], v[80:95]
    s_waitcnt vmcnt(6)
    v_mfma_f32_32x32x16_bf16 v[64:79], a[176:179], v[40:43], v[64:79]
    v_mfma_f32_32x32x16_bf16 v[80:95], a[180:183], v[40:43], v[80:95]
    s_waitcnt vmcnt(5)
    v_mfma_f32_32x32x16_bf16 v[64:79], a[184:187], v[44:47], v[64:79]
    v_mfma_f32_32x32x16_bf16 v[80:95], a[188:191], v[44:47], v[80:95]
    s_waitcnt vmcnt(3)
    v_mfma_f32_32x32x16_bf16 v[64:79], a[192:195], v[48:51], v[64:79]
    v_mfma_f32_32x32x16_bf16 v[80:95], a[196:199], v[48:51], v[80:95]
    s_waitcnt vmcnt(2)
    v_mfma_f32_32x32x16_bf16 v[64:79], a[200:203], v[52:55], v[64:79]
    v_mfma_f32_32x32x16_bf16 v[80:95], a[204:207], v[52:55], v[80:95]
    global_load_dword v31, v15, s[8:9] offset:4 sc1
    s_waitcnt vmcnt(2)
    v_mfma_f32_32x32x16_bf16 v[64:79], a[208:211], v[56:59], v[64:79]
    v_mfma_f32_32x32x16_bf16 v[80:95], a[212:215], v[56:59], v[80:95]
    s_waitcnt vmcnt(1)
    v_mfma_f32_32x32x16_bf16 v[64:79], a[216:219], v[60:63], v[64:79]
    v_mfma_f32_32x32x16_bf16 v[80:95], a[220:223], v[60:63], v[80:95]
    s_waitcnt vmcnt(0)
    v_cmp_gt_u32 vcc, 1, v31
    s_nop 1
    s_cbranch_vccnz pollHL_0
pollHL_0_ok:
    global_load_dwordx4 v[128:131], v7, s[42:43] offset:0 sc1
    global_load_dwordx4 v[132:135], v7, s[42:43] offset:1024 sc1
    global_load_dwordx4 v[136:139], v7, s[42:43] offset:2048 sc1
    global_load_dwordx4 v[140:143], v7, s[42:43] offset:3072 sc1
    v_add_u32 v7, 4096, v7
    s_nop 0
    ds_write_b128 v11, v[72:75] offset:2048
    ds_write_b128 v11, v[76:79] offset:3072
    ds_write_b128 v13, v[80:83] offset:4096
    ds_write_b128 v13, v[84:87] offset:5120
    ds_write_b128 v6, v[88:91] offset:6144
    ds_write_b128 v6, v[92:95] offset:7168
    global_load_dwordx4 v[144:147], v7, s[42:43] offset:0 sc1
    global_load_dwordx4 v[148:151], v7, s[42:43] offset:1024 sc1
    global_load_dwordx4 v[32:35], v7, s[42:43] offset:2048 sc1
    global_load_dwordx4 v[36:39], v7, s[42:43] offset:3072 sc1
    v_add_u32 v7, 4096, v7
    global_load_dwordx4 v[40:43], v7, s[42:43] offset:0 sc1
    s_waitcnt lgkmcnt(0)
    s_barrier
    ds_read_b128 v[72:75], v10 offset:2048
    ds_read_b128 v[76:79], v10 offset:3072
    ds_read_b128 v[80:83], v10 offset:4096
    ds_read_b128 v[84:87], v10 offset:5120
    ds_read_b128 v[88:91], v10 offset:6144
    ds_read_b128 v[92:95], v10 offset:7168
    global_load_dwordx4 v[44:47], v7, s[42:43] offset:1024 sc1
    global_load_dwordx4 v[48:51], v7, s[42:43] offset:2048 sc1
    s_waitcnt lgkmcnt(4)
    v_pk_add_f32 v[64:65], v[64:65], v[72:73]
    v_pk_add_f32 v[66:67], v[66:67], v[74:75]
    v_pk_add_f32 v[68:69], v[68:69], v[76:77]
    v_pk_add_f32 v[70:71], v[70:71], v[78:79]
    v_lshlrev_b32 v72, 16, v20
    v_and_b32 v73, 0xffff0000, v20
    v_lshlrev_b32 v74, 16, v21
    v_and_b32 v75, 0xffff0000, v21
    v_lshlrev_b32 v76, 16, v22
    global_load_dwordx4 v[52:55], v7, s[42:43] offset:3072 sc1
    v_add_u32 v7, 4096, v7
    v_and_b32 v77, 0xffff0000, v22
    v_lshlrev_b32 v78, 16, v23
    v_and_b32 v79, 0xffff0000, v23
    s_waitcnt lgkmcnt(0)
    v_pk_add_f32 v[80:81], v[80:81], v[88:89]
    v_pk_add_f32 v[82:83], v[82:83], v[90:91]
    v_pk_add_f32 v[84:85], v[84:85], v[92:93]
    v_pk_add_f32 v[86:87], v[86:87], v[94:95]
    v_pk_add_f32 v[64:65], v[64:65], v[80:81]
    v_pk_add_f32 v[66:67], v[66:67], v[82:83]
    global_load_dwordx4 v[56:59], v7, s[42:43] offset:0 sc1
    v_pk_add_f32 v[68:69], v[68:69], v[84:85]
    v_pk_add_f32 v[70:71], v[70:71], v[86:87]
    v_cvt_pk_bf16_f32 v64, 0, v64
    v_cvt_pk_bf16_f32 v65, 0, v65
    v_cvt_pk_bf16_f32 v66, 0, v66
    v_cvt_pk_bf16_f32 v67, 0, v67
    v_cvt_pk_bf16_f32 v68, 0, v68
    v_cvt_pk_bf16_f32 v69, 0, v69
    v_cvt_pk_bf16_f32 v70, 0, v70
    v_cvt_pk_bf16_f32 v71, 0, v71
    v_pk_add_f32 v[64:65], v[64:65], v[72:73]
    v_pk_add_f32 v[66:67], v[66:67], v[74:75]
    v_pk_add_f32 v[68:69], v[68:69], v[76:77]
    v_pk_add_f32 v[70:71], v[70:71], v[78:79]
    v_cvt_pk_bf16_f32 v80, v64, v65
    v_cvt_pk_bf16_f32 v81, v66, v67
    v_cvt_pk_bf16_f32 v82, v68, v69
    v_cvt_pk_bf16_f32 v83, v70, v71
    v_add_u32 v84, 0x8000, v28
    global_store_dwordx2 v28, v[80:81], s[44:45] sc1
    global_store_dwordx2 v84, v[82:83], s[44:45] sc1
    v_mov_b32 v64, 0
    v_mov_b32 v65, 0
    v_add_u32 v28, 0x2000, v28
    v_dot2c_f32_bf16 v64, s25, v80
    v_dot2c_f32_bf16 v65, v80, v80
    v_dot2c_f32_bf16 v64, s25, v81
    v_dot2c_f32_bf16 v65, v81, v81
    v_dot2c_f32_bf16 v64, s25, v82
    v_dot2c_f32_bf16 v65, v82, v82
    v_dot2c_f32_bf16 v64, s25, v83
    v_dot2c_f32_bf16 v65, v83, v83
    s_nop 2
    v_permlane32_swap_b32 v64, v65
    v_add_f32 v64, v64, v65
    ds_write_b32 v8, v64 offset:0
    s_waitcnt lgkmcnt(0)
    s_barrier
    s_cmp_lg_u32 s10, 0
    s_cbranch_scc1 ffn_nors0
    ds_read_b32 v2, v8 offset:0
    ds_read_b32 v3, v8 offset:256
    ds_read_b32 v12, v8 offset:512
    ds_read_b32 v9, v8 offset:768
    s_waitcnt lgkmcnt(0)
    v_add_f32 v2, v2, v3
    v_add_f32 v12, v12, v9
    v_add_f32 v2, v2, v12
    global_atomic_add_f32 v29, v2, s[8:9]
    v_add_u32 v29, 0x2000, v29
ffn_nors0:
    s_waitcnt vmcnt(14)
    v_mfma_f32_32x32x16_bf16 v[96:111], a[0:3], v[128:131], 0
    global_load_dwordx4 v[60:63], v7, s[42:43] offset:1024 sc1
    v_mfma_f32_32x32x16_bf16 v[112:127], a[4:7], v[128:131], 0
    s_waitcnt vmcnt(14)
    v_mfma_f32_32x32x16_bf16 v[96:111], a[8:11], v[132:135], v[96:111]
    global_load_dwordx4 v[128:131], v7, s[42:43] offset:2048 sc1
    v_mfma_f32_32x32x16_bf16 v[112:127], a[12:15], v[132:135], v[112:127]
    s_waitcnt vmcnt(14)
    v_mfma_f32_32x32x16_bf16 v[96:111], a[16:19], v[136:139], v[96:111]
    global_load_dwordx4 v[132:135], v7, s[42:43] offset:3072 sc1
    v_add_u32 v7, 4096, v7
    v_mfma_f32_32x32x16_bf16 v[112:127], a[20:23], v[136:139], v[112:127]
    s_waitcnt vmcnt(14)
    v_mfma_f32_32x32x16_bf16 v[96:111], a[24:27], v[140:143], v[96:111]
    global_load_dwordx4 v[136:139], v7, s[42:43] offset:0 sc1
    v_mfma_f32_32x32x16_bf16 v[112:127], a[28:31], v[140:143], v[112:127]
    s_waitcnt vmcnt(14)
    v_mfma_f32_32x32x16_bf16 v[96:111], a[32:35], v[144:147], v[96:111]
    global_load_dwordx4 v[140:143], v7, s[42:43] offset:1024 sc1
    v_mfma_f32_32x32x16_bf16 v[112:127], a[36:39], v[144:147], v[112:127]
    s_waitcnt vmcnt(14)
    v_mfma_f32_32x32x16_bf16 v[96:111], a[40:43], v[148:151], v[96:111]
    global_load_dwordx4 v[144:147], v7, s[42:43] offset:2048 sc1
    v_mfma_f32_32x32x16_bf16 v[112:127], a[44:47], v[148:151], v[112:127]
    s_waitcnt vmcnt(14)
    v_mfma_f32_32x32x16_bf16 v[96:111], a[48:51], v[32:35], v[96:111]
    global_load_dwordx4 v[148:151], v7, s[42:43] offset:3072 sc1
    v_add_u32 v7, 4096, v7
    v_mfma_f32_32x32x16_bf16 v[112:127], a[52:55], v[32:35], v[112:127]
    s_waitcnt vmcnt(14)
    v_mfma_f32_32x32x16_bf16 v[96:111], a[56:59], v[36:39], v[96:111]
    global_load_dwordx4 v[32:35], v7, s[42:43] offset:0 sc1
    v_mfma_f32_32x32x16_bf16 v[112:127], a[60:63], v[36:39], v[112:127]
    s_waitcnt vmcnt(14)
    v_mfma_f32_32x32x16_bf16 v[96:111], a[64:67], v[40:43], v[96:111]
    global_load_dwordx4 v[36:39], v7, s[42:43] offset:1024 sc1
    v_mfma_f32_32x32x16_bf16 v[112:127], a[68:71], v[40:43], v[112:127]
    s_waitcnt vmcnt(14)
    v_mfma_f32_32x32x16_bf16 v[96:111], a[72:75], v[44:47], v[96:111]
    global_load_dwordx4 v[40:43], v7, s[42:43] offset:2048 sc1
    v_mfma_f32_32x32x16_bf16 v[112:127], a[76:79], v[44:47], v[112:127]
    s_waitcnt vmcnt(14)
    v_mfma_f32_32x32x16_bf16 v[96:111], a[80:83], v[48:51], v[96:111]
    global_load_dwordx4 v[44:47], v7, s[42:43] offset:3072 sc1
    v_add_u32 v7, 4096, v7
    v_mfma_f32_32x32x16_bf16 v[112:127], a[84:87], v[48:51], v[112:127]
    s_waitcnt vmcnt(14)
    v_mfma_f32_32x32x16_bf16 v[96:111], a[88:91], v[52:55], v[96:111]
    global_load_dwordx4 v[48:51], v7, s[42:43] offset:0 sc1
    v_mfma_f32_32x32x16_bf16 v[112:127], a[92:95], v[52:55], v[112:127]
    s_waitcnt vmcnt(14)
    v_mfma_f32_32x32x16_bf16 v[96:111], a[96:99], v[56:59], v[96:111]
    global_load_dwordx4 v[52:55], v7, s[42:43] offset:1024 sc1
    v_mfma_f32_32x32x16_bf16 v[112:127], a[100:103], v[56:59], v[112:127]
    s_waitcnt vmcnt(12)
    v_mfma_f32_32x32x16_bf16 v[96:111], a[104:107], v[60:63], v[96:111]
    global_load_dwordx4 v[56:59], v7, s[42:43] offset:2048 sc1
    v_mfma_f32_32x32x16_bf16 v[112:127], a[108:111], v[60:63], v[112:127]
    s_barrier
    s_mov_b64 exec, 1
    v_mov_b32 v153, 3
    global_store_dword v152, v153, s[8:9] offset:0 sc1
    s_mov_b64 exec, -1
    s_waitcnt vmcnt(13)
    v_mfma_f32_32x32x16_bf16 v[96:111], a[112:115], v[128:131], v[96:111]
    global_load_dwordx4 v[60:63], v7, s[42:43] offset:3072 sc1
    v_add_u32 v7, 4096, v7
    v_mfma_f32_32x32x16_bf16 v[112:127], a[116:119], v[128:131], v[112:127]
    s_waitcnt vmcnt(13)
    v_mfma_f32_32x32x16_bf16 v[96:111], a[120:123], v[132:135], v[96:111]
    v_mfma_f32_32x32x16_bf16 v[112:127], a[124:127], v[132:135], v[112:127]
    s_waitcnt vmcnt(12)
    v_mfma_f32_32x32x16_bf16 v[96:111], a[128:131], v[136:139], v[96:111]
    v_mfma_f32_32x32x16_bf16 v[112:127], a[132:135], v[136:139], v[112:127]
    s_mul_i32 s14, s50, 12288
    s_add_u32 s14, s14, 13631488
    v_lshrrev_b32 v88, 6, v0
    v_mul_u32_u24 v88, 3072, v88
    v_lshl_add_u32 v88, v1, 4, v88
    v_add_u32 v88, s14, v88
    global_load_dwordx4 v[64:67], v88, s[8:9] offset:0 sc1
    global_load_dwordx4 v[68:71], v88, s[8:9] offset:1024 sc1
    global_load_dwordx4 v[72:75], v88, s[8:9] offset:2048 sc1
    s_waitcnt vmcnt(14)
    v_mfma_f32_32x32x16_bf16 v[96:111], a[136:139], v[140:143], v[96:111]
    v_mfma_f32_32x32x16_bf16 v[112:127], a[140:143], v[140:143], v[112:127]
    s_waitcnt vmcnt(13)
    v_mfma_f32_32x32x16_bf16 v[96:111], a[144:147], v[144:147], v[96:111]
    v_mfma_f32_32x32x16_bf16 v[112:127], a[148:151], v[144:147], v[112:127]
    s_waitcnt vmcnt(12)
    v_mfma_f32_32x32x16_bf16 v[96:111], a[152:155], v[148:151], v[96:111]
    v_mfma_f32_32x32x16_bf16 v[112:127], a[156:159], v[148:151], v[112:127]
    s_waitcnt vmcnt(11)
    v_mfma_f32_32x32x16_bf16 v[96:111], a[160:163], v[32:35], v[96:111]
    v_mfma_f32_32x32x16_bf16 v[112:127], a[164:167], v[32:35], v[112:127]
    v_mov_b32 v76, 0
    v_mov_b32 v77, 0
    v_mov_b32 v78, 0
    v_mov_b32 v79, 0
    v_min_u32 v90, 159, v0
    v_lshlrev_b32 v90, 4, v90
    ds_write_b128 v90, v[76:79] offset:33280
    ds_write_b128 v90, v[76:79] offset:40960
    v_bfe_u32 v90, v0, 2, 3
    v_mul_u32_u24 v90, 4160, v90
    v_and_b32 v91, 3, v0
    v_lshl_add_u32 v90, v91, 4, v90
    ds_write_b128 v90, v[76:79] offset:4096
    v_lshlrev_b32 v92, 4, v0
    s_movk_i32 s24, 255
    v_cmp_eq_u32 s[62:63], s24, v0
    s_waitcnt vmcnt(10)
    v_mfma_f32_32x32x16_bf16 v[96:111], a[168:171], v[36:39], v[96:111]
    v_mfma_f32_32x32x16_bf16 v[112:127], a[172:175], v[36:39], v[112:127]
    s_waitcnt vmcnt(9)
    v_mfma_f32_32x32x16_bf16 v[96:111], a[176:179], v[40:43], v[96:111]
    v_mfma_f32_32x32x16_bf16 v[112:127], a[180:183], v[40:43], v[112:127]
    s_waitcnt vmcnt(8)
    v_mfma_f32_32x32x16_bf16 v[96:111], a[184:187], v[44:47], v[96:111]
    v_mfma_f32_32x32x16_bf16 v[112:127], a[188:191], v[44:47], v[112:127]
    s_waitcnt vmcnt(7)
    v_mfma_f32_32x32x16_bf16 v[96:111], a[192:195], v[48:51], v[96:111]
    v_mfma_f32_32x32x16_bf16 v[112:127], a[196:199], v[48:51], v[112:127]
    s_waitcnt vmcnt(6)
    v_mfma_f32_32x32x16_bf16 v[96:111], a[200:203], v[52:55], v[96:111]
    v_mfma_f32_32x32x16_bf16 v[112:127], a[204:207], v[52:55], v[112:127]
    s_waitcnt vmcnt(5)
    v_mfma_f32_32x32x16_bf16 v[96:111], a[208:211], v[56:59], v[96:111]
    v_mfma_f32_32x32x16_bf16 v[112:127], a[212:215], v[56:59], v[112:127]
    s_waitcnt vmcnt(3)
    v_mfma_f32_32x32x16_bf16 v[96:111], a[216:219], v[60:63], v[96:111]
    v_mfma_f32_32x32x16_bf16 v[112:127], a[220:223], v[60:63], v[112:127]
    s_nop 10
    ds_write_b128 v11, v[104:107] offset:34816
    ds_write_b128 v11, v[108:111] offset:35840
    ds_write_b128 v13, v[112:115] offset:36864
    ds_write_b128 v13, v[116:119] offset:37888
    ds_write_b128 v6, v[120:123] offset:38912
    ds_write_b128 v6, v[124:127] offset:39936
    s_waitcnt lgkmcnt(0)
    s_barrier
    ds_read_b128 v[104:107], v10 offset:34816
    ds_read_b128 v[108:111], v10 offset:35840
    ds_read_b128 v[112:115], v10 offset:36864
    ds_read_b128 v[116:119], v10 offset:37888
    ds_read_b128 v[120:123], v10 offset:38912
    ds_read_b128 v[124:127], v10 offset:39936
    global_load_dword v31, v30, s[8:9] offset:0 sc1
    s_waitcnt lgkmcnt(4)
    v_pk_add_f32 v[96:97], v[96:97], v[104:105]
    v_pk_add_f32 v[98:99], v[98:99], v[106:107]
    v_pk_add_f32 v[100:101], v[100:101], v[108:109]
    v_pk_add_f32 v[102:103], v[102:103], v[110:111]
    v_lshlrev_b32 v104, 16, v24
    v_and_b32 v105, 0xffff0000, v24
    v_lshlrev_b32 v106, 16, v25
    v_and_b32 v107, 0xffff0000, v25
    v_lshlrev_b32 v108, 16, v26
    v_and_b32 v109, 0xffff0000, v26
    v_lshlrev_b32 v110, 16, v27
    v_and_b32 v111, 0xffff0000, v27
    s_waitcnt lgkmcnt(0)
    v_pk_add_f32 v[112:113], v[112:113], v[120:121]
    v_pk_add_f32 v[114:115], v[114:115], v[122:123]
    v_pk_add_f32 v[116:117], v[116:117], v[124:125]
    v_pk_add_f32 v[118:119], v[118:119], v[126:127]
    v_pk_add_f32 v[96:97], v[96:97], v[112:113]
    v_pk_add_f32 v[98:99], v[98:99], v[114:115]
    v_pk_add_f32 v[100:101], v[100:101], v[116:117]
    v_pk_add_f32 v[102:103], v[102:103], v[118:119]
    v_cvt_pk_bf16_f32 v96, 0, v96
    v_cvt_pk_bf16_f32 v97, 0, v97
    v_cvt_pk_bf16_f32 v98, 0, v98
    v_cvt_pk_bf16_f32 v99, 0, v99
    v_cvt_pk_bf16_f32 v100, 0, v100
    v_cvt_pk_bf16_f32 v101, 0, v101
    v_cvt_pk_bf16_f32 v102, 0, v102
    v_cvt_pk_bf16_f32 v103, 0, v103
    v_pk_add_f32 v[96:97], v[96:97], v[104:105]
    v_pk_add_f32 v[98:99], v[98:99], v[106:107]
    v_pk_add_f32 v[100:101], v[100:101], v[108:109]
    v_pk_add_f32 v[102:103], v[102:103], v[110:111]
    v_cvt_pk_bf16_f32 v112, v96, v97
    v_cvt_pk_bf16_f32 v113, v98, v99
    v_cvt_pk_bf16_f32 v114, v100, v101
    v_cvt_pk_bf16_f32 v115, v102, v103
    v_add_u32 v116, 0x8000, v28
    global_store_dwordx2 v28, v[112:113], s[44:45] sc1
    global_store_dwordx2 v116, v[114:115], s[44:45] sc1
    v_mov_b32 v96, 0
    v_mov_b32 v97, 0
    v_add_u32 v28, 0x2000, v28
    v_dot2c_f32_bf16 v96, s25, v112
    v_dot2c_f32_bf16 v97, v112, v112
    v_dot2c_f32_bf16 v96, s25, v113
    v_dot2c_f32_bf16 v97, v113, v113
    v_dot2c_f32_bf16 v96, s25, v114
    v_dot2c_f32_bf16 v97, v114, v114
    v_dot2c_f32_bf16 v96, s25, v115
    v_dot2c_f32_bf16 v97, v115, v115
    s_nop 2
    v_permlane32_swap_b32 v96, v97
    v_add_f32 v96, v96, v97
    ds_write_b32 v8, v96 offset:1024
    s_waitcnt vmcnt(2)
    v_cmp_gt_u32 vcc, 3, v31
    s_nop 1
    s_cbranch_vccnz pollE
pollE_ok:
    s_waitcnt lgkmcnt(0)
    s_barrier
    s_add_u32 s14, s56, 0
    v_lshlrev_b32 v5, 5, v0
    v_add_u32 v4, s14, v5
    v_add_u32 v5, 17039360, v5
    global_load_dwordx4 v[32:35], v5, s[8:9] sc1
    global_load_dwordx4 v[36:39], v5, s[8:9] offset:16 sc1
    global_load_dwordx4 v[16:19], v4, s[8:9] sc1
    global_load_dwordx4 v[20:23], v4, s[8:9] offset:16 sc1
    v_add_u32 v6, 0x2000, v4
    v_add_u32 v7, 0x2000, v5
    s_cmp_lg_u32 s10, 0
    s_cbranch_scc1 ffn_nors1
    ds_read_b32 v2, v8 offset:1024
    ds_read_b32 v3, v8 offset:1280
    ds_read_b32 v12, v8 offset:1536
    ds_read_b32 v9, v8 offset:1792
    s_waitcnt lgkmcnt(0)
    v_add_f32 v2, v2, v3
    v_add_f32 v12, v12, v9
    v_add_f32 v2, v2, v12
    global_atomic_add_f32 v29, v2, s[8:9]
    v_add_u32 v29, 0x2000, v29
ffn_nors1:
    v_cndmask_b32 v68, v68, 0, s[62:63]
    v_cndmask_b32 v69, v69, 0, s[62:63]
    ds_write_b128 v92, v[64:67] offset:0
    v_alignbit_b32 v76, v65, v64, 16
    v_alignbit_b32 v77, v66, v65, 16
    v_alignbit_b32 v78, v67, v66, 16
    v_alignbit_b32 v79, v68, v67, 16
    ds_write_b128 v92, v[76:79] offset:4160
    v_alignbit_b32 v80, v66, v65, 16
    v_alignbit_b32 v81, v67, v66, 16
    v_alignbit_b32 v82, v68, v67, 16
    v_alignbit_b32 v83, v69, v68, 16
    ds_write_b128 v92, v[80:83] offset:12480
    v_mov_b32 v84, v65
    v_mov_b32 v85, v66
    v_mov_b32 v86, v67
    v_mov_b32 v87, v68
    ds_write_b128 v92, v[84:87] offset:8320
    v_cndmask_b32 v74, v74, 0, s[62:63]
    v_cndmask_b32 v75, v75, 0, s[62:63]
    ds_write_b128 v92, v[70:73] offset:16640
    v_alignbit_b32 v76, v71, v70, 16
    v_alignbit_b32 v77, v72, v71, 16
    v_alignbit_b32 v78, v73, v72, 16
    v_alignbit_b32 v79, v74, v73, 16
    ds_write_b128 v92, v[76:79] offset:20800
    v_alignbit_b32 v80, v72, v71, 16
    v_alignbit_b32 v81, v73, v72, 16
    v_alignbit_b32 v82, v74, v73, 16
    v_alignbit_b32 v83, v75, v74, 16
    ds_write_b128 v92, v[80:83] offset:29120
    v_mov_b32 v84, v71
    v_mov_b32 v85, v72
    v_mov_b32 v86, v73
    v_mov_b32 v87, v74
    ds_write_b128 v92, v[84:87] offset:24960
    v_lshrrev_b32 v12, 3, v0
    v_and_b32 v3, 7, v0
    v_mul_u32_u24 v13, 80, v12
    v_lshl_add_u32 v13, v3, 3, v13
    v_add_u32 v13, 35840, v13
    v_mul_u32_u24 v14, 144, v12
    v_lshl_add_u32 v14, v3, 4, v14
    v_add_u32 v14, 48640, v14
    s_lshl_b32 s14, s50, 8
    s_add_u32 s14, s14, 4194304
    v_lshrrev_b32 v15, 4, v0
    v_lshlrev_b32 v15, 16, v15
    v_and_b32 v3, 15, v0
    v_lshl_add_u32 v15, v3, 3, v15
    v_add_u32 v15, s14, v15
    v_and_b32 v12, 31, v1
    v_lshrrev_b32 v3, 5, v1
    s_and_b32 s24, s10, 1
    s_lshr_b32 s15, s10, 1
    v_and_b32 v8, 3, v12
    v_sub_u32 v8, 3, v8
    v_mul_u32_u24 v8, 4160, v8
    v_and_b32 v9, 28, v12
    v_lshlrev_b32 v9, 1, v9
    v_sub_u32 v8, v8, v9
    v_lshl_add_u32 v8, v3, 4, v8
    s_mul_i32 s14, s15, 16640
    s_lshl_b32 s24, s24, 5
    s_add_u32 s14, s14, s24
    s_add_u32 s14, s14, 56
    v_add_u32 v8, s14, v8
    v_mul_u32_u24 v9, 80, v12
    v_lshl_add_u32 v9, v3, 4, v9
    s_mul_i32 s14, s15, 7680
    s_add_u32 s14, s14, s24
    s_add_u32 s14, s14, 33360
    v_add_u32 v9, s14, v9
    v_mul_u32_u24 v10, 144, v12
    v_lshl_add_u32 v10, v3, 4, v10
    s_mul_i32 s14, s10, 9216
    s_add_u32 s14, s14, 48640
    v_add_u32 v10, s14, v10
    v_add_u32 v12, 0x100000, v15
    v_mov_b32 v11, v30
    s_waitcnt vmcnt(2)
    v_pk_mul_f32 v[32:33], v[32:33], s[26:27] op_sel_hi:[1,0]
    v_pk_mul_f32 v[34:35], v[34:35], s[26:27] op_sel_hi:[1,0]
    v_pk_mul_f32 v[36:37], v[36:37], s[26:27] op_sel_hi:[1,0]
    v_pk_mul_f32 v[38:39], v[38:39], s[26:27] op_sel_hi:[1,0]
    v_fma_f32 v33, -v32, v32, v33
    v_fma_f32 v35, -v34, v34, v35
    v_fma_f32 v37, -v36, v36, v37
    v_fma_f32 v39, -v38, v38, v39
    v_max_f32 v33, 0, v33
    v_max_f32 v35, 0, v35
    v_max_f32 v37, 0, v37
    v_max_f32 v39, 0, v39
    v_cvt_pk_bf16_f32 v33, 0, v33
    v_cvt_pk_bf16_f32 v35, 0, v35
    v_cvt_pk_bf16_f32 v37, 0, v37
    v_cvt_pk_bf16_f32 v39, 0, v39
    v_add_f32 v33, s27, v33
    v_add_f32 v35, s27, v35
    v_add_f32 v37, s27, v37
    v_add_f32 v39, s27, v39
    v_cvt_pk_bf16_f32 v33, 0, v33
    v_cvt_pk_bf16_f32 v35, 0, v35
    v_cvt_pk_bf16_f32 v37, 0, v37
    v_cvt_pk_bf16_f32 v39, 0, v39
    v_sqrt_f32 v33, v33
    v_sqrt_f32 v35, v35
    v_sqrt_f32 v37, v37
    v_sqrt_f32 v39, v39
    v_cvt_pk_bf16_f32 v32, 0, v32
    v_cvt_pk_bf16_f32 v34, 0, v34
    v_cvt_pk_bf16_f32 v36, 0, v36
    v_cvt_pk_bf16_f32 v38, 0, v38
    v_cvt_pk_bf16_f32 v33, 0, v33
    v_cvt_pk_bf16_f32 v35, 0, v35
    v_cvt_pk_bf16_f32 v37, 0, v37
    v_cvt_pk_bf16_f32 v39, 0, v39
    v_rcp_f32 v33, v33
    v_rcp_f32 v35, v35
    v_rcp_f32 v37, v37
    v_rcp_f32 v39, v39
    s_waitcnt vmcnt(0)
    v_lshlrev_b32 v96, 16, v16
    v_and_b32 v97, 0xffff0000, v16
    v_lshlrev_b32 v98, 16, v18
    v_and_b32 v99, 0xffff0000, v18
    v_lshlrev_b32 v100, 16, v20
    v_and_b32 v101, 0xffff0000, v20
    v_lshlrev_b32 v102, 16, v22
    v_and_b32 v103, 0xffff0000, v22
    v_pk_add_f32 v[112:113], v[96:97], v[32:33] op_sel:[0,0] op_sel_hi:[1,0] neg_lo:[0,1] neg_hi:[0,1]
    v_pk_add_f32 v[114:115], v[98:99], v[34:35] op_sel:[0,0] op_sel_hi:[1,0] neg_lo:[0,1] neg_hi:[0,1]
    v_pk_add_f32 v[116:117], v[100:101], v[36:37] op_sel:[0,0] op_sel_hi:[1,0] neg_lo:[0,1] neg_hi:[0,1]
    v_pk_add_f32 v[118:119], v[102:103], v[38:39] op_sel:[0,0] op_sel_hi:[1,0] neg_lo:[0,1] neg_hi:[0,1]
    v_cvt_pk_bf16_f32 v112, 0, v112
    v_cvt_pk_bf16_f32 v113, 0, v113
    v_cvt_pk_bf16_f32 v114, 0, v114
    v_cvt_pk_bf16_f32 v115, 0, v115
    v_cvt_pk_bf16_f32 v116, 0, v116
    v_cvt_pk_bf16_f32 v117, 0, v117
    v_cvt_pk_bf16_f32 v118, 0, v118
    v_cvt_pk_bf16_f32 v119, 0, v119
    v_pk_mul_f32 v[112:113], v[112:113], v[32:33] op_sel:[0,1] op_sel_hi:[1,1]
    v_pk_mul_f32 v[114:115], v[114:115], v[34:35] op_sel:[0,1] op_sel_hi:[1,1]
    v_pk_mul_f32 v[116:117], v[116:117], v[36:37] op_sel:[0,1] op_sel_hi:[1,1]
    v_pk_mul_f32 v[118:119], v[118:119], v[38:39] op_sel:[0,1] op_sel_hi:[1,1]
    v_cvt_pk_bf16_f32 v112, 0, v112
    v_cvt_pk_bf16_f32 v113, 0, v113
    v_cvt_pk_bf16_f32 v114, 0, v114
    v_cvt_pk_bf16_f32 v115, 0, v115
    v_cvt_pk_bf16_f32 v116, 0, v116
    v_cvt_pk_bf16_f32 v117, 0, v117
    v_cvt_pk_bf16_f32 v118, 0, v118
    v_cvt_pk_bf16_f32 v119, 0, v119
    v_cvt_pk_f16_f32 v20, v112, v114
    v_cvt_pk_f16_f32 v21, v116, v118
    v_cvt_pk_f16_f32 v22, v113, v115
    v_cvt_pk_f16_f32 v23, v117, v119
    ds_write_b64 v13, v[20:21] offset:0
    ds_write_b64 v13, v[22:23] offset:7680
    s_waitcnt vmcnt(0)
    s_waitcnt lgkmcnt(0)
    s_barrier
    s_mov_b64 exec, 1
    v_mov_b32 v153, 4
    global_store_dword v152, v153, s[8:9] offset:0 sc1
    s_mov_b64 exec, -1
    ds_read_b64 v[128:129], v8 offset:4032
    ds_read_b64 v[130:131], v8 offset:4040
    ds_read_b128 v[132:135], v9 offset:2480
    ds_read_b64 v[136:137], v8 offset:3968
    ds_read_b64 v[138:139], v8 offset:3976
    ds_read_b128 v[140:143], v9 offset:2400
    ds_read_b64 v[144:145], v8 offset:3904
    ds_read_b64 v[146:147], v8 offset:3912
    ds_read_b128 v[148:151], v9 offset:2320
    ds_read_b64 v[48:49], v8 offset:3840
    ds_read_b64 v[50:51], v8 offset:3848
    ds_read_b128 v[52:55], v9 offset:2240
    s_waitcnt lgkmcnt(9)
    v_mfma_f32_32x32x16_f16 v[64:79], v[128:131], v[132:135], 0
    ds_read_b64 v[56:57], v8 offset:3776
    ds_read_b64 v[58:59], v8 offset:3784
    ds_read_b128 v[60:63], v9 offset:2160
    v_mul_f32 v112, s52, v112
    v_mul_f32 v113, s53, v113
    s_waitcnt lgkmcnt(9)
    v_mfma_f32_32x32x16_f16 v[64:79], v[136:139], v[140:143], v[64:79]
    ds_read_b64 v[128:129], v8 offset:3712
    ds_read_b64 v[130:131], v8 offset:3720
    ds_read_b128 v[132:135], v9 offset:2080
    v_mul_f32 v114, s52, v114
    v_mul_f32 v115, s53, v115
    s_waitcnt lgkmcnt(9)
    v_mfma_f32_32x32x16_f16 v[64:79], v[144:147], v[148:151], v[64:79]
    ds_read_b64 v[136:137], v8 offset:3648
    ds_read_b64 v[138:139], v8 offset:3656
    ds_read_b128 v[140:143], v9 offset:2000
    v_mul_f32 v116, s52, v116
    v_mul_f32 v117, s53, v117
    s_waitcnt lgkmcnt(9)
    v_mfma_f32_32x32x16_f16 v[64:79], v[48:51], v[52:55], v[64:79]
    ds_read_b64 v[144:145], v8 offset:3584
    ds_read_b64 v[146:147], v8 offset:3592
    ds_read_b128 v[148:151], v9 offset:1920
    v_mul_f32 v118, s52, v118
    v_mul_f32 v119, s53, v119
    s_waitcnt lgkmcnt(9)
    v_mfma_f32_32x32x16_f16 v[64:79], v[56:59], v[60:63], v[64:79]
    ds_read_b64 v[48:49], v8 offset:3520
    ds_read_b64 v[50:51], v8 offset:3528
    ds_read_b128 v[52:55], v9 offset:1840
    v_cvt_pk_bf16_f32 v112, 0, v112
    v_cvt_pk_bf16_f32 v113, 0, v113
    s_waitcnt lgkmcnt(9)
    v_mfma_f32_32x32x16_f16 v[64:79], v[128:131], v[132:135], v[64:79]
    ds_read_b64 v[56:57], v8 offset:3456
    ds_read_b64 v[58:59], v8 offset:3464
    ds_read_b128 v[60:63], v9 offset:1760
    v_cvt_pk_bf16_f32 v114, 0, v114
    v_cvt_pk_bf16_f32 v115, 0, v115
    s_waitcnt lgkmcnt(9)
    v_mfma_f32_32x32x16_f16 v[64:79], v[136:139], v[140:143], v[64:79]
    ds_read_b64 v[128:129], v8 offset:3392
    ds_read_b64 v[130:131], v8 offset:3400
    ds_read_b128 v[132:135], v9 offset:1680
    v_cvt_pk_bf16_f32 v116, 0, v116
    v_cvt_pk_bf16_f32 v117, 0, v117
    s_waitcnt lgkmcnt(9)
    v_mfma_f32_32x32x16_f16 v[64:79], v[144:147], v[148:151], v[64:79]
    ds_read_b64 v[136:137], v8 offset:3328
    ds_read_b64 v[138:139], v8 offset:3336
    ds_read_b128 v[140:143], v9 offset:1600
    v_cvt_pk_bf16_f32 v118, 0, v118
    v_cvt_pk_bf16_f32 v119, 0, v119
    s_waitcnt lgkmcnt(9)
    v_mfma_f32_32x32x16_f16 v[64:79], v[48:51], v[52:55], v[64:79]
    ds_read_b64 v[144:145], v8 offset:3264
    ds_read_b64 v[146:147], v8 offset:3272
    ds_read_b128 v[148:151], v9 offset:1520
    s_waitcnt lgkmcnt(9)
    v_mfma_f32_32x32x16_f16 v[64:79], v[56:59], v[60:63], v[64:79]
    ds_read_b64 v[48:49], v8 offset:3200
    ds_read_b64 v[50:51], v8 offset:3208
    ds_read_b128 v[52:55], v9 offset:1440
    s_waitcnt lgkmcnt(9)
    v_mfma_f32_32x32x16_f16 v[64:79], v[128:131], v[132:135], v[64:79]
    ds_read_b64 v[56:57], v8 offset:3136
    ds_read_b64 v[58:59], v8 offset:3144
    ds_read_b128 v[60:63], v9 offset:1360
    s_waitcnt lgkmcnt(9)
    v_mfma_f32_32x32x16_f16 v[64:79], v[136:139], v[140:143], v[64:79]
    ds_read_b64 v[128:129], v8 offset:3072
    ds_read_b64 v[130:131], v8 offset:3080
    ds_read_b128 v[132:135], v9 offset:1280
    s_waitcnt lgkmcnt(9)
    v_mfma_f32_32x32x16_f16 v[64:79], v[144:147], v[148:151], v[64:79]
    ds_read_b64 v[136:137], v8 offset:3008
    ds_read_b64 v[138:139], v8 offset:3016
    ds_read_b128 v[140:143], v9 offset:1200
    s_waitcnt lgkmcnt(9)
    v_mfma_f32_32x32x16_f16 v[64:79], v[48:51], v[52:55], v[64:79]
    ds_read_b64 v[144:145], v8 offset:2944
    ds_read_b64 v[146:147], v8 offset:2952
    ds_read_b128 v[148:151], v9 offset:1120
    s_waitcnt lgkmcnt(9)
    v_mfma_f32_32x32x16_f16 v[64:79], v[56:59], v[60:63], v[64:79]
    ds_read_b64 v[48:49], v8 offset:2880
    ds_read_b64 v[50:51], v8 offset:2888
    ds_read_b128 v[52:55], v9 offset:1040
    s_waitcnt lgkmcnt(9)
    v_mfma_f32_32x32x16_f16 v[64:79], v[128:131], v[132:135], v[64:79]
    ds_read_b64 v[56:57], v8 offset:2816
    ds_read_b64 v[58:59], v8 offset:2824
    ds_read_b128 v[60:63], v9 offset:960
    s_waitcnt lgkmcnt(9)
    v_mfma_f32_32x32x16_f16 v[64:79], v[136:139], v[140:143], v[64:79]
    ds_read_b64 v[128:129], v8 offset:2752
    ds_read_b64 v[130:131], v8 offset:2760
    ds_read_b128 v[132:135], v9 offset:880
    s_waitcnt lgkmcnt(9)
    v_mfma_f32_32x32x16_f16 v[64:79], v[144:147], v[148:151], v[64:79]
    ds_read_b64 v[136:137], v8 offset:2688
    ds_read_b64 v[138:139], v8 offset:2696
    ds_read_b128 v[140:143], v9 offset:800
    s_waitcnt lgkmcnt(9)
    v_mfma_f32_32x32x16_f16 v[64:79], v[48:51], v[52:55], v[64:79]
    ds_read_b64 v[144:145], v8 offset:2624
    ds_read_b64 v[146:147], v8 offset:2632
    ds_read_b128 v[148:151], v9 offset:720
    s_waitcnt lgkmcnt(9)
    v_mfma_f32_32x32x16_f16 v[64:79], v[56:59], v[60:63], v[64:79]
    ds_read_b64 v[48:49], v8 offset:2560
    ds_read_b64 v[50:51], v8 offset:2568
    ds_read_b128 v[52:55], v9 offset:640
    s_waitcnt lgkmcnt(9)
    v_mfma_f32_32x32x16_f16 v[64:79], v[128:131], v[132:135], v[64:79]
    ds_read_b64 v[56:57], v8 offset:2496
    ds_read_b64 v[58:59], v8 offset:2504
    ds_read_b128 v[60:63], v9 offset:560
    s_waitcnt lgkmcnt(9)
    v_mfma_f32_32x32x16_f16 v[64:79], v[136:139], v[140:143], v[64:79]
    ds_read_b64 v[128:129], v8 offset:2432
    ds_read_b64 v[130:131], v8 offset:2440
    ds_read_b128 v[132:135], v9 offset:480
    s_waitcnt lgkmcnt(9)
    v_mfma_f32_32x32x16_f16 v[64:79], v[144:147], v[148:151], v[64:79]
    ds_read_b64 v[136:137], v8 offset:2368
    ds_read_b64 v[138:139], v8 offset:2376
    ds_read_b128 v[140:143], v9 offset:400
    s_waitcnt lgkmcnt(9)
    v_mfma_f32_32x32x16_f16 v[64:79], v[48:51], v[52:55], v[64:79]
    ds_read_b64 v[144:145], v8 offset:2304
    ds_read_b64 v[146:147], v8 offset:2312
    ds_read_b128 v[148:151], v9 offset:320
    s_waitcnt lgkmcnt(9)
    v_mfma_f32_32x32x16_f16 v[64:79], v[56:59], v[60:63], v[64:79]
    ds_read_b64 v[48:49], v8 offset:2240
    ds_read_b64 v[50:51], v8 offset:2248
    ds_read_b128 v[52:55], v9 offset:240
    s_waitcnt lgkmcnt(9)
    v_mfma_f32_32x32x16_f16 v[64:79], v[128:131], v[132:135], v[64:79]
    ds_read_b64 v[56:57], v8 offset:2176
    ds_read_b64 v[58:59], v8 offset:2184
    ds_read_b128 v[60:63], v9 offset:160
    s_waitcnt lgkmcnt(9)
    v_mfma_f32_32x32x16_f16 v[64:79], v[136:139], v[140:143], v[64:79]
    ds_read_b64 v[128:129], v8 offset:2112
    ds_read_b64 v[130:131], v8 offset:2120
    ds_read_b128 v[132:135], v9 offset:80
    global_load_dword v3, v11, s[8:9] offset:0 sc1
    s_waitcnt lgkmcnt(9)
    v_mfma_f32_32x32x16_f16 v[64:79], v[144:147], v[148:151], v[64:79]
    ds_read_b64 v[136:137], v8 offset:2048
    ds_read_b64 v[138:139], v8 offset:2056
    ds_read_b128 v[140:143], v9 offset:0
    s_waitcnt lgkmcnt(9)
    v_mfma_f32_32x32x16_f16 v[64:79], v[48:51], v[52:55], v[64:79]
    ds_read_b64 v[144:145], v8 offset:1984
    ds_read_b64 v[146:147], v8 offset:1992
    ds_read_b128 v[148:151], v9 offset:2480
    s_waitcnt lgkmcnt(9)
    v_mfma_f32_32x32x16_f16 v[64:79], v[56:59], v[60:63], v[64:79]
    ds_read_b64 v[48:49], v8 offset:1920
    ds_read_b64 v[50:51], v8 offset:1928
    ds_read_b128 v[52:55], v9 offset:2400
    s_waitcnt lgkmcnt(9)
    v_mfma_f32_32x32x16_f16 v[64:79], v[128:131], v[132:135], v[64:79]
    ds_read_b64 v[56:57], v8 offset:1856
    ds_read_b64 v[58:59], v8 offset:1864
    ds_read_b128 v[60:63], v9 offset:2320
    s_waitcnt lgkmcnt(9)
    v_mfma_f32_32x32x16_f16 v[64:79], v[136:139], v[140:143], v[64:79]
    ds_read_b64 v[128:129], v8 offset:1792
    ds_read_b64 v[130:131], v8 offset:1800
    ds_read_b128 v[132:135], v9 offset:2240
    s_waitcnt lgkmcnt(9)
    v_mfma_f32_32x32x16_f16 v[80:95], v[144:147], v[148:151], 0
    ds_read_b64 v[136:137], v8 offset:1728
    ds_read_b64 v[138:139], v8 offset:1736
    ds_read_b128 v[140:143], v9 offset:2160
    s_waitcnt lgkmcnt(9)
    v_mfma_f32_32x32x16_f16 v[80:95], v[48:51], v[52:55], v[80:95]
    ds_read_b64 v[144:145], v8 offset:1664
    ds_read_b64 v[146:147], v8 offset:1672
    ds_read_b128 v[148:151], v9 offset:2080
    ds_write_b128 v10, v[64:67] offset:0
    ds_write_b128 v10, v[68:71] offset:32
    s_waitcnt lgkmcnt(9)
    v_mfma_f32_32x32x16_f16 v[80:95], v[56:59], v[60:63], v[80:95]
    ds_read_b64 v[48:49], v8 offset:1600
    ds_read_b64 v[50:51], v8 offset:1608
    ds_read_b128 v[52:55], v9 offset:2000
    ds_write_b128 v10, v[72:75] offset:64
    ds_write_b128 v10, v[76:79] offset:96
    s_waitcnt lgkmcnt(9)
    v_mfma_f32_32x32x16_f16 v[80:95], v[128:131], v[132:135], v[80:95]
    ds_read_b64 v[56:57], v8 offset:1536
    ds_read_b64 v[58:59], v8 offset:1544
    ds_read_b128 v[60:63], v9 offset:1920
    s_waitcnt lgkmcnt(9)
    v_mfma_f32_32x32x16_f16 v[80:95], v[136:139], v[140:143], v[80:95]
    ds_read_b64 v[128:129], v8 offset:1472
    ds_read_b64 v[130:131], v8 offset:1480
    ds_read_b128 v[132:135], v9 offset:1840
    s_waitcnt vmcnt(0)
    v_cmp_gt_u32 vcc, 4, v3
    s_nop 1
    s_cbranch_vccnz pollL
pollL_ok:
    s_waitcnt lgkmcnt(0)
    s_barrier
    ds_read_b128 v[16:19], v14 offset:0
    ds_read_b128 v[20:23], v14 offset:9216
    ds_read_b128 v[32:35], v14 offset:18432
    ds_read_b128 v[36:39], v14 offset:27648
    global_load_dwordx4 v[40:43], v7, s[8:9] sc1
    global_load_dwordx4 v[44:47], v7, s[8:9] offset:16 sc1
    global_load_dwordx4 v[24:27], v6, s[8:9] sc1
    global_load_dwordx4 v[28:31], v6, s[8:9] offset:16 sc1
    s_waitcnt lgkmcnt(9)
    v_mfma_f32_32x32x16_f16 v[80:95], v[144:147], v[148:151], v[80:95]
    ds_read_b64 v[136:137], v8 offset:1408
    ds_read_b64 v[138:139], v8 offset:1416
    ds_read_b128 v[140:143], v9 offset:1760
    s_waitcnt lgkmcnt(9)
    v_mfma_f32_32x32x16_f16 v[80:95], v[48:51], v[52:55], v[80:95]
    ds_read_b64 v[144:145], v8 offset:1344
    ds_read_b64 v[146:147], v8 offset:1352
    ds_read_b128 v[148:151], v9 offset:1680
    s_waitcnt lgkmcnt(6)
    v_add_f32 v16, v16, v20
    v_add_f32 v17, v17, v21
    v_add_f32 v18, v18, v22
    v_add_f32 v19, v19, v23
    v_mul_f32 v16, s54, v16
    s_waitcnt lgkmcnt(9)
    v_mfma_f32_32x32x16_f16 v[80:95], v[56:59], v[60:63], v[80:95]
    ds_read_b64 v[48:49], v8 offset:1280
    ds_read_b64 v[50:51], v8 offset:1288
    ds_read_b128 v[52:55], v9 offset:1600
    v_mul_f32 v17, s54, v17
    v_mul_f32 v18, s54, v18
    v_mul_f32 v19, s54, v19
    v_cvt_pk_bf16_f32 v16, 0, v16
    v_cvt_pk_bf16_f32 v17, 0, v17
    s_waitcnt lgkmcnt(9)
    v_mfma_f32_32x32x16_f16 v[80:95], v[128:131], v[132:135], v[80:95]
    ds_read_b64 v[56:57], v8 offset:1216
    ds_read_b64 v[58:59], v8 offset:1224
    ds_read_b128 v[60:63], v9 offset:1520
    v_cvt_pk_bf16_f32 v18, 0, v18
    v_cvt_pk_bf16_f32 v19, 0, v19
    v_add_f32 v16, v16, v112
    v_add_f32 v17, v17, v114
    v_add_f32 v18, v18, v116
    s_waitcnt lgkmcnt(9)
    v_mfma_f32_32x32x16_f16 v[80:95], v[136:139], v[140:143], v[80:95]
    ds_read_b64 v[128:129], v8 offset:1152
    ds_read_b64 v[130:131], v8 offset:1160
    ds_read_b128 v[132:135], v9 offset:1440
    v_add_f32 v19, v19, v118
    v_cvt_pk_bf16_f32 v16, 0, v16
    v_cvt_pk_bf16_f32 v17, 0, v17
    v_cvt_pk_bf16_f32 v18, 0, v18
    v_cvt_pk_bf16_f32 v19, 0, v19
    s_waitcnt lgkmcnt(9)
    v_mfma_f32_32x32x16_f16 v[80:95], v[144:147], v[148:151], v[80:95]
    ds_read_b64 v[136:137], v8 offset:1088
    ds_read_b64 v[138:139], v8 offset:1096
    ds_read_b128 v[140:143], v9 offset:1360
    v_add_f32 v16, v16, v96
    v_add_f32 v17, v17, v98
    v_add_f32 v18, v18, v100
    v_add_f32 v19, v19, v102
    v_cvt_pk_bf16_f32 v20, v16, v17
    s_waitcnt lgkmcnt(9)
    v_mfma_f32_32x32x16_f16 v[80:95], v[48:51], v[52:55], v[80:95]
    ds_read_b64 v[144:145], v8 offset:1024
    ds_read_b64 v[146:147], v8 offset:1032
    ds_read_b128 v[148:151], v9 offset:1280
    v_cvt_pk_bf16_f32 v21, v18, v19
    global_store_dwordx2 v15, v[20:21], s[8:9] offset:0 sc1
    v_add_f32 v32, v32, v36
    v_add_f32 v33, v33, v37
    v_add_f32 v34, v34, v38
    s_waitcnt lgkmcnt(9)
    v_mfma_f32_32x32x16_f16 v[80:95], v[56:59], v[60:63], v[80:95]
    ds_read_b64 v[48:49], v8 offset:960
    ds_read_b64 v[50:51], v8 offset:968
    ds_read_b128 v[52:55], v9 offset:1200
    v_add_f32 v35, v35, v39
    v_mul_f32 v32, s55, v32
    v_mul_f32 v33, s55, v33
    v_mul_f32 v34, s55, v34
    v_mul_f32 v35, s55, v35
    s_waitcnt lgkmcnt(9)
    v_mfma_f32_32x32x16_f16 v[80:95], v[128:131], v[132:135], v[80:95]
    ds_read_b64 v[56:57], v8 offset:896
    ds_read_b64 v[58:59], v8 offset:904
    ds_read_b128 v[60:63], v9 offset:1120
    v_cvt_pk_bf16_f32 v32, 0, v32
    v_cvt_pk_bf16_f32 v33, 0, v33
    v_cvt_pk_bf16_f32 v34, 0, v34
    v_cvt_pk_bf16_f32 v35, 0, v35
    v_add_f32 v32, v32, v113
    s_waitcnt lgkmcnt(9)
    v_mfma_f32_32x32x16_f16 v[80:95], v[136:139], v[140:143], v[80:95]
    ds_read_b64 v[128:129], v8 offset:832
    ds_read_b64 v[130:131], v8 offset:840
    ds_read_b128 v[132:135], v9 offset:1040
    v_add_f32 v33, v33, v115
    v_add_f32 v34, v34, v117
    v_add_f32 v35, v35, v119
    v_cvt_pk_bf16_f32 v32, 0, v32
    v_cvt_pk_bf16_f32 v33, 0, v33
    s_waitcnt lgkmcnt(9)
    v_mfma_f32_32x32x16_f16 v[80:95], v[144:147], v[148:151], v[80:95]
    ds_read_b64 v[136:137], v8 offset:768
    ds_read_b64 v[138:139], v8 offset:776
    ds_read_b128 v[140:143], v9 offset:960
    v_cvt_pk_bf16_f32 v34, 0, v34
    v_cvt_pk_bf16_f32 v35, 0, v35
    v_add_f32 v32, v32, v97
    v_add_f32 v33, v33, v99
    v_add_f32 v34, v34, v101
    s_waitcnt lgkmcnt(9)
    v_mfma_f32_32x32x16_f16 v[80:95], v[48:51], v[52:55], v[80:95]
    ds_read_b64 v[144:145], v8 offset:704
    ds_read_b64 v[146:147], v8 offset:712
    ds_read_b128 v[148:151], v9 offset:880
    v_add_f32 v35, v35, v103
    v_cvt_pk_bf16_f32 v36, v32, v33
    v_cvt_pk_bf16_f32 v37, v34, v35
    global_store_dwordx2 v15, v[36:37], s[8:9] offset:128 sc1
    s_waitcnt lgkmcnt(9)
    v_mfma_f32_32x32x16_f16 v[80:95], v[56:59], v[60:63], v[80:95]
    ds_read_b64 v[48:49], v8 offset:640
    ds_read_b64 v[50:51], v8 offset:648
    ds_read_b128 v[52:55], v9 offset:800
    s_waitcnt lgkmcnt(9)
    v_mfma_f32_32x32x16_f16 v[80:95], v[128:131], v[132:135], v[80:95]
    ds_read_b64 v[56:57], v8 offset:576
    ds_read_b64 v[58:59], v8 offset:584
    ds_read_b128 v[60:63], v9 offset:720
    s_waitcnt lgkmcnt(9)
    v_mfma_f32_32x32x16_f16 v[80:95], v[136:139], v[140:143], v[80:95]
    ds_read_b64 v[128:129], v8 offset:512
    ds_read_b64 v[130:131], v8 offset:520
    ds_read_b128 v[132:135], v9 offset:640
    s_waitcnt lgkmcnt(9)
    v_mfma_f32_32x32x16_f16 v[80:95], v[144:147], v[148:151], v[80:95]
    ds_read_b64 v[136:137], v8 offset:448
    ds_read_b64 v[138:139], v8 offset:456
    ds_read_b128 v[140:143], v9 offset:560
    s_waitcnt lgkmcnt(9)
    v_mfma_f32_32x32x16_f16 v[80:95], v[48:51], v[52:55], v[80:95]
    ds_read_b64 v[144:145], v8 offset:384
    ds_read_b64 v[146:147], v8 offset:392
    ds_read_b128 v[148:151], v9 offset:480
    s_waitcnt lgkmcnt(9)
    v_mfma_f32_32x32x16_f16 v[80:95], v[56:59], v[60:63], v[80:95]
    ds_read_b64 v[48:49], v8 offset:320
    ds_read_b64 v[50:51], v8 offset:328
    ds_read_b128 v[52:55], v9 offset:400
    s_waitcnt lgkmcnt(9)
    v_mfma_f32_32x32x16_f16 v[80:95], v[128:131], v[132:135], v[80:95]
    ds_read_b64 v[56:57], v8 offset:256
    ds_read_b64 v[58:59], v8 offset:264
    ds_read_b128 v[60:63], v9 offset:320
    s_waitcnt lgkmcnt(9)
    v_mfma_f32_32x32x16_f16 v[80:95], v[136:139], v[140:143], v[80:95]
    ds_read_b64 v[128:129], v8 offset:192
    ds_read_b64 v[130:131], v8 offset:200
    ds_read_b128 v[132:135], v9 offset:240
    s_waitcnt lgkmcnt(9)
    v_mfma_f32_32x32x16_f16 v[80:95], v[144:147], v[148:151], v[80:95]
    ds_read_b64 v[136:137], v8 offset:128
    ds_read_b64 v[138:139], v8 offset:136
    ds_read_b128 v[140:143], v9 offset:160
    s_waitcnt lgkmcnt(9)
    v_mfma_f32_32x32x16_f16 v[80:95], v[48:51], v[52:55], v[80:95]
    ds_read_b64 v[144:145], v8 offset:64
    ds_read_b64 v[146:147], v8 offset:72
    ds_read_b128 v[148:151], v9 offset:80
    s_waitcnt lgkmcnt(9)
    v_mfma_f32_32x32x16_f16 v[80:95], v[56:59], v[60:63], v[80:95]
    ds_read_b64 v[48:49], v8 offset:0
    ds_read_b64 v[50:51], v8 offset:8
    ds_read_b128 v[52:55], v9 offset:0
    s_waitcnt lgkmcnt(9)
    v_mfma_f32_32x32x16_f16 v[80:95], v[128:131], v[132:135], v[80:95]
    s_waitcnt lgkmcnt(6)
    v_mfma_f32_32x32x16_f16 v[80:95], v[136:139], v[140:143], v[80:95]
    s_waitcnt lgkmcnt(3)
    v_mfma_f32_32x32x16_f16 v[80:95], v[144:147], v[148:151], v[80:95]
    s_waitcnt lgkmcnt(0)
    v_mfma_f32_32x32x16_f16 v[80:95], v[48:51], v[52:55], v[80:95]
    s_waitcnt vmcnt(4)
    v_pk_mul_f32 v[40:41], v[40:41], s[26:27] op_sel_hi:[1,0]
    v_pk_mul_f32 v[42:43], v[42:43], s[26:27] op_sel_hi:[1,0]
    v_pk_mul_f32 v[44:45], v[44:45], s[26:27] op_sel_hi:[1,0]
    v_pk_mul_f32 v[46:47], v[46:47], s[26:27] op_sel_hi:[1,0]
    v_fma_f32 v41, -v40, v40, v41
    v_fma_f32 v43, -v42, v42, v43
    v_fma_f32 v45, -v44, v44, v45
    v_fma_f32 v47, -v46, v46, v47
    v_max_f32 v41, 0, v41
    v_max_f32 v43, 0, v43
    v_max_f32 v45, 0, v45
    v_max_f32 v47, 0, v47
    v_cvt_pk_bf16_f32 v41, 0, v41
    v_cvt_pk_bf16_f32 v43, 0, v43
    v_cvt_pk_bf16_f32 v45, 0, v45
    v_cvt_pk_bf16_f32 v47, 0, v47
    v_add_f32 v41, s27, v41
    v_add_f32 v43, s27, v43
    v_add_f32 v45, s27, v45
    v_add_f32 v47, s27, v47
    v_cvt_pk_bf16_f32 v41, 0, v41
    v_cvt_pk_bf16_f32 v43, 0, v43
    v_cvt_pk_bf16_f32 v45, 0, v45
    v_cvt_pk_bf16_f32 v47, 0, v47
    v_sqrt_f32 v41, v41
    v_sqrt_f32 v43, v43
    v_sqrt_f32 v45, v45
    v_sqrt_f32 v47, v47
    v_cvt_pk_bf16_f32 v40, 0, v40
    v_cvt_pk_bf16_f32 v42, 0, v42
    v_cvt_pk_bf16_f32 v44, 0, v44
    v_cvt_pk_bf16_f32 v46, 0, v46
    v_cvt_pk_bf16_f32 v41, 0, v41
    v_cvt_pk_bf16_f32 v43, 0, v43
    v_cvt_pk_bf16_f32 v45, 0, v45
    v_cvt_pk_bf16_f32 v47, 0, v47
    v_rcp_f32 v41, v41
    v_rcp_f32 v43, v43
    v_rcp_f32 v45, v45
    v_rcp_f32 v47, v47
    s_waitcnt vmcnt(2)
    s_waitcnt vmcnt(0)
    s_barrier
    s_mov_b64 exec, 1
    v_mov_b32 v153, 5
    global_store_dword v152, v153, s[8:9] offset:0 sc1
    s_mov_b64 exec, -1
    v_lshlrev_b32 v104, 16, v24
    v_and_b32 v105, 0xffff0000, v24
    v_lshlrev_b32 v106, 16, v26
    v_and_b32 v107, 0xffff0000, v26
    v_lshlrev_b32 v108, 16, v28
    v_and_b32 v109, 0xffff0000, v28
    v_lshlrev_b32 v110, 16, v30
    v_and_b32 v111, 0xffff0000, v30
    v_pk_add_f32 v[120:121], v[104:105], v[40:41] op_sel:[0,0] op_sel_hi:[1,0] neg_lo:[0,1] neg_hi:[0,1]
    v_pk_add_f32 v[122:123], v[106:107], v[42:43] op_sel:[0,0] op_sel_hi:[1,0] neg_lo:[0,1] neg_hi:[0,1]
    v_pk_add_f32 v[124:125], v[108:109], v[44:45] op_sel:[0,0] op_sel_hi:[1,0] neg_lo:[0,1] neg_hi:[0,1]
    v_pk_add_f32 v[126:127], v[110:111], v[46:47] op_sel:[0,0] op_sel_hi:[1,0] neg_lo:[0,1] neg_hi:[0,1]
    v_cvt_pk_bf16_f32 v120, 0, v120
    v_cvt_pk_bf16_f32 v121, 0, v121
    v_cvt_pk_bf16_f32 v122, 0, v122
    v_cvt_pk_bf16_f32 v123, 0, v123
    v_cvt_pk_bf16_f32 v124, 0, v124
    v_cvt_pk_bf16_f32 v125, 0, v125
    v_cvt_pk_bf16_f32 v126, 0, v126
    v_cvt_pk_bf16_f32 v127, 0, v127
    v_pk_mul_f32 v[120:121], v[120:121], v[40:41] op_sel:[0,1] op_sel_hi:[1,1]
    v_pk_mul_f32 v[122:123], v[122:123], v[42:43] op_sel:[0,1] op_sel_hi:[1,1]
    v_pk_mul_f32 v[124:125], v[124:125], v[44:45] op_sel:[0,1] op_sel_hi:[1,1]
    v_pk_mul_f32 v[126:127], v[126:127], v[46:47] op_sel:[0,1] op_sel_hi:[1,1]
    v_cvt_pk_bf16_f32 v120, 0, v120
    v_cvt_pk_bf16_f32 v121, 0, v121
    v_cvt_pk_bf16_f32 v122, 0, v122
    v_cvt_pk_bf16_f32 v123, 0, v123
    v_cvt_pk_bf16_f32 v124, 0, v124
    v_cvt_pk_bf16_f32 v125, 0, v125
    v_cvt_pk_bf16_f32 v126, 0, v126
    v_cvt_pk_bf16_f32 v127, 0, v127
    v_cvt_pk_f16_f32 v28, v120, v122
    v_cvt_pk_f16_f32 v29, v124, v126
    v_cvt_pk_f16_f32 v30, v121, v123
    v_cvt_pk_f16_f32 v31, v125, v127
    ds_write_b64 v13, v[28:29] offset:2560
    ds_write_b64 v13, v[30:31] offset:10240
    s_waitcnt lgkmcnt(0)
    s_barrier
    ds_read_b64 v[56:57], v8 offset:4032
    ds_read_b64 v[58:59], v8 offset:4040
    ds_read_b128 v[60:63], v9 offset:5040
    ds_read_b64 v[128:129], v8 offset:3968
    ds_read_b64 v[130:131], v8 offset:3976
    ds_read_b128 v[132:135], v9 offset:4960
    ds_read_b64 v[136:137], v8 offset:3904
    ds_read_b64 v[138:139], v8 offset:3912
    ds_read_b128 v[140:143], v9 offset:4880
    ds_read_b64 v[144:145], v8 offset:3840
    ds_read_b64 v[146:147], v8 offset:3848
    ds_read_b128 v[148:151], v9 offset:4800
    s_waitcnt lgkmcnt(9)
    v_mfma_f32_32x32x16_f16 v[80:95], v[56:59], v[60:63], v[80:95]
    ds_read_b64 v[48:49], v8 offset:3776
    ds_read_b64 v[50:51], v8 offset:3784
    ds_read_b128 v[52:55], v9 offset:4720
    v_lshrrev_b32 v2, 2, v1
    v_lshlrev_b32 v13, 9, v2
    s_waitcnt lgkmcnt(9)
    v_mfma_f32_32x32x16_f16 v[80:95], v[128:131], v[132:135], v[80:95]
    ds_read_b64 v[56:57], v8 offset:3712
    ds_read_b64 v[58:59], v8 offset:3720
    ds_read_b128 v[60:63], v9 offset:4640
    v_and_b32 v2, 3, v1
    v_lshl_add_u32 v13, v2, 5, v13
    s_waitcnt lgkmcnt(9)
    v_mfma_f32_32x32x16_f16 v[80:95], v[136:139], v[140:143], v[80:95]
    ds_read_b64 v[128:129], v8 offset:3648
    ds_read_b64 v[130:131], v8 offset:3656
    ds_read_b128 v[132:135], v9 offset:4560
    s_lshl_b32 s14, s10, 7
    s_add_u32 s14, s14, 17137664
    s_waitcnt lgkmcnt(9)
    v_mfma_f32_32x32x16_f16 v[80:95], v[144:147], v[148:151], v[80:95]
    ds_read_b64 v[136:137], v8 offset:3584
    ds_read_b64 v[138:139], v8 offset:3592
    ds_read_b128 v[140:143], v9 offset:4480
    v_add_u32 v13, s14, v13
    s_add_u32 s16, s8, 4194304
    s_addc_u32 s17, s9, 0
    s_waitcnt lgkmcnt(9)
    v_mfma_f32_32x32x16_f16 v[80:95], v[48:51], v[52:55], v[80:95]
    ds_read_b64 v[144:145], v8 offset:3520
    ds_read_b64 v[146:147], v8 offset:3528
    ds_read_b128 v[148:151], v9 offset:4400
    v_lshrrev_b32 v2, 3, v1
    v_and_b32 v3, 7, v1
    s_waitcnt lgkmcnt(9)
    v_mfma_f32_32x32x16_f16 v[80:95], v[56:59], v[60:63], v[80:95]
    ds_read_b64 v[48:49], v8 offset:3456
    ds_read_b64 v[50:51], v8 offset:3464
    ds_read_b128 v[52:55], v9 offset:4320
    v_bfe_u32 v4, v1, 4, 1
    v_lshlrev_b32 v4, 2, v4
    s_waitcnt lgkmcnt(9)
    v_mfma_f32_32x32x16_f16 v[80:95], v[128:131], v[132:135], v[80:95]
    ds_read_b64 v[56:57], v8 offset:3392
    ds_read_b64 v[58:59], v8 offset:3400
    ds_read_b128 v[60:63], v9 offset:4240
    v_xor_b32 v4, v4, v3
    v_lshlrev_b32 v4, 4, v4
    s_waitcnt lgkmcnt(9)
    v_mfma_f32_32x32x16_f16 v[80:95], v[136:139], v[140:143], v[80:95]
    ds_read_b64 v[128:129], v8 offset:3328
    ds_read_b64 v[130:131], v8 offset:3336
    ds_read_b128 v[132:135], v9 offset:4160
    v_lshl_add_u32 v4, v2, 7, v4
    s_lshl_b32 s14, s11, 16
    s_waitcnt lgkmcnt(9)
    v_mfma_f32_32x32x16_f16 v[80:95], v[144:147], v[148:151], v[80:95]
    ds_read_b64 v[136:137], v8 offset:3264
    ds_read_b64 v[138:139], v8 offset:3272
    ds_read_b128 v[140:143], v9 offset:4080
    v_add_u32 v4, s14, v4
    v_lshlrev_b32 v5, 4, v1
    s_waitcnt lgkmcnt(9)
    v_mfma_f32_32x32x16_f16 v[80:95], v[48:51], v[52:55], v[80:95]
    ds_read_b64 v[144:145], v8 offset:3200
    ds_read_b64 v[146:147], v8 offset:3208
    ds_read_b128 v[148:151], v9 offset:4000
    v_mov_b32 v7, v5
    v_add_u32 v6, 114688, v5
    s_waitcnt lgkmcnt(9)
    v_mfma_f32_32x32x16_f16 v[80:95], v[56:59], v[60:63], v[80:95]
    ds_read_b64 v[48:49], v8 offset:3136
    ds_read_b64 v[50:51], v8 offset:3144
    ds_read_b128 v[52:55], v9 offset:3920
    v_mul_f32 v120, s52, v120
    v_mul_f32 v121, s53, v121
    s_waitcnt lgkmcnt(9)
    v_mfma_f32_32x32x16_f16 v[80:95], v[128:131], v[132:135], v[80:95]
    ds_read_b64 v[56:57], v8 offset:3072
    ds_read_b64 v[58:59], v8 offset:3080
    ds_read_b128 v[60:63], v9 offset:3840
    v_mul_f32 v122, s52, v122
    v_mul_f32 v123, s53, v123
    s_waitcnt lgkmcnt(9)
    v_mfma_f32_32x32x16_f16 v[80:95], v[136:139], v[140:143], v[80:95]
    ds_read_b64 v[128:129], v8 offset:3008
    ds_read_b64 v[130:131], v8 offset:3016
    ds_read_b128 v[132:135], v9 offset:3760
    v_mul_f32 v124, s52, v124
    v_mul_f32 v125, s53, v125
    s_waitcnt lgkmcnt(9)
    v_mfma_f32_32x32x16_f16 v[80:95], v[144:147], v[148:151], v[80:95]
    ds_read_b64 v[136:137], v8 offset:2944
    ds_read_b64 v[138:139], v8 offset:2952
    ds_read_b128 v[140:143], v9 offset:3680
    v_mul_f32 v126, s52, v126
    v_mul_f32 v127, s53, v127
    s_waitcnt lgkmcnt(9)
    v_mfma_f32_32x32x16_f16 v[80:95], v[48:51], v[52:55], v[80:95]
    ds_read_b64 v[144:145], v8 offset:2880
    ds_read_b64 v[146:147], v8 offset:2888
    ds_read_b128 v[148:151], v9 offset:3600
    v_cvt_pk_bf16_f32 v120, 0, v120
    v_cvt_pk_bf16_f32 v121, 0, v121
    s_waitcnt lgkmcnt(9)
    v_mfma_f32_32x32x16_f16 v[80:95], v[56:59], v[60:63], v[80:95]
    ds_read_b64 v[48:49], v8 offset:2816
    ds_read_b64 v[50:51], v8 offset:2824
    ds_read_b128 v[52:55], v9 offset:3520
    v_cvt_pk_bf16_f32 v122, 0, v122
    v_cvt_pk_bf16_f32 v123, 0, v123
    s_waitcnt lgkmcnt(9)
    v_mfma_f32_32x32x16_f16 v[80:95], v[128:131], v[132:135], v[80:95]
    ds_read_b64 v[56:57], v8 offset:2752
    ds_read_b64 v[58:59], v8 offset:2760
    ds_read_b128 v[60:63], v9 offset:3440
    global_load_dword v16, v13, s[8:9] offset:0 sc1
    v_cvt_pk_bf16_f32 v124, 0, v124
    v_cvt_pk_bf16_f32 v125, 0, v125
    s_waitcnt lgkmcnt(9)
    v_mfma_f32_32x32x16_f16 v[80:95], v[136:139], v[140:143], v[80:95]
    ds_read_b64 v[128:129], v8 offset:2688
    ds_read_b64 v[130:131], v8 offset:2696
    ds_read_b128 v[132:135], v9 offset:3360
    v_cvt_pk_bf16_f32 v126, 0, v126
    v_cvt_pk_bf16_f32 v127, 0, v127
    s_waitcnt lgkmcnt(9)
    v_mfma_f32_32x32x16_f16 v[80:95], v[144:147], v[148:151], v[80:95]
    ds_read_b64 v[136:137], v8 offset:2624
    ds_read_b64 v[138:139], v8 offset:2632
    ds_read_b128 v[140:143], v9 offset:3280
    s_waitcnt lgkmcnt(9)
    v_mfma_f32_32x32x16_f16 v[80:95], v[48:51], v[52:55], v[80:95]
    ds_read_b64 v[144:145], v8 offset:2560
    ds_read_b64 v[146:147], v8 offset:2568
    ds_read_b128 v[148:151], v9 offset:3200
    s_waitcnt lgkmcnt(9)
    v_mfma_f32_32x32x16_f16 v[80:95], v[56:59], v[60:63], v[80:95]
    ds_read_b64 v[48:49], v8 offset:2496
    ds_read_b64 v[50:51], v8 offset:2504
    ds_read_b128 v[52:55], v9 offset:3120
    s_waitcnt lgkmcnt(9)
    v_mfma_f32_32x32x16_f16 v[80:95], v[128:131], v[132:135], v[80:95]
    ds_read_b64 v[56:57], v8 offset:2432
    ds_read_b64 v[58:59], v8 offset:2440
    ds_read_b128 v[60:63], v9 offset:3040
    s_waitcnt lgkmcnt(9)
    v_mfma_f32_32x32x16_f16 v[80:95], v[136:139], v[140:143], v[80:95]
    ds_read_b64 v[128:129], v8 offset:2368
    ds_read_b64 v[130:131], v8 offset:2376
    ds_read_b128 v[132:135], v9 offset:2960
    s_waitcnt lgkmcnt(9)
    v_mfma_f32_32x32x16_f16 v[80:95], v[144:147], v[148:151], v[80:95]
    ds_read_b64 v[136:137], v8 offset:2304
    ds_read_b64 v[138:139], v8 offset:2312
    ds_read_b128 v[140:143], v9 offset:2880
    s_waitcnt lgkmcnt(9)
    v_mfma_f32_32x32x16_f16 v[80:95], v[48:51], v[52:55], v[80:95]
    ds_read_b64 v[144:145], v8 offset:2240
    ds_read_b64 v[146:147], v8 offset:2248
    ds_read_b128 v[148:151], v9 offset:2800
    s_waitcnt lgkmcnt(9)
    v_mfma_f32_32x32x16_f16 v[80:95], v[56:59], v[60:63], v[80:95]
    ds_read_b64 v[48:49], v8 offset:2176
    ds_read_b64 v[50:51], v8 offset:2184
    ds_read_b128 v[52:55], v9 offset:2720
    s_waitcnt lgkmcnt(9)
    v_mfma_f32_32x32x16_f16 v[80:95], v[128:131], v[132:135], v[80:95]
    ds_read_b64 v[56:57], v8 offset:2112
    ds_read_b64 v[58:59], v8 offset:2120
    ds_read_b128 v[60:63], v9 offset:2640
    s_waitcnt vmcnt(0)
    v_cmp_gt_u32 vcc, 5, v16
    s_nop 1
    s_cbranch_vccnz pollXE_1
pollXE_1_ok:
    s_add_u32 m0, s21, 98304
    s_add_u32 s24, s21, 0
    buffer_load_dwordx4 v4, s[16:19], s24 offen sc1 lds
    s_waitcnt lgkmcnt(9)
    v_mfma_f32_32x32x16_f16 v[80:95], v[136:139], v[140:143], v[80:95]
    ds_read_b64 v[128:129], v8 offset:2048
    ds_read_b64 v[130:131], v8 offset:2056
    ds_read_b128 v[132:135], v9 offset:2560
    s_waitcnt lgkmcnt(9)
    v_mfma_f32_32x32x16_f16 v[80:95], v[144:147], v[148:151], v[80:95]
    s_add_u32 m0, s21, 102400
    s_add_u32 s24, s21, 4096
    buffer_load_dwordx4 v4, s[16:19], s24 offen sc1 lds
    s_waitcnt lgkmcnt(6)
    v_mfma_f32_32x32x16_f16 v[80:95], v[48:51], v[52:55], v[80:95]
    s_waitcnt lgkmcnt(3)
    v_mfma_f32_32x32x16_f16 v[80:95], v[56:59], v[60:63], v[80:95]
    s_add_u32 m0, s21, 106496
    s_add_u32 s24, s21, 8192
    buffer_load_dwordx4 v4, s[16:19], s24 offen sc1 lds
    s_waitcnt lgkmcnt(0)
    v_mfma_f32_32x32x16_f16 v[80:95], v[128:131], v[132:135], v[80:95]
    s_nop 11
    ds_write_b128 v10, v[80:83] offset:4608
    ds_write_b128 v10, v[84:87] offset:4640
    ds_write_b128 v10, v[88:91] offset:4672
    ds_write_b128 v10, v[92:95] offset:4704
    s_waitcnt lgkmcnt(0)
    s_barrier
    ds_read_b128 v[24:27], v14 offset:4608
    ds_read_b128 v[28:31], v14 offset:13824
    ds_read_b128 v[40:43], v14 offset:23040
    ds_read_b128 v[44:47], v14 offset:32256
    s_add_u32 m0, s21, 110592
    s_add_u32 s24, s21, 12288
    buffer_load_dwordx4 v4, s[16:19], s24 offen sc1 lds
    s_add_u32 m0, s21, 114688
    s_add_u32 s24, s21, 16384
    buffer_load_dwordx4 v4, s[16:19], s24 offen sc1 lds
    s_add_u32 m0, s21, 118784
    s_add_u32 s24, s21, 20480
    buffer_load_dwordx4 v4, s[16:19], s24 offen sc1 lds
    s_waitcnt lgkmcnt(0)
    v_add_f32 v24, v24, v28
    v_add_f32 v25, v25, v29
    v_add_f32 v26, v26, v30
    v_add_f32 v27, v27, v31
    v_mul_f32 v24, s54, v24
    v_mul_f32 v25, s54, v25
    v_mul_f32 v26, s54, v26
    v_mul_f32 v27, s54, v27
    v_cvt_pk_bf16_f32 v24, 0, v24
    v_cvt_pk_bf16_f32 v25, 0, v25
    v_cvt_pk_bf16_f32 v26, 0, v26
    v_cvt_pk_bf16_f32 v27, 0, v27
    s_add_u32 m0, s21, 122880
    s_add_u32 s24, s21, 24576
    buffer_load_dwordx4 v4, s[16:19], s24 offen sc1 lds
    v_add_f32 v24, v24, v120
    v_add_f32 v25, v25, v122
    v_add_f32 v26, v26, v124
    v_add_f32 v27, v27, v126
    v_cvt_pk_bf16_f32 v24, 0, v24
    v_cvt_pk_bf16_f32 v25, 0, v25
    v_cvt_pk_bf16_f32 v26, 0, v26
    v_cvt_pk_bf16_f32 v27, 0, v27
    v_add_f32 v24, v24, v104
    v_add_f32 v25, v25, v106
    v_add_f32 v26, v26, v108
    v_add_f32 v27, v27, v110
    s_add_u32 m0, s21, 126976
    s_add_u32 s24, s21, 28672
    buffer_load_dwordx4 v4, s[16:19], s24 offen sc1 lds
    v_cvt_pk_bf16_f32 v28, v24, v25
    v_cvt_pk_bf16_f32 v29, v26, v27
    global_store_dwordx2 v12, v[28:29], s[8:9] offset:0 sc1
    v_add_f32 v40, v40, v44
    v_add_f32 v41, v41, v45
    v_add_f32 v42, v42, v46
    v_add_f32 v43, v43, v47
    v_mul_f32 v40, s55, v40
    v_mul_f32 v41, s55, v41
    v_mul_f32 v42, s55, v42
    v_mul_f32 v43, s55, v43
    v_cvt_pk_bf16_f32 v40, 0, v40
    s_xor_b32 s21, s21, 0x8000
    s_add_u32 m0, s21, 98304
    s_add_u32 s24, s21, 0
    buffer_load_dwordx4 v4, s[16:19], s24 offen sc1 lds
    v_cvt_pk_bf16_f32 v41, 0, v41
    v_cvt_pk_bf16_f32 v42, 0, v42
    v_cvt_pk_bf16_f32 v43, 0, v43
    v_add_f32 v40, v40, v121
    v_add_f32 v41, v41, v123
    v_add_f32 v42, v42, v125
    v_add_f32 v43, v43, v127
    v_cvt_pk_bf16_f32 v40, 0, v40
    v_cvt_pk_bf16_f32 v41, 0, v41
    v_cvt_pk_bf16_f32 v42, 0, v42
    v_cvt_pk_bf16_f32 v43, 0, v43
    v_add_f32 v40, v40, v105
    s_add_u32 m0, s21, 102400
    s_add_u32 s24, s21, 4096
    buffer_load_dwordx4 v4, s[16:19], s24 offen sc1 lds
    v_add_f32 v41, v41, v107
    v_add_f32 v42, v42, v109
    v_add_f32 v43, v43, v111
    v_cvt_pk_bf16_f32 v44, v40, v41
    v_cvt_pk_bf16_f32 v45, v42, v43
    global_store_dwordx2 v12, v[44:45], s[8:9] offset:128 sc1
    s_add_u32 m0, s21, 106496
    s_add_u32 s24, s21, 8192
    buffer_load_dwordx4 v4, s[16:19], s24 offen sc1 lds
    v_mov_b32 v14, s59
    v_and_b32 v15, 3, v1
    v_lshl_add_u32 v15, v15, 7, s60
    v_bfe_u32 v2, v1, 2, 2
    s_add_u32 m0, s21, 110592
    s_add_u32 s24, s21, 12288
    buffer_load_dwordx4 v4, s[16:19], s24 offen sc1 lds
    v_lshlrev_b32 v10, 7, v2
    v_bfe_u32 v3, v1, 4, 1
    v_lshl_add_u32 v10, v3, 5, v10
    v_and_b32 v3, 3, v1
    s_add_u32 m0, s21, 114688
    s_add_u32 s24, s21, 16384
    buffer_load_dwordx4 v4, s[16:19], s24 offen sc1 lds
    v_lshl_add_u32 v10, v3, 3, v10
    v_lshrrev_b32 v2, 1, v2
    v_lshrrev_b32 v3, 5, v1
    v_lshl_add_u32 v9, v3, 10, v10
    s_add_u32 m0, s21, 118784
    s_add_u32 s24, s21, 20480
    buffer_load_dwordx4 v4, s[16:19], s24 offen sc1 lds
    v_lshl_add_u32 v10, v3, 9, v10
    v_add_u32 v9, 98304, v9
    v_lshl_add_u32 v8, v2, 6, v9
    v_xor_b32 v3, 1, v2
    v_lshl_add_u32 v9, v3, 6, v9
    v_xor_b32 v2, s35, v2
    v_lshl_add_u32 v10, v2, 6, v10
    s_lshl_b32 s14, s46, 7
    v_add_u32 v10, s14, v10
    v_add_u32 v11, 98304, v10
    v_and_b32 v2, 31, v1
    s_lshl_b32 s14, s11, 10
    s_add_u32 s14, s14, 17203200
    v_lshl_add_u32 v12, v2, 4, s14
    s_cmp_ge_u32 s12, 14
    s_cbranch_scc1 ffn_helper_1
    s_waitcnt vmcnt(14)
    s_barrier
    ds_read_b64_tr_b16 v[32:33], v8 offset:0
    ds_read_b64_tr_b16 v[34:35], v8 offset:512
    ds_read_b64_tr_b16 v[36:37], v9 offset:0
    ds_read_b64_tr_b16 v[38:39], v9 offset:512
    ds_read_b64_tr_b16 v[40:41], v8 offset:2048
    ds_read_b64_tr_b16 v[42:43], v8 offset:2560
    ds_read_b64_tr_b16 v[44:45], v9 offset:2048
    ds_read_b64_tr_b16 v[46:47], v9 offset:2560
    s_waitcnt lgkmcnt(6)
    v_mfma_f32_32x32x16_bf16 v[64:79], v[160:163], v[32:35], 0
    ds_read_b64_tr_b16 v[48:49], v8 offset:4096
    ds_read_b64_tr_b16 v[50:51], v8 offset:4608
    s_waitcnt lgkmcnt(6)
    v_mfma_f32_32x32x16_bf16 v[80:95], v[160:163], v[36:39], 0
    ds_read_b64_tr_b16 v[52:53], v9 offset:4096
    ds_read_b64_tr_b16 v[54:55], v9 offset:4608
    s_add_u32 m0, s21, 122880
    s_add_u32 s24, s21, 24576
    buffer_load_dwordx4 v4, s[16:19], s24 offen sc1 lds
    s_waitcnt lgkmcnt(6)
    v_mfma_f32_32x32x16_bf16 v[64:79], v[164:167], v[40:43], v[64:79]
    ds_read_b64_tr_b16 v[32:33], v8 offset:6144
    ds_read_b64_tr_b16 v[34:35], v8 offset:6656
    s_waitcnt lgkmcnt(6)
    v_mfma_f32_32x32x16_bf16 v[80:95], v[164:167], v[44:47], v[80:95]
    ds_read_b64_tr_b16 v[36:37], v9 offset:6144
    ds_read_b64_tr_b16 v[38:39], v9 offset:6656
    s_add_u32 m0, s21, 126976
    s_add_u32 s24, s21, 28672
    s_xor_b32 s21, s21, 0x8000
    buffer_load_dwordx4 v4, s[16:19], s24 offen sc1 lds
    s_waitcnt lgkmcnt(6)
    v_mfma_f32_32x32x16_bf16 v[64:79], v[168:171], v[48:51], v[64:79]
    s_waitcnt vmcnt(6)
    s_barrier
    s_mov_b64 exec, 1
    v_mov_b32 v153, 6
    global_store_dword v152, v153, s[8:9] offset:0 sc1
    s_mov_b64 exec, -1
    ds_read_b64_tr_b16 v[40:41], v8 offset:8192
    ds_read_b64_tr_b16 v[42:43], v8 offset:8704
    s_waitcnt lgkmcnt(6)
    v_mfma_f32_32x32x16_bf16 v[80:95], v[168:171], v[52:55], v[80:95]
    ds_read_b64_tr_b16 v[44:45], v9 offset:8192
    ds_read_b64_tr_b16 v[46:47], v9 offset:8704
    s_waitcnt lgkmcnt(6)
    v_mfma_f32_32x32x16_bf16 v[64:79], v[172:175], v[32:35], v[64:79]
    ds_read_b64_tr_b16 v[48:49], v8 offset:10240
    ds_read_b64_tr_b16 v[50:51], v8 offset:10752
    s_waitcnt lgkmcnt(6)
    v_mfma_f32_32x32x16_bf16 v[80:95], v[172:175], v[36:39], v[80:95]
    ds_read_b64_tr_b16 v[52:53], v9 offset:10240
    ds_read_b64_tr_b16 v[54:55], v9 offset:10752
    s_waitcnt lgkmcnt(6)
    v_mfma_f32_32x32x16_bf16 v[64:79], v[176:179], v[40:43], v[64:79]
    ds_read_b64_tr_b16 v[32:33], v8 offset:12288
    ds_read_b64_tr_b16 v[34:35], v8 offset:12800
    s_waitcnt lgkmcnt(6)
    v_mfma_f32_32x32x16_bf16 v[80:95], v[176:179], v[44:47], v[80:95]
    ds_read_b64_tr_b16 v[36:37], v9 offset:12288
    ds_read_b64_tr_b16 v[38:39], v9 offset:12800
    s_waitcnt lgkmcnt(6)
    v_mfma_f32_32x32x16_bf16 v[64:79], v[180:183], v[48:51], v[64:79]
    ds_read_b64_tr_b16 v[40:41], v8 offset:14336
    ds_read_b64_tr_b16 v[42:43], v8 offset:14848
    s_waitcnt lgkmcnt(6)
    v_mfma_f32_32x32x16_bf16 v[80:95], v[180:183], v[52:55], v[80:95]
    ds_read_b64_tr_b16 v[44:45], v9 offset:14336
    ds_read_b64_tr_b16 v[46:47], v9 offset:14848
    s_waitcnt lgkmcnt(6)
    v_mfma_f32_32x32x16_bf16 v[64:79], v[184:187], v[32:35], v[64:79]
    s_barrier
    ds_read_b64_tr_b16 v[48:49], v8 offset:16384
    ds_read_b64_tr_b16 v[50:51], v8 offset:16896
    s_waitcnt lgkmcnt(6)
    v_mfma_f32_32x32x16_bf16 v[80:95], v[184:187], v[36:39], v[80:95]
    ds_read_b64_tr_b16 v[52:53], v9 offset:16384
    ds_read_b64_tr_b16 v[54:55], v9 offset:16896
    s_waitcnt lgkmcnt(6)
    v_mfma_f32_32x32x16_bf16 v[64:79], v[188:191], v[40:43], v[64:79]
    ds_read_b64_tr_b16 v[32:33], v8 offset:18432
    ds_read_b64_tr_b16 v[34:35], v8 offset:18944
    s_waitcnt lgkmcnt(6)
    v_mfma_f32_32x32x16_bf16 v[80:95], v[188:191], v[44:47], v[80:95]
    ds_read_b64_tr_b16 v[36:37], v9 offset:18432
    ds_read_b64_tr_b16 v[38:39], v9 offset:18944
    s_waitcnt lgkmcnt(6)
    v_mfma_f32_32x32x16_bf16 v[64:79], v[192:195], v[48:51], v[64:79]
    ds_read_b64_tr_b16 v[40:41], v8 offset:20480
    ds_read_b64_tr_b16 v[42:43], v8 offset:20992
    s_waitcnt lgkmcnt(6)
    v_mfma_f32_32x32x16_bf16 v[80:95], v[192:195], v[52:55], v[80:95]
    ds_read_b64_tr_b16 v[44:45], v9 offset:20480
    ds_read_b64_tr_b16 v[46:47], v9 offset:20992
    s_waitcnt lgkmcnt(6)
    v_mfma_f32_32x32x16_bf16 v[64:79], v[196:199], v[32:35], v[64:79]
    ds_read_b64_tr_b16 v[48:49], v8 offset:22528
    ds_read_b64_tr_b16 v[50:51], v8 offset:23040
    s_waitcnt lgkmcnt(6)
    v_mfma_f32_32x32x16_bf16 v[80:95], v[196:199], v[36:39], v[80:95]
    ds_read_b64_tr_b16 v[52:53], v9 offset:22528
    ds_read_b64_tr_b16 v[54:55], v9 offset:23040
    s_waitcnt lgkmcnt(6)
    v_mfma_f32_32x32x16_bf16 v[64:79], v[200:203], v[40:43], v[64:79]
    ds_read_b64_tr_b16 v[32:33], v8 offset:24576
    ds_read_b64_tr_b16 v[34:35], v8 offset:25088
    s_waitcnt lgkmcnt(6)
    v_mfma_f32_32x32x16_bf16 v[80:95], v[200:203], v[44:47], v[80:95]
    ds_read_b64_tr_b16 v[36:37], v9 offset:24576
    ds_read_b64_tr_b16 v[38:39], v9 offset:25088
    s_waitcnt lgkmcnt(6)
    v_mfma_f32_32x32x16_bf16 v[64:79], v[204:207], v[48:51], v[64:79]
    ds_read_b64_tr_b16 v[40:41], v8 offset:26624
    ds_read_b64_tr_b16 v[42:43], v8 offset:27136
    s_waitcnt lgkmcnt(6)
    v_mfma_f32_32x32x16_bf16 v[80:95], v[204:207], v[52:55], v[80:95]
    ds_read_b64_tr_b16 v[44:45], v9 offset:26624
    ds_read_b64_tr_b16 v[46:47], v9 offset:27136
    s_waitcnt lgkmcnt(6)
    v_mfma_f32_32x32x16_bf16 v[64:79], v[208:211], v[32:35], v[64:79]
    ds_read_b64_tr_b16 v[48:49], v8 offset:28672
    ds_read_b64_tr_b16 v[50:51], v8 offset:29184
    s_waitcnt lgkmcnt(6)
    v_mfma_f32_32x32x16_bf16 v[80:95], v[208:211], v[36:39], v[80:95]
    ds_read_b64_tr_b16 v[52:53], v9 offset:28672
    ds_read_b64_tr_b16 v[54:55], v9 offset:29184
    s_waitcnt lgkmcnt(6)
    v_mfma_f32_32x32x16_bf16 v[64:79], v[212:215], v[40:43], v[64:79]
    ds_read_b64_tr_b16 v[32:33], v8 offset:30720
    ds_read_b64_tr_b16 v[34:35], v8 offset:31232
    s_waitcnt lgkmcnt(6)
    v_mfma_f32_32x32x16_bf16 v[80:95], v[212:215], v[44:47], v[80:95]
    ds_read_b64_tr_b16 v[36:37], v9 offset:30720
    ds_read_b64_tr_b16 v[38:39], v9 offset:31232
    s_waitcnt lgkmcnt(6)
    v_mfma_f32_32x32x16_bf16 v[64:79], v[216:219], v[48:51], v[64:79]
    s_waitcnt vmcnt(1)
    s_barrier
    ds_read_b64_tr_b16 v[40:41], v8 offset:32768
    ds_read_b64_tr_b16 v[42:43], v8 offset:33280
    s_waitcnt lgkmcnt(6)
    v_mfma_f32_32x32x16_bf16 v[80:95], v[216:219], v[52:55], v[80:95]
    ds_read_b64_tr_b16 v[44:45], v9 offset:32768
    ds_read_b64_tr_b16 v[46:47], v9 offset:33280
    s_waitcnt lgkmcnt(6)
    v_mfma_f32_32x32x16_bf16 v[64:79], v[220:223], v[32:35], v[64:79]
    ds_read_b64_tr_b16 v[48:49], v8 offset:34816
    ds_read_b64_tr_b16 v[50:51], v8 offset:35328
    s_waitcnt lgkmcnt(6)
    v_mfma_f32_32x32x16_bf16 v[80:95], v[220:223], v[36:39], v[80:95]
    ds_read_b64_tr_b16 v[52:53], v9 offset:34816
    ds_read_b64_tr_b16 v[54:55], v9 offset:35328
    s_waitcnt lgkmcnt(6)
    v_mfma_f32_32x32x16_bf16 v[64:79], v[224:227], v[40:43], v[64:79]
    ds_read_b64_tr_b16 v[32:33], v8 offset:36864
    ds_read_b64_tr_b16 v[34:35], v8 offset:37376
    s_waitcnt lgkmcnt(6)
    v_mfma_f32_32x32x16_bf16 v[80:95], v[224:227], v[44:47], v[80:95]
    ds_read_b64_tr_b16 v[36:37], v9 offset:36864
    ds_read_b64_tr_b16 v[38:39], v9 offset:37376
    s_waitcnt lgkmcnt(6)
    v_mfma_f32_32x32x16_bf16 v[64:79], v[228:231], v[48:51], v[64:79]
    ds_read_b64_tr_b16 v[40:41], v8 offset:38912
    ds_read_b64_tr_b16 v[42:43], v8 offset:39424
    s_waitcnt lgkmcnt(6)
    v_mfma_f32_32x32x16_bf16 v[80:95], v[228:231], v[52:55], v[80:95]
    ds_read_b64_tr_b16 v[44:45], v9 offset:38912
    ds_read_b64_tr_b16 v[46:47], v9 offset:39424
    s_waitcnt lgkmcnt(6)
    v_mfma_f32_32x32x16_bf16 v[64:79], v[232:235], v[32:35], v[64:79]
    ds_read_b64_tr_b16 v[48:49], v8 offset:40960
    ds_read_b64_tr_b16 v[50:51], v8 offset:41472
    s_waitcnt lgkmcnt(6)
    v_mfma_f32_32x32x16_bf16 v[80:95], v[232:235], v[36:39], v[80:95]
    ds_read_b64_tr_b16 v[52:53], v9 offset:40960
    ds_read_b64_tr_b16 v[54:55], v9 offset:41472
    s_waitcnt lgkmcnt(6)
    v_mfma_f32_32x32x16_bf16 v[64:79], v[236:239], v[40:43], v[64:79]
    ds_read_b64_tr_b16 v[32:33], v8 offset:43008
    ds_read_b64_tr_b16 v[34:35], v8 offset:43520
    s_waitcnt lgkmcnt(6)
    v_mfma_f32_32x32x16_bf16 v[80:95], v[236:239], v[44:47], v[80:95]
    ds_read_b64_tr_b16 v[36:37], v9 offset:43008
    ds_read_b64_tr_b16 v[38:39], v9 offset:43520
    s_waitcnt lgkmcnt(6)
    v_mfma_f32_32x32x16_bf16 v[64:79], v[240:243], v[48:51], v[64:79]
    ds_read_b64_tr_b16 v[40:41], v8 offset:45056
    ds_read_b64_tr_b16 v[42:43], v8 offset:45568
    s_waitcnt lgkmcnt(6)
    v_mfma_f32_32x32x16_bf16 v[80:95], v[240:243], v[52:55], v[80:95]
    ds_read_b64_tr_b16 v[44:45], v9 offset:45056
    ds_read_b64_tr_b16 v[46:47], v9 offset:45568
    s_waitcnt lgkmcnt(6)
    v_mfma_f32_32x32x16_bf16 v[64:79], v[244:247], v[32:35], v[64:79]
    ds_read_b64_tr_b16 v[48:49], v8 offset:47104
    ds_read_b64_tr_b16 v[50:51], v8 offset:47616
    s_waitcnt lgkmcnt(6)
    v_mfma_f32_32x32x16_bf16 v[80:95], v[244:247], v[36:39], v[80:95]
    ds_read_b64_tr_b16 v[52:53], v9 offset:47104
    ds_read_b64_tr_b16 v[54:55], v9 offset:47616
    global_load_dwordx4 v[56:59], v12, s[8:9] offset:0 sc1
    global_load_dwordx4 v[60:63], v12, s[8:9] offset:512 sc1
    s_waitcnt lgkmcnt(6)
    v_mfma_f32_32x32x16_bf16 v[64:79], v[248:251], v[40:43], v[64:79]
    ds_read_b64_tr_b16 v[32:33], v8 offset:49152
    ds_read_b64_tr_b16 v[34:35], v8 offset:49664
    s_waitcnt lgkmcnt(6)
    v_mfma_f32_32x32x16_bf16 v[80:95], v[248:251], v[44:47], v[80:95]
    ds_read_b64_tr_b16 v[36:37], v9 offset:49152
    ds_read_b64_tr_b16 v[38:39], v9 offset:49664
    s_waitcnt lgkmcnt(6)
    v_mfma_f32_32x32x16_bf16 v[64:79], v[252:255], v[48:51], v[64:79]
    ds_read_b64_tr_b16 v[40:41], v8 offset:51200
    ds_read_b64_tr_b16 v[42:43], v8 offset:51712
    s_waitcnt lgkmcnt(6)
    v_mfma_f32_32x32x16_bf16 v[80:95], v[252:255], v[52:55], v[80:95]
    ds_read_b64_tr_b16 v[44:45], v9 offset:51200
    ds_read_b64_tr_b16 v[46:47], v9 offset:51712
    s_waitcnt lgkmcnt(6)
    v_mfma_f32_32x32x16_bf16 v[64:79], a[224:227], v[32:35], v[64:79]
    ds_read_b64_tr_b16 v[48:49], v8 offset:53248
    ds_read_b64_tr_b16 v[50:51], v8 offset:53760
    s_waitcnt lgkmcnt(6)
    v_mfma_f32_32x32x16_bf16 v[80:95], a[224:227], v[36:39], v[80:95]
    ds_read_b64_tr_b16 v[52:53], v9 offset:53248
    ds_read_b64_tr_b16 v[54:55], v9 offset:53760
    s_waitcnt lgkmcnt(6)
    v_mfma_f32_32x32x16_bf16 v[64:79], a[228:231], v[40:43], v[64:79]
    ds_read_b64_tr_b16 v[32:33], v8 offset:55296
    ds_read_b64_tr_b16 v[34:35], v8 offset:55808
    s_waitcnt lgkmcnt(6)
    v_mfma_f32_32x32x16_bf16 v[80:95], a[228:231], v[44:47], v[80:95]
    ds_read_b64_tr_b16 v[36:37], v9 offset:55296
    ds_read_b64_tr_b16 v[38:39], v9 offset:55808
    global_load_dword v31, v13, s[8:9] offset:0 sc1
    s_waitcnt lgkmcnt(6)
    v_mfma_f32_32x32x16_bf16 v[64:79], a[232:235], v[48:51], v[64:79]
    ds_read_b64_tr_b16 v[40:41], v8 offset:57344
    ds_read_b64_tr_b16 v[42:43], v8 offset:57856
    s_waitcnt lgkmcnt(6)
    v_mfma_f32_32x32x16_bf16 v[80:95], a[232:235], v[52:55], v[80:95]
    ds_read_b64_tr_b16 v[44:45], v9 offset:57344
    ds_read_b64_tr_b16 v[46:47], v9 offset:57856
    s_waitcnt lgkmcnt(6)
    v_mfma_f32_32x32x16_bf16 v[64:79], a[236:239], v[32:35], v[64:79]
    ds_read_b64_tr_b16 v[48:49], v8 offset:59392
    ds_read_b64_tr_b16 v[50:51], v8 offset:59904
    s_waitcnt lgkmcnt(6)
    v_mfma_f32_32x32x16_bf16 v[80:95], a[236:239], v[36:39], v[80:95]
    ds_read_b64_tr_b16 v[52:53], v9 offset:59392
    ds_read_b64_tr_b16 v[54:55], v9 offset:59904
    s_waitcnt lgkmcnt(6)
    v_mfma_f32_32x32x16_bf16 v[64:79], a[240:243], v[40:43], v[64:79]
    ds_read_b64_tr_b16 v[32:33], v8 offset:61440
    ds_read_b64_tr_b16 v[34:35], v8 offset:61952
    s_waitcnt lgkmcnt(6)
    v_mfma_f32_32x32x16_bf16 v[80:95], a[240:243], v[44:47], v[80:95]
    ds_read_b64_tr_b16 v[36:37], v9 offset:61440
    ds_read_b64_tr_b16 v[38:39], v9 offset:61952
    s_waitcnt vmcnt(1)
ffn_chk0_1:
    v_min_u32 v2, v57, v59
    v_min3_u32 v2, v2, v61, v63
    v_cmp_eq_u32 vcc, 0, v2
    s_nop 1
    s_cbranch_vccnz ffn_retry0_1
    v_add_f32 v16, v56, v58
    v_add_f32 v18, v60, v62
    v_add_f32 v17, v57, v59
    v_add_f32 v19, v61, v63
    v_mul_f32 v16, s26, v16
    v_mul_f32 v18, s26, v18
    s_waitcnt lgkmcnt(6)
    v_mfma_f32_32x32x16_bf16 v[64:79], a[244:247], v[48:51], v[64:79]
    ds_read_b64_tr_b16 v[40:41], v8 offset:63488
    ds_read_b64_tr_b16 v[42:43], v8 offset:64000
    v_mul_f32 v17, s26, v17
    v_mul_f32 v19, s26, v19
    v_cvt_pk_bf16_f32 v56, -v16, -v16
    v_cvt_pk_bf16_f32 v60, -v18, -v18
    v_mov_b32 v58, 0
    v_mov_b32 v59, 0
    s_waitcnt lgkmcnt(6)
    v_mfma_f32_32x32x16_bf16 v[80:95], a[244:247], v[52:55], v[80:95]
    ds_read_b64_tr_b16 v[44:45], v9 offset:63488
    ds_read_b64_tr_b16 v[46:47], v9 offset:64000
    v_mov_b32 v57, v56
    v_mov_b32 v61, v60
    v_mov_b32 v62, 0
    v_mov_b32 v63, 0
    v_fma_f32 v17, -v16, v16, v17
    v_fma_f32 v19, -v18, v18, v19
    s_waitcnt lgkmcnt(6)
    v_mfma_f32_32x32x16_bf16 v[64:79], a[248:251], v[32:35], v[64:79]
    v_max_f32 v17, 0, v17
    v_max_f32 v19, 0, v19
    v_cvt_pk_bf16_f32 v17, 0, v17
    v_cvt_pk_bf16_f32 v19, 0, v19
    v_add_f32 v17, s27, v17
    v_add_f32 v19, s27, v19
    s_waitcnt lgkmcnt(4)
    v_mfma_f32_32x32x16_bf16 v[80:95], a[248:251], v[36:39], v[80:95]
    v_cvt_pk_bf16_f32 v17, 0, v17
    v_cvt_pk_bf16_f32 v19, 0, v19
    v_sqrt_f32 v17, v17
    v_sqrt_f32 v19, v19
    v_cvt_pk_bf16_f32 v17, 0, v17
    v_cvt_pk_bf16_f32 v19, 0, v19
    s_waitcnt lgkmcnt(2)
    v_mfma_f32_32x32x16_bf16 v[64:79], a[252:255], v[40:43], v[64:79]
    v_mfma_f32_32x32x16_bf16 v[64:79], v[156:159], v[56:59], v[64:79]
    v_rcp_f32 v16, v17
    v_rcp_f32 v18, v19
    v_mul_f32 v16, s31, v16
    v_mul_f32 v18, s31, v18
    s_waitcnt lgkmcnt(0)
    v_mfma_f32_32x32x16_bf16 v[80:95], a[252:255], v[44:47], v[80:95]
    v_mfma_f32_32x32x16_bf16 v[80:95], v[156:159], v[60:63], v[80:95]
    ds_read_b64_tr_b16 v[20:21], v11 offset:0
    ds_read_b64_tr_b16 v[22:23], v11 offset:1024
    s_waitcnt vmcnt(0)
    v_cmp_gt_u32 vcc, 6, v31
    s_nop 1
    s_cbranch_vccnz pollXL_1
pollXL_1_ok:
    s_add_u32 m0, s21, 0
    s_add_u32 s24, s21, 1048576
    buffer_load_dwordx4 v4, s[16:19], s24 offen sc1 lds
    s_add_u32 m0, s21, 4096
    s_add_u32 s24, s21, 1052672
    buffer_load_dwordx4 v4, s[16:19], s24 offen sc1 lds
    s_add_u32 m0, s21, 8192
    s_add_u32 s24, s21, 1056768
    buffer_load_dwordx4 v4, s[16:19], s24 offen sc1 lds
    v_pk_mul_f32 v[48:49], v[64:65], v[16:17] op_sel:[0,0] op_sel_hi:[1,0]
    v_pk_mul_f32 v[50:51], v[66:67], v[16:17] op_sel:[0,0] op_sel_hi:[1,0]
    v_pk_mul_f32 v[52:53], v[68:69], v[16:17] op_sel:[0,0] op_sel_hi:[1,0]
    v_pk_mul_f32 v[54:55], v[70:71], v[16:17] op_sel:[0,0] op_sel_hi:[1,0]
    v_pk_mul_f32 v[56:57], v[72:73], v[16:17] op_sel:[0,0] op_sel_hi:[1,0]
    v_pk_mul_f32 v[58:59], v[74:75], v[16:17] op_sel:[0,0] op_sel_hi:[1,0]
    v_pk_mul_f32 v[60:61], v[76:77], v[16:17] op_sel:[0,0] op_sel_hi:[1,0]
    v_pk_mul_f32 v[62:63], v[78:79], v[16:17] op_sel:[0,0] op_sel_hi:[1,0]
    v_exp_f32 v48, v48
    v_exp_f32 v49, v49
    v_exp_f32 v50, v50
    v_exp_f32 v51, v51
    v_exp_f32 v52, v52
    v_exp_f32 v53, v53
    s_add_u32 m0, s21, 12288
    s_add_u32 s24, s21, 1060864
    buffer_load_dwordx4 v4, s[16:19], s24 offen sc1 lds
    v_exp_f32 v54, v54
    v_exp_f32 v55, v55
    v_exp_f32 v56, v56
    v_exp_f32 v57, v57
    v_exp_f32 v58, v58
    v_exp_f32 v59, v59
    v_exp_f32 v60, v60
    v_exp_f32 v61, v61
    v_exp_f32 v62, v62
    v_exp_f32 v63, v63
    v_pk_fma_f32 v[48:49], v[48:49], v[16:17], v[16:17] op_sel:[0,1,1] op_sel_hi:[1,1,1]
    v_pk_fma_f32 v[50:51], v[50:51], v[16:17], v[16:17] op_sel:[0,1,1] op_sel_hi:[1,1,1]
    v_pk_fma_f32 v[52:53], v[52:53], v[16:17], v[16:17] op_sel:[0,1,1] op_sel_hi:[1,1,1]
    v_pk_fma_f32 v[54:55], v[54:55], v[16:17], v[16:17] op_sel:[0,1,1] op_sel_hi:[1,1,1]
    s_add_u32 m0, s21, 16384
    s_add_u32 s24, s21, 1064960
    buffer_load_dwordx4 v4, s[16:19], s24 offen sc1 lds
    v_pk_fma_f32 v[56:57], v[56:57], v[16:17], v[16:17] op_sel:[0,1,1] op_sel_hi:[1,1,1]
    v_pk_fma_f32 v[58:59], v[58:59], v[16:17], v[16:17] op_sel:[0,1,1] op_sel_hi:[1,1,1]
    v_pk_fma_f32 v[60:61], v[60:61], v[16:17], v[16:17] op_sel:[0,1,1] op_sel_hi:[1,1,1]
    v_pk_fma_f32 v[62:63], v[62:63], v[16:17], v[16:17] op_sel:[0,1,1] op_sel_hi:[1,1,1]
    v_rcp_f32 v48, v48
    v_rcp_f32 v49, v49
    v_rcp_f32 v50, v50
    v_rcp_f32 v51, v51
    v_rcp_f32 v52, v52
    v_rcp_f32 v53, v53
    v_rcp_f32 v54, v54
    v_rcp_f32 v55, v55
    v_rcp_f32 v56, v56
    v_rcp_f32 v57, v57
    s_add_u32 m0, s21, 20480
    s_add_u32 s24, s21, 1069056
    buffer_load_dwordx4 v4, s[16:19], s24 offen sc1 lds
    v_rcp_f32 v58, v58
    v_rcp_f32 v59, v59
    v_rcp_f32 v60, v60
    v_rcp_f32 v61, v61
    v_rcp_f32 v62, v62
    v_rcp_f32 v63, v63
    v_pk_mul_f32 v[64:65], v[64:65], v[48:49]
    v_pk_mul_f32 v[66:67], v[66:67], v[50:51]
    v_pk_mul_f32 v[68:69], v[68:69], v[52:53]
    v_pk_mul_f32 v[70:71], v[70:71], v[54:55]
    v_pk_mul_f32 v[72:73], v[72:73], v[56:57]
    v_pk_mul_f32 v[74:75], v[74:75], v[58:59]
    v_pk_mul_f32 v[76:77], v[76:77], v[60:61]
    v_pk_mul_f32 v[78:79], v[78:79], v[62:63]
    s_add_u32 m0, s21, 24576
    s_add_u32 s24, s21, 1073152
    buffer_load_dwordx4 v4, s[16:19], s24 offen sc1 lds
    v_cvt_pk_bf16_f32 v64, v64, v65
    v_cvt_pk_bf16_f32 v65, v66, v67
    v_cvt_pk_bf16_f32 v66, v68, v69
    v_cvt_pk_bf16_f32 v67, v70, v71
    v_cvt_pk_bf16_f32 v68, v72, v73
    v_cvt_pk_bf16_f32 v69, v74, v75
    v_cvt_pk_bf16_f32 v70, v76, v77
    v_cvt_pk_bf16_f32 v71, v78, v79
    global_store_dwordx4 v5, v[64:67], s[40:41] sc1
    global_store_dwordx4 v5, v[68:71], s[40:41] offset:1024 sc1
    v_pk_mul_f32 v[48:49], v[80:81], v[18:19] op_sel:[0,0] op_sel_hi:[1,0]
    v_pk_mul_f32 v[50:51], v[82:83], v[18:19] op_sel:[0,0] op_sel_hi:[1,0]
    v_pk_mul_f32 v[52:53], v[84:85], v[18:19] op_sel:[0,0] op_sel_hi:[1,0]
    v_pk_mul_f32 v[54:55], v[86:87], v[18:19] op_sel:[0,0] op_sel_hi:[1,0]
    s_add_u32 m0, s21, 28672
    s_add_u32 s24, s21, 1077248
    buffer_load_dwordx4 v4, s[16:19], s24 offen sc1 lds
    v_pk_mul_f32 v[56:57], v[88:89], v[18:19] op_sel:[0,0] op_sel_hi:[1,0]
    v_pk_mul_f32 v[58:59], v[90:91], v[18:19] op_sel:[0,0] op_sel_hi:[1,0]
    v_pk_mul_f32 v[60:61], v[92:93], v[18:19] op_sel:[0,0] op_sel_hi:[1,0]
    v_pk_mul_f32 v[62:63], v[94:95], v[18:19] op_sel:[0,0] op_sel_hi:[1,0]
    v_exp_f32 v48, v48
    v_exp_f32 v49, v49
    v_exp_f32 v50, v50
    v_exp_f32 v51, v51
    v_exp_f32 v52, v52
    v_exp_f32 v53, v53
    v_exp_f32 v54, v54
    v_exp_f32 v55, v55
    v_exp_f32 v56, v56
    v_exp_f32 v57, v57
    s_xor_b32 s21, s21, 0x8000
    s_add_u32 m0, s21, 0
    s_add_u32 s24, s21, 1048576
    buffer_load_dwordx4 v4, s[16:19], s24 offen sc1 lds
    v_exp_f32 v58, v58
    v_exp_f32 v59, v59
    v_exp_f32 v60, v60
    v_exp_f32 v61, v61
    v_exp_f32 v62, v62
    v_exp_f32 v63, v63
    v_pk_fma_f32 v[48:49], v[48:49], v[18:19], v[18:19] op_sel:[0,1,1] op_sel_hi:[1,1,1]
    v_pk_fma_f32 v[50:51], v[50:51], v[18:19], v[18:19] op_sel:[0,1,1] op_sel_hi:[1,1,1]
    v_pk_fma_f32 v[52:53], v[52:53], v[18:19], v[18:19] op_sel:[0,1,1] op_sel_hi:[1,1,1]
    v_pk_fma_f32 v[54:55], v[54:55], v[18:19], v[18:19] op_sel:[0,1,1] op_sel_hi:[1,1,1]
    v_pk_fma_f32 v[56:57], v[56:57], v[18:19], v[18:19] op_sel:[0,1,1] op_sel_hi:[1,1,1]
    v_pk_fma_f32 v[58:59], v[58:59], v[18:19], v[18:19] op_sel:[0,1,1] op_sel_hi:[1,1,1]
    v_pk_fma_f32 v[60:61], v[60:61], v[18:19], v[18:19] op_sel:[0,1,1] op_sel_hi:[1,1,1]
    v_pk_fma_f32 v[62:63], v[62:63], v[18:19], v[18:19] op_sel:[0,1,1] op_sel_hi:[1,1,1]
    s_add_u32 m0, s21, 4096
    s_add_u32 s24, s21, 1052672
    buffer_load_dwordx4 v4, s[16:19], s24 offen sc1 lds
    v_rcp_f32 v48, v48
    v_rcp_f32 v49, v49
    v_rcp_f32 v50, v50
    v_rcp_f32 v51, v51
    v_rcp_f32 v52, v52
    v_rcp_f32 v53, v53
    v_rcp_f32 v54, v54
    v_rcp_f32 v55, v55
    v_rcp_f32 v56, v56
    v_rcp_f32 v57, v57
    v_rcp_f32 v58, v58
    v_rcp_f32 v59, v59
    v_rcp_f32 v60, v60
    v_rcp_f32 v61, v61
    v_rcp_f32 v62, v62
    v_rcp_f32 v63, v63
    v_pk_mul_f32 v[80:81], v[80:81], v[48:49]
    v_pk_mul_f32 v[82:83], v[82:83], v[50:51]
    v_pk_mul_f32 v[84:85], v[84:85], v[52:53]
    v_pk_mul_f32 v[86:87], v[86:87], v[54:55]
    v_pk_mul_f32 v[88:89], v[88:89], v[56:57]
    v_pk_mul_f32 v[90:91], v[90:91], v[58:59]
    v_pk_mul_f32 v[92:93], v[92:93], v[60:61]
    v_pk_mul_f32 v[94:95], v[94:95], v[62:63]
    v_cvt_pk_bf16_f32 v80, v80, v81
    v_cvt_pk_bf16_f32 v81, v82, v83
    v_cvt_pk_bf16_f32 v82, v84, v85
    v_cvt_pk_bf16_f32 v83, v86, v87
    v_cvt_pk_bf16_f32 v84, v88, v89
    v_cvt_pk_bf16_f32 v85, v90, v91
    v_cvt_pk_bf16_f32 v86, v92, v93
    v_cvt_pk_bf16_f32 v87, v94, v95
    global_store_dwordx4 v6, v[80:83], s[40:41] sc1
    global_store_dwordx4 v6, v[84:87], s[40:41] offset:1024 sc1
    v_add_u32 v12, 0x4000, v12
    v_subrev_u32 v8, 98304, v8
    v_subrev_u32 v9, 98304, v9
    s_add_u32 s40, s40, 3670016
    s_addc_u32 s41, s41, 0
    s_waitcnt vmcnt(10)
    s_barrier
    ds_read_b64_tr_b16 v[32:33], v8 offset:0
    ds_read_b64_tr_b16 v[34:35], v8 offset:512
    ds_read_b64_tr_b16 v[36:37], v9 offset:0
    ds_read_b64_tr_b16 v[38:39], v9 offset:512
    ds_read_b64_tr_b16 v[40:41], v8 offset:2048
    ds_read_b64_tr_b16 v[42:43], v8 offset:2560
    ds_read_b64_tr_b16 v[44:45], v9 offset:2048
    ds_read_b64_tr_b16 v[46:47], v9 offset:2560
    s_waitcnt lgkmcnt(6)
    v_mfma_f32_32x32x16_bf16 v[96:111], v[160:163], v[32:35], 0
    ds_read_b64_tr_b16 v[48:49], v8 offset:4096
    ds_read_b64_tr_b16 v[50:51], v8 offset:4608
    s_waitcnt lgkmcnt(6)
    v_mfma_f32_32x32x16_bf16 v[112:127], v[160:163], v[36:39], 0
    ds_read_b64_tr_b16 v[52:53], v9 offset:4096
    ds_read_b64_tr_b16 v[54:55], v9 offset:4608
    s_add_u32 m0, s21, 8192
    s_add_u32 s24, s21, 1056768
    buffer_load_dwordx4 v4, s[16:19], s24 offen sc1 lds
    s_waitcnt lgkmcnt(6)
    v_mfma_f32_32x32x16_bf16 v[96:111], v[164:167], v[40:43], v[96:111]
    ds_read_b64_tr_b16 v[32:33], v8 offset:6144
    ds_read_b64_tr_b16 v[34:35], v8 offset:6656
    s_waitcnt lgkmcnt(6)
    v_mfma_f32_32x32x16_bf16 v[112:127], v[164:167], v[44:47], v[112:127]
    ds_read_b64_tr_b16 v[36:37], v9 offset:6144
    ds_read_b64_tr_b16 v[38:39], v9 offset:6656
    s_add_u32 m0, s21, 12288
    s_add_u32 s24, s21, 1060864
    buffer_load_dwordx4 v4, s[16:19], s24 offen sc1 lds
    s_waitcnt lgkmcnt(6)
    v_mfma_f32_32x32x16_bf16 v[96:111], v[168:171], v[48:51], v[96:111]
    ds_read_b64_tr_b16 v[40:41], v8 offset:8192
    ds_read_b64_tr_b16 v[42:43], v8 offset:8704
    s_waitcnt lgkmcnt(6)
    v_mfma_f32_32x32x16_bf16 v[112:127], v[168:171], v[52:55], v[112:127]
    ds_read_b64_tr_b16 v[44:45], v9 offset:8192
    ds_read_b64_tr_b16 v[46:47], v9 offset:8704
    s_add_u32 m0, s21, 16384
    s_add_u32 s24, s21, 1064960
    buffer_load_dwordx4 v4, s[16:19], s24 offen sc1 lds
    s_waitcnt lgkmcnt(6)
    v_mfma_f32_32x32x16_bf16 v[96:111], v[172:175], v[32:35], v[96:111]
    ds_read_b64_tr_b16 v[48:49], v8 offset:10240
    ds_read_b64_tr_b16 v[50:51], v8 offset:10752
    s_waitcnt lgkmcnt(6)
    v_mfma_f32_32x32x16_bf16 v[112:127], v[172:175], v[36:39], v[112:127]
    ds_read_b64_tr_b16 v[52:53], v9 offset:10240
    ds_read_b64_tr_b16 v[54:55], v9 offset:10752
    s_add_u32 m0, s21, 20480
    s_add_u32 s24, s21, 1069056
    buffer_load_dwordx4 v4, s[16:19], s24 offen sc1 lds
    s_waitcnt lgkmcnt(6)
    v_mfma_f32_32x32x16_bf16 v[96:111], v[176:179], v[40:43], v[96:111]
    ds_read_b64_tr_b16 v[32:33], v8 offset:12288
    ds_read_b64_tr_b16 v[34:35], v8 offset:12800
    s_waitcnt lgkmcnt(6)
    v_mfma_f32_32x32x16_bf16 v[112:127], v[176:179], v[44:47], v[112:127]
    ds_read_b64_tr_b16 v[36:37], v9 offset:12288
    ds_read_b64_tr_b16 v[38:39], v9 offset:12800
    s_add_u32 m0, s21, 24576
    s_add_u32 s24, s21, 1073152
    buffer_load_dwordx4 v4, s[16:19], s24 offen sc1 lds
    s_waitcnt lgkmcnt(6)
    v_mfma_f32_32x32x16_bf16 v[96:111], v[180:183], v[48:51], v[96:111]
    ds_read_b64_tr_b16 v[40:41], v8 offset:14336
    ds_read_b64_tr_b16 v[42:43], v8 offset:14848
    s_waitcnt lgkmcnt(6)
    v_mfma_f32_32x32x16_bf16 v[112:127], v[180:183], v[52:55], v[112:127]
    ds_read_b64_tr_b16 v[44:45], v9 offset:14336
    ds_read_b64_tr_b16 v[46:47], v9 offset:14848
    s_add_u32 m0, s21, 28672
    s_add_u32 s24, s21, 1077248
    s_xor_b32 s21, s21, 0x8000
    buffer_load_dwordx4 v4, s[16:19], s24 offen sc1 lds
    s_waitcnt lgkmcnt(6)
    v_mfma_f32_32x32x16_bf16 v[96:111], v[184:187], v[32:35], v[96:111]
    s_waitcnt vmcnt(8)
    s_barrier
    ds_read_b64_tr_b16 v[48:49], v8 offset:16384
    ds_read_b64_tr_b16 v[50:51], v8 offset:16896
    s_waitcnt lgkmcnt(6)
    v_mfma_f32_32x32x16_bf16 v[112:127], v[184:187], v[36:39], v[112:127]
    ds_read_b64_tr_b16 v[52:53], v9 offset:16384
    ds_read_b64_tr_b16 v[54:55], v9 offset:16896
    s_waitcnt lgkmcnt(6)
    v_mfma_f32_32x32x16_bf16 v[96:111], v[188:191], v[40:43], v[96:111]
    ds_read_b64_tr_b16 v[32:33], v8 offset:18432
    ds_read_b64_tr_b16 v[34:35], v8 offset:18944
    s_waitcnt lgkmcnt(6)
    v_mfma_f32_32x32x16_bf16 v[112:127], v[188:191], v[44:47], v[112:127]
    ds_read_b64_tr_b16 v[36:37], v9 offset:18432
    ds_read_b64_tr_b16 v[38:39], v9 offset:18944
    s_waitcnt lgkmcnt(6)
    v_mfma_f32_32x32x16_bf16 v[96:111], v[192:195], v[48:51], v[96:111]
    ds_read_b64_tr_b16 v[40:41], v8 offset:20480
    ds_read_b64_tr_b16 v[42:43], v8 offset:20992
    s_waitcnt lgkmcnt(6)
    v_mfma_f32_32x32x16_bf16 v[112:127], v[192:195], v[52:55], v[112:127]
    ds_read_b64_tr_b16 v[44:45], v9 offset:20480
    ds_read_b64_tr_b16 v[46:47], v9 offset:20992
    s_waitcnt lgkmcnt(6)
    v_mfma_f32_32x32x16_bf16 v[96:111], v[196:199], v[32:35], v[96:111]
    ds_read_b64_tr_b16 v[48:49], v8 offset:22528
    ds_read_b64_tr_b16 v[50:51], v8 offset:23040
    s_waitcnt lgkmcnt(6)
    v_mfma_f32_32x32x16_bf16 v[112:127], v[196:199], v[36:39], v[112:127]
    ds_read_b64_tr_b16 v[52:53], v9 offset:22528
    ds_read_b64_tr_b16 v[54:55], v9 offset:23040
    s_waitcnt lgkmcnt(6)
    v_mfma_f32_32x32x16_bf16 v[96:111], v[200:203], v[40:43], v[96:111]
    ds_read_b64_tr_b16 v[32:33], v8 offset:24576
    ds_read_b64_tr_b16 v[34:35], v8 offset:25088
    s_waitcnt lgkmcnt(6)
    v_mfma_f32_32x32x16_bf16 v[112:127], v[200:203], v[44:47], v[112:127]
    ds_read_b64_tr_b16 v[36:37], v9 offset:24576
    ds_read_b64_tr_b16 v[38:39], v9 offset:25088
    s_waitcnt vmcnt(6)
    s_barrier
    s_mov_b64 exec, 1
    v_mov_b32 v153, 1
    global_store_dword v14, v153, s[8:9] offset:8 sc1
    s_mov_b64 exec, -1
    s_waitcnt lgkmcnt(6)
    v_mfma_f32_32x32x16_bf16 v[96:111], v[204:207], v[48:51], v[96:111]
    ds_read_b64_tr_b16 v[40:41], v8 offset:26624
    ds_read_b64_tr_b16 v[42:43], v8 offset:27136
    s_waitcnt lgkmcnt(6)
    v_mfma_f32_32x32x16_bf16 v[112:127], v[204:207], v[52:55], v[112:127]
    ds_read_b64_tr_b16 v[44:45], v9 offset:26624
    ds_read_b64_tr_b16 v[46:47], v9 offset:27136
    s_waitcnt lgkmcnt(6)
    v_mfma_f32_32x32x16_bf16 v[96:111], v[208:211], v[32:35], v[96:111]
    ds_read_b64_tr_b16 v[48:49], v8 offset:28672
    ds_read_b64_tr_b16 v[50:51], v8 offset:29184
    s_waitcnt lgkmcnt(6)
    v_mfma_f32_32x32x16_bf16 v[112:127], v[208:211], v[36:39], v[112:127]
    ds_read_b64_tr_b16 v[52:53], v9 offset:28672
    ds_read_b64_tr_b16 v[54:55], v9 offset:29184
    s_waitcnt lgkmcnt(6)
    v_mfma_f32_32x32x16_bf16 v[96:111], v[212:215], v[40:43], v[96:111]
    ds_read_b64_tr_b16 v[32:33], v8 offset:30720
    ds_read_b64_tr_b16 v[34:35], v8 offset:31232
    s_waitcnt lgkmcnt(6)
    v_mfma_f32_32x32x16_bf16 v[112:127], v[212:215], v[44:47], v[112:127]
    ds_read_b64_tr_b16 v[36:37], v9 offset:30720
    ds_read_b64_tr_b16 v[38:39], v9 offset:31232
    s_waitcnt lgkmcnt(6)
    v_mfma_f32_32x32x16_bf16 v[96:111], v[216:219], v[48:51], v[96:111]
    ds_read_b64_tr_b16 v[40:41], v8 offset:32768
    ds_read_b64_tr_b16 v[42:43], v8 offset:33280
    s_waitcnt lgkmcnt(6)
    v_mfma_f32_32x32x16_bf16 v[112:127], v[216:219], v[52:55], v[112:127]
    ds_read_b64_tr_b16 v[44:45], v9 offset:32768
    ds_read_b64_tr_b16 v[46:47], v9 offset:33280
    s_waitcnt lgkmcnt(6)
    v_mfma_f32_32x32x16_bf16 v[96:111], v[220:223], v[32:35], v[96:111]
    ds_read_b64_tr_b16 v[48:49], v8 offset:34816
    ds_read_b64_tr_b16 v[50:51], v8 offset:35328
    s_waitcnt lgkmcnt(6)
    v_mfma_f32_32x32x16_bf16 v[112:127], v[220:223], v[36:39], v[112:127]
    ds_read_b64_tr_b16 v[52:53], v9 offset:34816
    ds_read_b64_tr_b16 v[54:55], v9 offset:35328
    s_waitcnt lgkmcnt(6)
    v_mfma_f32_32x32x16_bf16 v[96:111], v[224:227], v[40:43], v[96:111]
    s_waitcnt vmcnt(1)
    s_barrier
    ds_read_b64_tr_b16 v[32:33], v8 offset:36864
    ds_read_b64_tr_b16 v[34:35], v8 offset:37376
    s_waitcnt lgkmcnt(6)
    v_mfma_f32_32x32x16_bf16 v[112:127], v[224:227], v[44:47], v[112:127]
    ds_read_b64_tr_b16 v[36:37], v9 offset:36864
    ds_read_b64_tr_b16 v[38:39], v9 offset:37376
    s_waitcnt lgkmcnt(6)
    v_mfma_f32_32x32x16_bf16 v[96:111], v[228:231], v[48:51], v[96:111]
    ds_read_b64_tr_b16 v[40:41], v8 offset:38912
    ds_read_b64_tr_b16 v[42:43], v8 offset:39424
    s_waitcnt lgkmcnt(6)
    v_mfma_f32_32x32x16_bf16 v[112:127], v[228:231], v[52:55], v[112:127]
    ds_read_b64_tr_b16 v[44:45], v9 offset:38912
    ds_read_b64_tr_b16 v[46:47], v9 offset:39424
    s_waitcnt lgkmcnt(6)
    v_mfma_f32_32x32x16_bf16 v[96:111], v[232:235], v[32:35], v[96:111]
    ds_read_b64_tr_b16 v[48:49], v8 offset:40960
    ds_read_b64_tr_b16 v[50:51], v8 offset:41472
    s_waitcnt lgkmcnt(6)
    v_mfma_f32_32x32x16_bf16 v[112:127], v[232:235], v[36:39], v[112:127]
    ds_read_b64_tr_b16 v[52:53], v9 offset:40960
    ds_read_b64_tr_b16 v[54:55], v9 offset:41472
    s_waitcnt lgkmcnt(6)
    v_mfma_f32_32x32x16_bf16 v[96:111], v[236:239], v[40:43], v[96:111]
    ds_read_b64_tr_b16 v[32:33], v8 offset:43008
    ds_read_b64_tr_b16 v[34:35], v8 offset:43520
    s_waitcnt lgkmcnt(6)
    v_mfma_f32_32x32x16_bf16 v[112:127], v[236:239], v[44:47], v[112:127]
    ds_read_b64_tr_b16 v[36:37], v9 offset:43008
    ds_read_b64_tr_b16 v[38:39], v9 offset:43520
    s_waitcnt lgkmcnt(6)
    v_mfma_f32_32x32x16_bf16 v[96:111], v[240:243], v[48:51], v[96:111]
    ds_read_b64_tr_b16 v[40:41], v8 offset:45056
    ds_read_b64_tr_b16 v[42:43], v8 offset:45568
    s_waitcnt lgkmcnt(6)
    v_mfma_f32_32x32x16_bf16 v[112:127], v[240:243], v[52:55], v[112:127]
    ds_read_b64_tr_b16 v[44:45], v9 offset:45056
    ds_read_b64_tr_b16 v[46:47], v9 offset:45568
    global_load_dword v31, v15, s[8:9] offset:8 sc1
    s_waitcnt lgkmcnt(6)
    v_mfma_f32_32x32x16_bf16 v[96:111], v[244:247], v[32:35], v[96:111]
    ds_read_b64_tr_b16 v[48:49], v8 offset:47104
    ds_read_b64_tr_b16 v[50:51], v8 offset:47616
    s_waitcnt lgkmcnt(6)
    v_mfma_f32_32x32x16_bf16 v[112:127], v[244:247], v[36:39], v[112:127]
    ds_read_b64_tr_b16 v[52:53], v9 offset:47104
    ds_read_b64_tr_b16 v[54:55], v9 offset:47616
    global_load_dwordx4 v[56:59], v12, s[8:9] offset:0 sc1
    global_load_dwordx4 v[60:63], v12, s[8:9] offset:512 sc1
    s_waitcnt lgkmcnt(6)
    v_mfma_f32_32x32x16_bf16 v[96:111], v[248:251], v[40:43], v[96:111]
    ds_read_b64_tr_b16 v[32:33], v8 offset:49152
    ds_read_b64_tr_b16 v[34:35], v8 offset:49664
    s_waitcnt lgkmcnt(6)
    v_mfma_f32_32x32x16_bf16 v[112:127], v[248:251], v[44:47], v[112:127]
    ds_read_b64_tr_b16 v[36:37], v9 offset:49152
    ds_read_b64_tr_b16 v[38:39], v9 offset:49664
    s_waitcnt lgkmcnt(6)
    v_mfma_f32_32x32x16_bf16 v[96:111], v[252:255], v[48:51], v[96:111]
    ds_read_b64_tr_b16 v[40:41], v8 offset:51200
    ds_read_b64_tr_b16 v[42:43], v8 offset:51712
    s_waitcnt lgkmcnt(6)
    v_mfma_f32_32x32x16_bf16 v[112:127], v[252:255], v[52:55], v[112:127]
    ds_read_b64_tr_b16 v[44:45], v9 offset:51200
    ds_read_b64_tr_b16 v[46:47], v9 offset:51712
    s_waitcnt lgkmcnt(6)
    v_mfma_f32_32x32x16_bf16 v[96:111], a[224:227], v[32:35], v[96:111]
    ds_read_b64_tr_b16 v[48:49], v8 offset:53248
    ds_read_b64_tr_b16 v[50:51], v8 offset:53760
    s_waitcnt lgkmcnt(6)
    v_mfma_f32_32x32x16_bf16 v[112:127], a[224:227], v[36:39], v[112:127]
    ds_read_b64_tr_b16 v[52:53], v9 offset:53248
    ds_read_b64_tr_b16 v[54:55], v9 offset:53760
    s_waitcnt lgkmcnt(6)
    v_mfma_f32_32x32x16_bf16 v[96:111], a[228:231], v[40:43], v[96:111]
    ds_read_b64_tr_b16 v[32:33], v8 offset:55296
    ds_read_b64_tr_b16 v[34:35], v8 offset:55808
    s_waitcnt lgkmcnt(6)
    v_mfma_f32_32x32x16_bf16 v[112:127], a[228:231], v[44:47], v[112:127]
    ds_read_b64_tr_b16 v[36:37], v9 offset:55296
    ds_read_b64_tr_b16 v[38:39], v9 offset:55808
    s_waitcnt vmcnt(2)
    v_cmp_gt_u32 vcc, 1, v31
    s_nop 1
    s_cbranch_vccnz pollHE_1
pollHE_1_ok:
    global_load_dwordx4 v[128:131], v7, s[42:43] offset:0 sc1
    s_waitcnt lgkmcnt(6)
    v_mfma_f32_32x32x16_bf16 v[96:111], a[232:235], v[48:51], v[96:111]
    ds_read_b64_tr_b16 v[40:41], v8 offset:57344
    ds_read_b64_tr_b16 v[42:43], v8 offset:57856
    s_waitcnt lgkmcnt(6)
    v_mfma_f32_32x32x16_bf16 v[112:127], a[232:235], v[52:55], v[112:127]
    ds_read_b64_tr_b16 v[44:45], v9 offset:57344
    ds_read_b64_tr_b16 v[46:47], v9 offset:57856
    global_load_dwordx4 v[132:135], v7, s[42:43] offset:1024 sc1
    s_waitcnt lgkmcnt(6)
    v_mfma_f32_32x32x16_bf16 v[96:111], a[236:239], v[32:35], v[96:111]
    ds_read_b64_tr_b16 v[48:49], v8 offset:59392
    ds_read_b64_tr_b16 v[50:51], v8 offset:59904
    s_waitcnt lgkmcnt(6)
    v_mfma_f32_32x32x16_bf16 v[112:127], a[236:239], v[36:39], v[112:127]
    ds_read_b64_tr_b16 v[52:53], v9 offset:59392
    ds_read_b64_tr_b16 v[54:55], v9 offset:59904
    global_load_dwordx4 v[136:139], v7, s[42:43] offset:2048 sc1
    s_waitcnt lgkmcnt(6)
    v_mfma_f32_32x32x16_bf16 v[96:111], a[240:243], v[40:43], v[96:111]
    ds_read_b64_tr_b16 v[32:33], v8 offset:61440
    ds_read_b64_tr_b16 v[34:35], v8 offset:61952
    s_waitcnt lgkmcnt(6)
    v_mfma_f32_32x32x16_bf16 v[112:127], a[240:243], v[44:47], v[112:127]
    ds_read_b64_tr_b16 v[36:37], v9 offset:61440
    ds_read_b64_tr_b16 v[38:39], v9 offset:61952
    global_load_dwordx4 v[140:143], v7, s[42:43] offset:3072 sc1
    v_add_u32 v7, 4096, v7
    s_waitcnt vmcnt(4)
ffn_chk1_1:
    v_min_u32 v2, v57, v59
    v_min3_u32 v2, v2, v61, v63
    v_cmp_eq_u32 vcc, 0, v2
    s_nop 1
    s_cbranch_vccnz ffn_retry1_1
    v_add_f32 v16, v56, v58
    v_add_f32 v18, v60, v62
    v_add_f32 v17, v57, v59
    v_add_f32 v19, v61, v63
    v_mul_f32 v16, s26, v16
    v_mul_f32 v18, s26, v18
    s_waitcnt lgkmcnt(6)
    v_mfma_f32_32x32x16_bf16 v[96:111], a[244:247], v[48:51], v[96:111]
    ds_read_b64_tr_b16 v[40:41], v8 offset:63488
    ds_read_b64_tr_b16 v[42:43], v8 offset:64000
    v_mul_f32 v17, s26, v17
    v_mul_f32 v19, s26, v19
    v_cvt_pk_bf16_f32 v56, -v16, -v16
    v_cvt_pk_bf16_f32 v60, -v18, -v18
    v_mov_b32 v58, 0
    v_mov_b32 v59, 0
    s_waitcnt lgkmcnt(6)
    v_mfma_f32_32x32x16_bf16 v[112:127], a[244:247], v[52:55], v[112:127]
    ds_read_b64_tr_b16 v[44:45], v9 offset:63488
    ds_read_b64_tr_b16 v[46:47], v9 offset:64000
    global_load_dwordx4 v[144:147], v7, s[42:43] offset:0 sc1
    v_mov_b32 v57, v56
    v_mov_b32 v61, v60
    v_mov_b32 v62, 0
    v_mov_b32 v63, 0
    v_fma_f32 v17, -v16, v16, v17
    v_fma_f32 v19, -v18, v18, v19
    s_waitcnt lgkmcnt(6)
    v_mfma_f32_32x32x16_bf16 v[96:111], a[248:251], v[32:35], v[96:111]
    v_max_f32 v17, 0, v17
    v_max_f32 v19, 0, v19
    v_cvt_pk_bf16_f32 v17, 0, v17
    v_cvt_pk_bf16_f32 v19, 0, v19
    v_add_f32 v17, s27, v17
    v_add_f32 v19, s27, v19
    s_waitcnt lgkmcnt(4)
    v_mfma_f32_32x32x16_bf16 v[112:127], a[248:251], v[36:39], v[112:127]
    global_load_dwordx4 v[148:151], v7, s[42:43] offset:1024 sc1
    v_cvt_pk_bf16_f32 v17, 0, v17
    v_cvt_pk_bf16_f32 v19, 0, v19
    v_sqrt_f32 v17, v17
    v_sqrt_f32 v19, v19
    v_cvt_pk_bf16_f32 v17, 0, v17
    v_cvt_pk_bf16_f32 v19, 0, v19
    s_waitcnt lgkmcnt(2)
    v_mfma_f32_32x32x16_bf16 v[96:111], a[252:255], v[40:43], v[96:111]
    v_mfma_f32_32x32x16_bf16 v[96:111], v[156:159], v[56:59], v[96:111]
    v_rcp_f32 v16, v17
    v_rcp_f32 v18, v19
    v_mul_f32 v16, s31, v16
    v_mul_f32 v18, s31, v18
    s_waitcnt lgkmcnt(0)
    v_mfma_f32_32x32x16_bf16 v[112:127], a[252:255], v[44:47], v[112:127]
    v_mfma_f32_32x32x16_bf16 v[112:127], v[156:159], v[60:63], v[112:127]
    ds_read_b64_tr_b16 v[24:25], v10 offset:0
    ds_read_b64_tr_b16 v[26:27], v10 offset:1024
    global_load_dwordx4 v[32:35], v7, s[42:43] offset:2048 sc1
    global_load_dwordx4 v[36:39], v7, s[42:43] offset:3072 sc1
    v_add_u32 v7, 4096, v7
    global_load_dwordx4 v[40:43], v7, s[42:43] offset:0 sc1
    v_pk_mul_f32 v[48:49], v[96:97], v[16:17] op_sel:[0,0] op_sel_hi:[1,0]
    v_pk_mul_f32 v[50:51], v[98:99], v[16:17] op_sel:[0,0] op_sel_hi:[1,0]
    v_pk_mul_f32 v[52:53], v[100:101], v[16:17] op_sel:[0,0] op_sel_hi:[1,0]
    v_pk_mul_f32 v[54:55], v[102:103], v[16:17] op_sel:[0,0] op_sel_hi:[1,0]
    v_pk_mul_f32 v[56:57], v[104:105], v[16:17] op_sel:[0,0] op_sel_hi:[1,0]
    v_pk_mul_f32 v[58:59], v[106:107], v[16:17] op_sel:[0,0] op_sel_hi:[1,0]
    v_pk_mul_f32 v[60:61], v[108:109], v[16:17] op_sel:[0,0] op_sel_hi:[1,0]
    v_pk_mul_f32 v[62:63], v[110:111], v[16:17] op_sel:[0,0] op_sel_hi:[1,0]
    v_exp_f32 v48, v48
    v_exp_f32 v49, v49
    v_exp_f32 v50, v50
    v_exp_f32 v51, v51
    v_exp_f32 v52, v52
    v_exp_f32 v53, v53
    global_load_dwordx4 v[44:47], v7, s[42:43] offset:1024 sc1
    v_exp_f32 v54, v54
    v_exp_f32 v55, v55
    v_exp_f32 v56, v56
    v_exp_f32 v57, v57
    v_exp_f32 v58, v58
    v_exp_f32 v59, v59
    v_exp_f32 v60, v60
    v_exp_f32 v61, v61
    v_exp_f32 v62, v62
    v_exp_f32 v63, v63
    v_pk_fma_f32 v[48:49], v[48:49], v[16:17], v[16:17] op_sel:[0,1,1] op_sel_hi:[1,1,1]
    v_pk_fma_f32 v[50:51], v[50:51], v[16:17], v[16:17] op_sel:[0,1,1] op_sel_hi:[1,1,1]
    v_pk_fma_f32 v[52:53], v[52:53], v[16:17], v[16:17] op_sel:[0,1,1] op_sel_hi:[1,1,1]
    v_pk_fma_f32 v[54:55], v[54:55], v[16:17], v[16:17] op_sel:[0,1,1] op_sel_hi:[1,1,1]
    v_pk_fma_f32 v[56:57], v[56:57], v[16:17], v[16:17] op_sel:[0,1,1] op_sel_hi:[1,1,1]
    v_pk_fma_f32 v[58:59], v[58:59], v[16:17], v[16:17] op_sel:[0,1,1] op_sel_hi:[1,1,1]
    v_pk_fma_f32 v[60:61], v[60:61], v[16:17], v[16:17] op_sel:[0,1,1] op_sel_hi:[1,1,1]
    v_pk_fma_f32 v[62:63], v[62:63], v[16:17], v[16:17] op_sel:[0,1,1] op_sel_hi:[1,1,1]
    v_rcp_f32 v48, v48
    v_rcp_f32 v49, v49
    v_rcp_f32 v50, v50
    v_rcp_f32 v51, v51
    v_rcp_f32 v52, v52
    v_rcp_f32 v53, v53
    v_rcp_f32 v54, v54
    v_rcp_f32 v55, v55
    v_rcp_f32 v56, v56
    v_rcp_f32 v57, v57
    v_rcp_f32 v58, v58
    v_rcp_f32 v59, v59
    v_rcp_f32 v60, v60
    v_rcp_f32 v61, v61
    v_rcp_f32 v62, v62
    v_rcp_f32 v63, v63
    v_pk_mul_f32 v[96:97], v[96:97], v[48:49]
    v_pk_mul_f32 v[98:99], v[98:99], v[50:51]
    v_pk_mul_f32 v[100:101], v[100:101], v[52:53]
    v_pk_mul_f32 v[102:103], v[102:103], v[54:55]
    v_pk_mul_f32 v[104:105], v[104:105], v[56:57]
    v_pk_mul_f32 v[106:107], v[106:107], v[58:59]
    v_pk_mul_f32 v[108:109], v[108:109], v[60:61]
    v_pk_mul_f32 v[110:111], v[110:111], v[62:63]
    v_cvt_pk_bf16_f32 v96, v96, v97
    v_cvt_pk_bf16_f32 v97, v98, v99
    v_cvt_pk_bf16_f32 v98, v100, v101
    v_cvt_pk_bf16_f32 v99, v102, v103
    v_cvt_pk_bf16_f32 v100, v104, v105
    v_cvt_pk_bf16_f32 v101, v106, v107
    v_cvt_pk_bf16_f32 v102, v108, v109
    v_cvt_pk_bf16_f32 v103, v110, v111
    global_store_dwordx4 v5, v[96:99], s[40:41] sc1
    global_store_dwordx4 v5, v[100:103], s[40:41] offset:1024 sc1
    v_pk_mul_f32 v[48:49], v[112:113], v[18:19] op_sel:[0,0] op_sel_hi:[1,0]
    v_pk_mul_f32 v[50:51], v[114:115], v[18:19] op_sel:[0,0] op_sel_hi:[1,0]
    v_pk_mul_f32 v[52:53], v[116:117], v[18:19] op_sel:[0,0] op_sel_hi:[1,0]
    v_pk_mul_f32 v[54:55], v[118:119], v[18:19] op_sel:[0,0] op_sel_hi:[1,0]
    v_pk_mul_f32 v[56:57], v[120:121], v[18:19] op_sel:[0,0] op_sel_hi:[1,0]
    v_pk_mul_f32 v[58:59], v[122:123], v[18:19] op_sel:[0,0] op_sel_hi:[1,0]
    v_pk_mul_f32 v[60:61], v[124:125], v[18:19] op_sel:[0,0] op_sel_hi:[1,0]
    v_pk_mul_f32 v[62:63], v[126:127], v[18:19] op_sel:[0,0] op_sel_hi:[1,0]
    v_exp_f32 v48, v48
    v_exp_f32 v49, v49
    v_exp_f32 v50, v50
    v_exp_f32 v51, v51
    v_exp_f32 v52, v52
    v_exp_f32 v53, v53
    v_exp_f32 v54, v54
    v_exp_f32 v55, v55
    v_exp_f32 v56, v56
    v_exp_f32 v57, v57
    v_exp_f32 v58, v58
    v_exp_f32 v59, v59
    v_exp_f32 v60, v60
    v_exp_f32 v61, v61
    v_exp_f32 v62, v62
    v_exp_f32 v63, v63
    v_pk_fma_f32 v[48:49], v[48:49], v[18:19], v[18:19] op_sel:[0,1,1] op_sel_hi:[1,1,1]
    v_pk_fma_f32 v[50:51], v[50:51], v[18:19], v[18:19] op_sel:[0,1,1] op_sel_hi:[1,1,1]
    v_pk_fma_f32 v[52:53], v[52:53], v[18:19], v[18:19] op_sel:[0,1,1] op_sel_hi:[1,1,1]
    v_pk_fma_f32 v[54:55], v[54:55], v[18:19], v[18:19] op_sel:[0,1,1] op_sel_hi:[1,1,1]
    v_pk_fma_f32 v[56:57], v[56:57], v[18:19], v[18:19] op_sel:[0,1,1] op_sel_hi:[1,1,1]
    v_pk_fma_f32 v[58:59], v[58:59], v[18:19], v[18:19] op_sel:[0,1,1] op_sel_hi:[1,1,1]
    v_pk_fma_f32 v[60:61], v[60:61], v[18:19], v[18:19] op_sel:[0,1,1] op_sel_hi:[1,1,1]
    v_pk_fma_f32 v[62:63], v[62:63], v[18:19], v[18:19] op_sel:[0,1,1] op_sel_hi:[1,1,1]
    v_rcp_f32 v48, v48
    v_rcp_f32 v49, v49
    v_rcp_f32 v50, v50
    v_rcp_f32 v51, v51
    v_rcp_f32 v52, v52
    v_rcp_f32 v53, v53
    v_rcp_f32 v54, v54
    v_rcp_f32 v55, v55
    v_rcp_f32 v56, v56
    v_rcp_f32 v57, v57
    v_rcp_f32 v58, v58
    v_rcp_f32 v59, v59
    v_rcp_f32 v60, v60
    v_rcp_f32 v61, v61
    v_rcp_f32 v62, v62
    v_rcp_f32 v63, v63
    v_pk_mul_f32 v[112:113], v[112:113], v[48:49]
    v_pk_mul_f32 v[114:115], v[114:115], v[50:51]
    v_pk_mul_f32 v[116:117], v[116:117], v[52:53]
    v_pk_mul_f32 v[118:119], v[118:119], v[54:55]
    v_pk_mul_f32 v[120:121], v[120:121], v[56:57]
    v_pk_mul_f32 v[122:123], v[122:123], v[58:59]
    v_pk_mul_f32 v[124:125], v[124:125], v[60:61]
    v_pk_mul_f32 v[126:127], v[126:127], v[62:63]
    v_cvt_pk_bf16_f32 v112, v112, v113
    v_cvt_pk_bf16_f32 v113, v114, v115
    v_cvt_pk_bf16_f32 v114, v116, v117
    v_cvt_pk_bf16_f32 v115, v118, v119
    v_cvt_pk_bf16_f32 v116, v120, v121
    v_cvt_pk_bf16_f32 v117, v122, v123
    v_cvt_pk_bf16_f32 v118, v124, v125
    v_cvt_pk_bf16_f32 v119, v126, v127
    global_store_dwordx4 v6, v[112:115], s[40:41] sc1
    global_store_dwordx4 v6, v[116:119], s[40:41] offset:1024 sc1
    s_sub_u32 s40, s40, 3670016
    s_subb_u32 s41, s41, 0
    v_and_b32 v3, 31, v1
    v_lshrrev_b32 v4, 5, v1
    s_lshl_b32 s24, s32, 5
    v_add_u32 v3, s24, v3
    s_lshl_b32 s24, s46, 1
    s_add_u32 s44, s6, s24
    s_addc_u32 s45, s7, 0
    v_lshlrev_b32 v28, 4, v4
    v_lshl_add_u32 v28, v3, 10, v28
    s_lshl_b32 s24, s10, 13
    s_add_u32 s24, s24, 65536
    v_add_u32 v10, s24, v5
    v_xor_b32 v11, 0x2000, v10
    v_xor_b32 v13, 0x4000, v10
    v_xor_b32 v6, 0x6000, v10
    s_waitcnt lgkmcnt(0)
ffn_g2_1:
    global_load_dwordx4 v[48:51], v7, s[42:43] offset:2048 sc1
    global_load_dwordx4 v[52:55], v7, s[42:43] offset:3072 sc1
    v_add_u32 v7, 4096, v7
    global_load_dwordx4 v[56:59], v7, s[42:43] offset:0 sc1
    s_waitcnt vmcnt(16)
    v_mfma_f32_32x32x16_bf16 v[64:79], a[0:3], v[128:131], 0
    global_load_dwordx4 v[60:63], v7, s[42:43] offset:1024 sc1
    v_mfma_f32_32x32x16_bf16 v[80:95], a[4:7], v[128:131], 0
    s_waitcnt vmcnt(16)
    v_mfma_f32_32x32x16_bf16 v[64:79], a[8:11], v[132:135], v[64:79]
    global_load_dwordx4 v[128:131], v7, s[42:43] offset:2048 sc1
    v_mfma_f32_32x32x16_bf16 v[80:95], a[12:15], v[132:135], v[80:95]
    s_waitcnt vmcnt(16)
    v_mfma_f32_32x32x16_bf16 v[64:79], a[16:19], v[136:139], v[64:79]
    global_load_dwordx4 v[132:135], v7, s[42:43] offset:3072 sc1
    v_add_u32 v7, 4096, v7
    v_mfma_f32_32x32x16_bf16 v[80:95], a[20:23], v[136:139], v[80:95]
    s_waitcnt vmcnt(16)
    v_mfma_f32_32x32x16_bf16 v[64:79], a[24:27], v[140:143], v[64:79]
    global_load_dwordx4 v[136:139], v7, s[42:43] offset:0 sc1
    v_mfma_f32_32x32x16_bf16 v[80:95], a[28:31], v[140:143], v[80:95]
    s_waitcnt vmcnt(16)
    v_mfma_f32_32x32x16_bf16 v[64:79], a[32:35], v[144:147], v[64:79]
    global_load_dwordx4 v[140:143], v7, s[42:43] offset:1024 sc1
    v_mfma_f32_32x32x16_bf16 v[80:95], a[36:39], v[144:147], v[80:95]
    s_waitcnt vmcnt(16)
    v_mfma_f32_32x32x16_bf16 v[64:79], a[40:43], v[148:151], v[64:79]
    global_load_dwordx4 v[144:147], v7, s[42:43] offset:2048 sc1
    v_mfma_f32_32x32x16_bf16 v[80:95], a[44:47], v[148:151], v[80:95]
    s_waitcnt vmcnt(16)
    v_mfma_f32_32x32x16_bf16 v[64:79], a[48:51], v[32:35], v[64:79]
    global_load_dwordx4 v[148:151], v7, s[42:43] offset:3072 sc1
    v_add_u32 v7, 4096, v7
    v_mfma_f32_32x32x16_bf16 v[80:95], a[52:55], v[32:35], v[80:95]
    s_waitcnt vmcnt(16)
    v_mfma_f32_32x32x16_bf16 v[64:79], a[56:59], v[36:39], v[64:79]
    global_load_dwordx4 v[32:35], v7, s[42:43] offset:0 sc1
    v_mfma_f32_32x32x16_bf16 v[80:95], a[60:63], v[36:39], v[80:95]
    s_waitcnt vmcnt(16)
    v_mfma_f32_32x32x16_bf16 v[64:79], a[64:67], v[40:43], v[64:79]
    global_load_dwordx4 v[36:39], v7, s[42:43] offset:1024 sc1
    v_mfma_f32_32x32x16_bf16 v[80:95], a[68:71], v[40:43], v[80:95]
    s_waitcnt vmcnt(16)
    v_mfma_f32_32x32x16_bf16 v[64:79], a[72:75], v[44:47], v[64:79]
    global_load_dwordx4 v[40:43], v7, s[42:43] offset:2048 sc1
    v_mfma_f32_32x32x16_bf16 v[80:95], a[76:79], v[44:47], v[80:95]
    s_waitcnt vmcnt(12)
    v_mfma_f32_32x32x16_bf16 v[64:79], a[80:83], v[48:51], v[64:79]
    global_load_dwordx4 v[44:47], v7, s[42:43] offset:3072 sc1
    v_add_u32 v7, 4096, v7
    v_mfma_f32_32x32x16_bf16 v[80:95], a[84:87], v[48:51], v[80:95]
    s_barrier
    s_mov_b64 exec, 1
    v_mov_b32 v153, 1
    global_store_dword v14, v153, s[8:9] offset:12 sc1
    s_mov_b64 exec, -1
    s_waitcnt vmcnt(13)
    v_mfma_f32_32x32x16_bf16 v[64:79], a[88:91], v[52:55], v[64:79]
    global_load_dwordx4 v[48:51], v7, s[42:43] offset:0 sc1
    v_mfma_f32_32x32x16_bf16 v[80:95], a[92:95], v[52:55], v[80:95]
    s_waitcnt vmcnt(13)
    v_mfma_f32_32x32x16_bf16 v[64:79], a[96:99], v[56:59], v[64:79]
    global_load_dwordx4 v[52:55], v7, s[42:43] offset:1024 sc1
    v_mfma_f32_32x32x16_bf16 v[80:95], a[100:103], v[56:59], v[80:95]
    s_waitcnt vmcnt(13)
    v_mfma_f32_32x32x16_bf16 v[64:79], a[104:107], v[60:63], v[64:79]
    global_load_dwordx4 v[56:59], v7, s[42:43] offset:2048 sc1
    v_mfma_f32_32x32x16_bf16 v[80:95], a[108:111], v[60:63], v[80:95]
    s_waitcnt vmcnt(13)
    v_mfma_f32_32x32x16_bf16 v[64:79], a[112:115], v[128:131], v[64:79]
    global_load_dwordx4 v[60:63], v7, s[42:43] offset:3072 sc1
    v_add_u32 v7, 3670016, v5
    v_mfma_f32_32x32x16_bf16 v[80:95], a[116:119], v[128:131], v[80:95]
    s_waitcnt vmcnt(13)
    v_mfma_f32_32x32x16_bf16 v[64:79], a[120:123], v[132:135], v[64:79]
    v_mfma_f32_32x32x16_bf16 v[80:95], a[124:127], v[132:135], v[80:95]
    s_waitcnt vmcnt(12)
    v_mfma_f32_32x32x16_bf16 v[64:79], a[128:131], v[136:139], v[64:79]
    v_mfma_f32_32x32x16_bf16 v[80:95], a[132:135], v[136:139], v[80:95]
    s_waitcnt vmcnt(11)
    v_mfma_f32_32x32x16_bf16 v[64:79], a[136:139], v[140:143], v[64:79]
    v_mfma_f32_32x32x16_bf16 v[80:95], a[140:143], v[140:143], v[80:95]
    s_waitcnt vmcnt(10)
    v_mfma_f32_32x32x16_bf16 v[64:79], a[144:147], v[144:147], v[64:79]
    v_mfma_f32_32x32x16_bf16 v[80:95], a[148:151], v[144:147], v[80:95]
    s_waitcnt vmcnt(9)
    v_mfma_f32_32x32x16_bf16 v[64:79], a[152:155], v[148:151], v[64:79]
    v_mfma_f32_32x32x16_bf16 v[80:95], a[156:159], v[148:151], v[80:95]
    s_waitcnt vmcnt(8)
    v_mfma_f32_32x32x16_bf16 v[64:79], a[160:163], v[32:35], v[64:79]
    v_mfma_f32_32x32x16_bf16 v[80:95], a[164:167], v[32:35], v[80:95]
    s_waitcnt vmcnt(7)
    v_mfma_f32_32x32x16_bf16 v[64:79], a[168:171], v[36:39], v[64:79]
    v_mfma_f32_32x32x16_bf16 v[80:95], a[172:175], v[36:39], v[80:95]
    s_waitcnt vmcnt(6)
    v_mfma_f32_32x32x16_bf16 v[64:79], a[176:179], v[40:43], v[64:79]
    v_mfma_f32_32x32x16_bf16 v[80:95], a[180:183], v[40:43], v[80:95]
    s_waitcnt vmcnt(5)
    v_mfma_f32_32x32x16_bf16 v[64:79], a[184:187], v[44:47], v[64:79]
    v_mfma_f32_32x32x16_bf16 v[80:95], a[188:191], v[44:47], v[80:95]
    s_waitcnt vmcnt(3)
    v_mfma_f32_32x32x16_bf16 v[64:79], a[192:195], v[48:51], v[64:79]
    v_mfma_f32_32x32x16_bf16 v[80:95], a[196:199], v[48:51], v[80:95]
    s_waitcnt vmcnt(2)
    v_mfma_f32_32x32x16_bf16 v[64:79], a[200:203], v[52:55], v[64:79]
    v_mfma_f32_32x32x16_bf16 v[80:95], a[204:207], v[52:55], v[80:95]
    global_load_dword v31, v15, s[8:9] offset:12 sc1
    s_waitcnt vmcnt(2)
    v_mfma_f32_32x32x16_bf16 v[64:79], a[208:211], v[56:59], v[64:79]
    v_mfma_f32_32x32x16_bf16 v[80:95], a[212:215], v[56:59], v[80:95]
    s_waitcnt vmcnt(1)
    v_mfma_f32_32x32x16_bf16 v[64:79], a[216:219], v[60:63], v[64:79]
    v_mfma_f32_32x32x16_bf16 v[80:95], a[220:223], v[60:63], v[80:95]
    s_waitcnt vmcnt(0)
    v_cmp_gt_u32 vcc, 1, v31
    s_nop 1
    s_cbranch_vccnz pollHL_1
pollHL_1_ok:
    global_load_dwordx4 v[128:131], v7, s[42:43] offset:0 sc1
    global_load_dwordx4 v[132:135], v7, s[42:43] offset:1024 sc1
    global_load_dwordx4 v[136:139], v7, s[42:43] offset:2048 sc1
    global_load_dwordx4 v[140:143], v7, s[42:43] offset:3072 sc1
    v_add_u32 v7, 4096, v7
    s_nop 0
    ds_write_b128 v11, v[72:75] offset:2048
    ds_write_b128 v11, v[76:79] offset:3072
    ds_write_b128 v13, v[80:83] offset:4096
    ds_write_b128 v13, v[84:87] offset:5120
    ds_write_b128 v6, v[88:91] offset:6144
    ds_write_b128 v6, v[92:95] offset:7168
    global_load_dwordx4 v[144:147], v7, s[42:43] offset:0 sc1
    global_load_dwordx4 v[148:151], v7, s[42:43] offset:1024 sc1
    global_load_dwordx4 v[32:35], v7, s[42:43] offset:2048 sc1
    global_load_dwordx4 v[36:39], v7, s[42:43] offset:3072 sc1
    v_add_u32 v7, 4096, v7
    global_load_dwordx4 v[40:43], v7, s[42:43] offset:0 sc1
    s_waitcnt lgkmcnt(0)
    s_barrier
    ds_read_b128 v[72:75], v10 offset:2048
    ds_read_b128 v[76:79], v10 offset:3072
    ds_read_b128 v[80:83], v10 offset:4096
    ds_read_b128 v[84:87], v10 offset:5120
    ds_read_b128 v[88:91], v10 offset:6144
    ds_read_b128 v[92:95], v10 offset:7168
    global_load_dwordx4 v[44:47], v7, s[42:43] offset:1024 sc1
    global_load_dwordx4 v[48:51], v7, s[42:43] offset:2048 sc1
    s_waitcnt lgkmcnt(4)
    v_pk_add_f32 v[64:65], v[64:65], v[72:73]
    v_pk_add_f32 v[66:67], v[66:67], v[74:75]
    v_pk_add_f32 v[68:69], v[68:69], v[76:77]
    v_pk_add_f32 v[70:71], v[70:71], v[78:79]
    v_lshlrev_b32 v72, 16, v20
    v_and_b32 v73, 0xffff0000, v20
    v_lshlrev_b32 v74, 16, v21
    v_and_b32 v75, 0xffff0000, v21
    v_lshlrev_b32 v76, 16, v22
    global_load_dwordx4 v[52:55], v7, s[42:43] offset:3072 sc1
    v_add_u32 v7, 4096, v7
    v_and_b32 v77, 0xffff0000, v22
    v_lshlrev_b32 v78, 16, v23
    v_and_b32 v79, 0xffff0000, v23
    s_waitcnt lgkmcnt(0)
    v_pk_add_f32 v[80:81], v[80:81], v[88:89]
    v_pk_add_f32 v[82:83], v[82:83], v[90:91]
    v_pk_add_f32 v[84:85], v[84:85], v[92:93]
    v_pk_add_f32 v[86:87], v[86:87], v[94:95]
    v_pk_add_f32 v[64:65], v[64:65], v[80:81]
    v_pk_add_f32 v[66:67], v[66:67], v[82:83]
    global_load_dwordx4 v[56:59], v7, s[42:43] offset:0 sc1
    v_pk_add_f32 v[68:69], v[68:69], v[84:85]
    v_pk_add_f32 v[70:71], v[70:71], v[86:87]
    v_cvt_pk_bf16_f32 v64, 0, v64
    v_cvt_pk_bf16_f32 v65, 0, v65
    v_cvt_pk_bf16_f32 v66, 0, v66
    v_cvt_pk_bf16_f32 v67, 0, v67
    v_cvt_pk_bf16_f32 v68, 0, v68
    v_cvt_pk_bf16_f32 v69, 0, v69
    v_cvt_pk_bf16_f32 v70, 0, v70
    v_cvt_pk_bf16_f32 v71, 0, v71
    v_pk_add_f32 v[64:65], v[64:65], v[72:73]
    v_pk_add_f32 v[66:67], v[66:67], v[74:75]
    v_pk_add_f32 v[68:69], v[68:69], v[76:77]
    v_pk_add_f32 v[70:71], v[70:71], v[78:79]
    v_cvt_pk_bf16_f32 v80, v64, v65
    v_cvt_pk_bf16_f32 v81, v66, v67
    v_cvt_pk_bf16_f32 v82, v68, v69
    v_cvt_pk_bf16_f32 v83, v70, v71
    s_nop 0
    v_permlane32_swap_b32 v80, v82
    v_permlane32_swap_b32 v81, v83
    global_store_dwordx4 v28, v[80:83], s[44:45]
    v_add_u32 v28, 0x100000, v28
    s_waitcnt vmcnt(13)
    v_mfma_f32_32x32x16_bf16 v[96:111], a[0:3], v[128:131], 0
    global_load_dwordx4 v[60:63], v7, s[42:43] offset:1024 sc1
    v_mfma_f32_32x32x16_bf16 v[112:127], a[4:7], v[128:131], 0
    s_waitcnt vmcnt(13)
    v_mfma_f32_32x32x16_bf16 v[96:111], a[8:11], v[132:135], v[96:111]
    global_load_dwordx4 v[128:131], v7, s[42:43] offset:2048 sc1
    v_mfma_f32_32x32x16_bf16 v[112:127], a[12:15], v[132:135], v[112:127]
    s_waitcnt vmcnt(13)
    v_mfma_f32_32x32x16_bf16 v[96:111], a[16:19], v[136:139], v[96:111]
    global_load_dwordx4 v[132:135], v7, s[42:43] offset:3072 sc1
    v_add_u32 v7, 4096, v7
    v_mfma_f32_32x32x16_bf16 v[112:127], a[20:23], v[136:139], v[112:127]
    s_waitcnt vmcnt(13)
    v_mfma_f32_32x32x16_bf16 v[96:111], a[24:27], v[140:143], v[96:111]
    global_load_dwordx4 v[136:139], v7, s[42:43] offset:0 sc1
    v_mfma_f32_32x32x16_bf16 v[112:127], a[28:31], v[140:143], v[112:127]
    s_waitcnt vmcnt(13)
    v_mfma_f32_32x32x16_bf16 v[96:111], a[32:35], v[144:147], v[96:111]
    global_load_dwordx4 v[140:143], v7, s[42:43] offset:1024 sc1
    v_mfma_f32_32x32x16_bf16 v[112:127], a[36:39], v[144:147], v[112:127]
    s_waitcnt vmcnt(13)
    v_mfma_f32_32x32x16_bf16 v[96:111], a[40:43], v[148:151], v[96:111]
    global_load_dwordx4 v[144:147], v7, s[42:43] offset:2048 sc1
    v_mfma_f32_32x32x16_bf16 v[112:127], a[44:47], v[148:151], v[112:127]
    s_waitcnt vmcnt(13)
    v_mfma_f32_32x32x16_bf16 v[96:111], a[48:51], v[32:35], v[96:111]
    global_load_dwordx4 v[148:151], v7, s[42:43] offset:3072 sc1
    v_add_u32 v7, 4096, v7
    v_mfma_f32_32x32x16_bf16 v[112:127], a[52:55], v[32:35], v[112:127]
    s_waitcnt vmcnt(13)
    v_mfma_f32_32x32x16_bf16 v[96:111], a[56:59], v[36:39], v[96:111]
    global_load_dwordx4 v[32:35], v7, s[42:43] offset:0 sc1
    v_mfma_f32_32x32x16_bf16 v[112:127], a[60:63], v[36:39], v[112:127]
    s_waitcnt vmcnt(13)
    v_mfma_f32_32x32x16_bf16 v[96:111], a[64:67], v[40:43], v[96:111]
    global_load_dwordx4 v[36:39], v7, s[42:43] offset:1024 sc1
    v_mfma_f32_32x32x16_bf16 v[112:127], a[68:71], v[40:43], v[112:127]
    s_waitcnt vmcnt(13)
    v_mfma_f32_32x32x16_bf16 v[96:111], a[72:75], v[44:47], v[96:111]
    global_load_dwordx4 v[40:43], v7, s[42:43] offset:2048 sc1
    v_mfma_f32_32x32x16_bf16 v[112:127], a[76:79], v[44:47], v[112:127]
    s_waitcnt vmcnt(13)
    v_mfma_f32_32x32x16_bf16 v[96:111], a[80:83], v[48:51], v[96:111]
    global_load_dwordx4 v[44:47], v7, s[42:43] offset:3072 sc1
    v_add_u32 v7, 4096, v7
    v_mfma_f32_32x32x16_bf16 v[112:127], a[84:87], v[48:51], v[112:127]
    s_waitcnt vmcnt(13)
    v_mfma_f32_32x32x16_bf16 v[96:111], a[88:91], v[52:55], v[96:111]
    global_load_dwordx4 v[48:51], v7, s[42:43] offset:0 sc1
    v_mfma_f32_32x32x16_bf16 v[112:127], a[92:95], v[52:55], v[112:127]
    s_waitcnt vmcnt(13)
    v_mfma_f32_32x32x16_bf16 v[96:111], a[96:99], v[56:59], v[96:111]
    global_load_dwordx4 v[52:55], v7, s[42:43] offset:1024 sc1
    v_mfma_f32_32x32x16_bf16 v[112:127], a[100:103], v[56:59], v[112:127]
    s_waitcnt vmcnt(12)
    v_mfma_f32_32x32x16_bf16 v[96:111], a[104:107], v[60:63], v[96:111]
    global_load_dwordx4 v[56:59], v7, s[42:43] offset:2048 sc1
    v_mfma_f32_32x32x16_bf16 v[112:127], a[108:111], v[60:63], v[112:127]
    s_waitcnt vmcnt(12)
    v_mfma_f32_32x32x16_bf16 v[96:111], a[112:115], v[128:131], v[96:111]
    global_load_dwordx4 v[60:63], v7, s[42:43] offset:3072 sc1
    v_add_u32 v7, 4096, v7
    v_mfma_f32_32x32x16_bf16 v[112:127], a[116:119], v[128:131], v[112:127]
    s_waitcnt vmcnt(12)
    v_mfma_f32_32x32x16_bf16 v[96:111], a[120:123], v[132:135], v[96:111]
    v_mfma_f32_32x32x16_bf16 v[112:127], a[124:127], v[132:135], v[112:127]
    s_waitcnt vmcnt(11)
    v_mfma_f32_32x32x16_bf16 v[96:111], a[128:131], v[136:139], v[96:111]
    v_mfma_f32_32x32x16_bf16 v[112:127], a[132:135], v[136:139], v[112:127]
    s_waitcnt vmcnt(10)
    v_mfma_f32_32x32x16_bf16 v[96:111], a[136:139], v[140:143], v[96:111]
    v_mfma_f32_32x32x16_bf16 v[112:127], a[140:143], v[140:143], v[112:127]
    s_waitcnt vmcnt(9)
    v_mfma_f32_32x32x16_bf16 v[96:111], a[144:147], v[144:147], v[96:111]
    v_mfma_f32_32x32x16_bf16 v[112:127], a[148:151], v[144:147], v[112:127]
    s_waitcnt vmcnt(8)
    v_mfma_f32_32x32x16_bf16 v[96:111], a[152:155], v[148:151], v[96:111]
    v_mfma_f32_32x32x16_bf16 v[112:127], a[156:159], v[148:151], v[112:127]
    s_waitcnt vmcnt(7)
    v_mfma_f32_32x32x16_bf16 v[96:111], a[160:163], v[32:35], v[96:111]
    v_mfma_f32_32x32x16_bf16 v[112:127], a[164:167], v[32:35], v[112:127]
    s_waitcnt vmcnt(6)
    v_mfma_f32_32x32x16_bf16 v[96:111], a[168:171], v[36:39], v[96:111]
    v_mfma_f32_32x32x16_bf16 v[112:127], a[172:175], v[36:39], v[112:127]
    s_waitcnt vmcnt(5)
    v_mfma_f32_32x32x16_bf16 v[96:111], a[176:179], v[40:43], v[96:111]
    v_mfma_f32_32x32x16_bf16 v[112:127], a[180:183], v[40:43], v[112:127]
    s_waitcnt vmcnt(4)
    v_mfma_f32_32x32x16_bf16 v[96:111], a[184:187], v[44:47], v[96:111]
    v_mfma_f32_32x32x16_bf16 v[112:127], a[188:191], v[44:47], v[112:127]
    s_waitcnt vmcnt(3)
    v_mfma_f32_32x32x16_bf16 v[96:111], a[192:195], v[48:51], v[96:111]
    v_mfma_f32_32x32x16_bf16 v[112:127], a[196:199], v[48:51], v[112:127]
    s_waitcnt vmcnt(2)
    v_mfma_f32_32x32x16_bf16 v[96:111], a[200:203], v[52:55], v[96:111]
    v_mfma_f32_32x32x16_bf16 v[112:127], a[204:207], v[52:55], v[112:127]
    s_waitcnt vmcnt(1)
    v_mfma_f32_32x32x16_bf16 v[96:111], a[208:211], v[56:59], v[96:111]
    v_mfma_f32_32x32x16_bf16 v[112:127], a[212:215], v[56:59], v[112:127]
    s_waitcnt vmcnt(0)
    v_mfma_f32_32x32x16_bf16 v[96:111], a[216:219], v[60:63], v[96:111]
    v_mfma_f32_32x32x16_bf16 v[112:127], a[220:223], v[60:63], v[112:127]
    s_nop 10
    ds_write_b128 v11, v[104:107] offset:34816
    ds_write_b128 v11, v[108:111] offset:35840
    ds_write_b128 v13, v[112:115] offset:36864
    ds_write_b128 v13, v[116:119] offset:37888
    ds_write_b128 v6, v[120:123] offset:38912
    ds_write_b128 v6, v[124:127] offset:39936
    s_waitcnt lgkmcnt(0)
    s_barrier
    ds_read_b128 v[104:107], v10 offset:34816
    ds_read_b128 v[108:111], v10 offset:35840
    ds_read_b128 v[112:115], v10 offset:36864
    ds_read_b128 v[116:119], v10 offset:37888
    ds_read_b128 v[120:123], v10 offset:38912
    ds_read_b128 v[124:127], v10 offset:39936
    s_waitcnt lgkmcnt(4)
    v_pk_add_f32 v[96:97], v[96:97], v[104:105]
    v_pk_add_f32 v[98:99], v[98:99], v[106:107]
    v_pk_add_f32 v[100:101], v[100:101], v[108:109]
    v_pk_add_f32 v[102:103], v[102:103], v[110:111]
    v_lshlrev_b32 v104, 16, v24
    v_and_b32 v105, 0xffff0000, v24
    v_lshlrev_b32 v106, 16, v25
    v_and_b32 v107, 0xffff0000, v25
    v_lshlrev_b32 v108, 16, v26
    v_and_b32 v109, 0xffff0000, v26
    v_lshlrev_b32 v110, 16, v27
    v_and_b32 v111, 0xffff0000, v27
    s_waitcnt lgkmcnt(0)
    v_pk_add_f32 v[112:113], v[112:113], v[120:121]
    v_pk_add_f32 v[114:115], v[114:115], v[122:123]
    v_pk_add_f32 v[116:117], v[116:117], v[124:125]
    v_pk_add_f32 v[118:119], v[118:119], v[126:127]
    v_pk_add_f32 v[96:97], v[96:97], v[112:113]
    v_pk_add_f32 v[98:99], v[98:99], v[114:115]
    v_pk_add_f32 v[100:101], v[100:101], v[116:117]
    v_pk_add_f32 v[102:103], v[102:103], v[118:119]
    v_cvt_pk_bf16_f32 v96, 0, v96
    v_cvt_pk_bf16_f32 v97, 0, v97
    v_cvt_pk_bf16_f32 v98, 0, v98
    v_cvt_pk_bf16_f32 v99, 0, v99
    v_cvt_pk_bf16_f32 v100, 0, v100
    v_cvt_pk_bf16_f32 v101, 0, v101
    v_cvt_pk_bf16_f32 v102, 0, v102
    v_cvt_pk_bf16_f32 v103, 0, v103
    v_pk_add_f32 v[96:97], v[96:97], v[104:105]
    v_pk_add_f32 v[98:99], v[98:99], v[106:107]
    v_pk_add_f32 v[100:101], v[100:101], v[108:109]
    v_pk_add_f32 v[102:103], v[102:103], v[110:111]
    v_cvt_pk_bf16_f32 v112, v96, v97
    v_cvt_pk_bf16_f32 v113, v98, v99
    v_cvt_pk_bf16_f32 v114, v100, v101
    v_cvt_pk_bf16_f32 v115, v102, v103
    s_nop 0
    v_permlane32_swap_b32 v112, v114
    v_permlane32_swap_b32 v113, v115
    global_store_dwordx4 v28, v[112:115], s[44:45]
    v_add_u32 v28, 0x100000, v28
main_end:
    s_endpgm
prep_retag:
    global_load_dwordx2 v[14:15], v50, s[64:65] sc1
    s_waitcnt vmcnt(0)
    s_branch prep_tag
pollA:
    s_sleep 2
    global_load_dwordx2 v[40:41], v11, s[8:9] sc1
    s_waitcnt vmcnt(0)
    v_cmp_ne_u64 vcc, s[66:67], v[40:41]
    s_nop 1
    s_and_b64 exec, exec, vcc
    s_cbranch_execnz pollA
    s_mov_b64 exec, -1
    s_branch pollA_ok
pollXE_0:
    s_sleep 2
    global_load_dword v16, v13, s[8:9] offset:0 sc1
    s_waitcnt vmcnt(0)
    v_cmp_gt_u32 vcc, 1, v16
    s_nop 1
    s_and_b64 exec, exec, vcc
    s_cbranch_execnz pollXE_0
    s_mov_b64 exec, -1
    s_branch pollXE_0_ok
ffn_retry0_0:
    global_load_dwordx4 v[56:59], v12, s[8:9] offset:0 sc1
    global_load_dwordx4 v[60:63], v12, s[8:9] offset:512 sc1
    s_waitcnt vmcnt(0)
    s_branch ffn_chk0_0
pollXL_0:
    s_sleep 2
    global_load_dword v31, v13, s[8:9] offset:0 sc1
    s_waitcnt vmcnt(0)
    v_cmp_gt_u32 vcc, 2, v31
    s_nop 1
    s_and_b64 exec, exec, vcc
    s_cbranch_execnz pollXL_0
    s_mov_b64 exec, -1
    s_branch pollXL_0_ok
pollHE_0:
    s_sleep 2
    global_load_dword v31, v15, s[8:9] offset:0 sc1
    s_waitcnt vmcnt(0)
    v_cmp_gt_u32 vcc, 1, v31
    s_nop 1
    s_and_b64 exec, exec, vcc
    s_cbranch_execnz pollHE_0
    s_mov_b64 exec, -1
    s_branch pollHE_0_ok
ffn_retry1_0:
    global_load_dwordx4 v[56:59], v12, s[8:9] offset:0 sc1
    global_load_dwordx4 v[60:63], v12, s[8:9] offset:512 sc1
    s_waitcnt vmcnt(0)
    s_branch ffn_chk1_0
pollHL_0:
    s_sleep 2
    global_load_dword v31, v15, s[8:9] offset:4 sc1
    s_waitcnt vmcnt(0)
    v_cmp_gt_u32 vcc, 1, v31
    s_nop 1
    s_and_b64 exec, exec, vcc
    s_cbranch_execnz pollHL_0
    s_mov_b64 exec, -1
    s_branch pollHL_0_ok
pollE:
    s_sleep 2
    global_load_dword v31, v30, s[8:9] offset:0 sc1
    s_waitcnt vmcnt(0)
    v_cmp_gt_u32 vcc, 3, v31
    s_nop 1
    s_and_b64 exec, exec, vcc
    s_cbranch_execnz pollE
    s_mov_b64 exec, -1
    s_branch pollE_ok
ffn_helper_0:
    v_lshrrev_b32 v2, 5, v1
    v_lshlrev_b32 v2, 9, v2
    v_sub_u32 v8, v8, v2
    v_sub_u32 v9, v9, v2
    s_xor_b32 s24, s21, 0
    v_add_u32 v8, s24, v8
    v_add_u32 v9, s24, v9
    v_lshlrev_b32 v28, 4, v0
    v_add_u32 v28, 94208, v28
    v_and_b32 v3, 31, v1
    v_lshlrev_b32 v30, 4, v3
    v_lshrrev_b32 v3, 5, v1
    v_lshl_add_u32 v30, v3, 3, v30
    v_add_u32 v30, 94208, v30
    v_add_u32 v12, v12, v2
    s_lshl_b32 s24, s35, 3
    v_add_u32 v12, s24, v12
    v_mov_b32 v16, 0
    v_mov_b32 v17, 0
    v_mov_b32 v18, 0
    v_mov_b32 v19, 0
    s_waitcnt vmcnt(14)
    ds_read_b64_tr_b16 v[32:33], v8 offset:0
    ds_read_b64_tr_b16 v[34:35], v9 offset:0
    ds_read_b64_tr_b16 v[36:37], v8 offset:4096
    ds_read_b64_tr_b16 v[38:39], v9 offset:4096
    ds_read_b64_tr_b16 v[40:41], v8 offset:8192
    ds_read_b64_tr_b16 v[42:43], v9 offset:8192
    ds_read_b64_tr_b16 v[44:45], v8 offset:12288
    ds_read_b64_tr_b16 v[46:47], v9 offset:12288
    s_waitcnt lgkmcnt(6)
    v_dot2c_f32_bf16 v16, s25, v32
    v_dot2c_f32_bf16 v17, v32, v32
    v_dot2c_f32_bf16 v18, s25, v34
    v_dot2c_f32_bf16 v19, v34, v34
    v_dot2c_f32_bf16 v16, s25, v33
    v_dot2c_f32_bf16 v17, v33, v33
    v_dot2c_f32_bf16 v18, s25, v35
    v_dot2c_f32_bf16 v19, v35, v35
    s_waitcnt lgkmcnt(4)
    v_dot2c_f32_bf16 v16, s25, v36
    v_dot2c_f32_bf16 v17, v36, v36
    v_dot2c_f32_bf16 v18, s25, v38
    v_dot2c_f32_bf16 v19, v38, v38
    v_dot2c_f32_bf16 v16, s25, v37
    v_dot2c_f32_bf16 v17, v37, v37
    v_dot2c_f32_bf16 v18, s25, v39
    v_dot2c_f32_bf16 v19, v39, v39
    s_waitcnt lgkmcnt(2)
    v_dot2c_f32_bf16 v16, s25, v40
    v_dot2c_f32_bf16 v17, v40, v40
    v_dot2c_f32_bf16 v18, s25, v42
    v_dot2c_f32_bf16 v19, v42, v42
    v_dot2c_f32_bf16 v16, s25, v41
    v_dot2c_f32_bf16 v17, v41, v41
    v_dot2c_f32_bf16 v18, s25, v43
    v_dot2c_f32_bf16 v19, v43, v43
    s_waitcnt lgkmcnt(0)
    v_dot2c_f32_bf16 v16, s25, v44
    v_dot2c_f32_bf16 v17, v44, v44
    v_dot2c_f32_bf16 v18, s25, v46
    v_dot2c_f32_bf16 v19, v46, v46
    v_dot2c_f32_bf16 v16, s25, v45
    v_dot2c_f32_bf16 v17, v45, v45
    v_dot2c_f32_bf16 v18, s25, v47
    v_dot2c_f32_bf16 v19, v47, v47
    s_waitcnt vmcnt(8)
    ds_read_b64_tr_b16 v[32:33], v8 offset:16384
    ds_read_b64_tr_b16 v[34:35], v9 offset:16384
    ds_read_b64_tr_b16 v[36:37], v8 offset:20480
    ds_read_b64_tr_b16 v[38:39], v9 offset:20480
    ds_read_b64_tr_b16 v[40:41], v8 offset:24576
    ds_read_b64_tr_b16 v[42:43], v9 offset:24576
    ds_read_b64_tr_b16 v[44:45], v8 offset:28672
    ds_read_b64_tr_b16 v[46:47], v9 offset:28672
    s_waitcnt lgkmcnt(6)
    v_dot2c_f32_bf16 v16, s25, v32
    v_dot2c_f32_bf16 v17, v32, v32
    v_dot2c_f32_bf16 v18, s25, v34
    v_dot2c_f32_bf16 v19, v34, v34
    v_dot2c_f32_bf16 v16, s25, v33
    v_dot2c_f32_bf16 v17, v33, v33
    v_dot2c_f32_bf16 v18, s25, v35
    v_dot2c_f32_bf16 v19, v35, v35
    s_waitcnt lgkmcnt(4)
    v_dot2c_f32_bf16 v16, s25, v36
    v_dot2c_f32_bf16 v17, v36, v36
    v_dot2c_f32_bf16 v18, s25, v38
    v_dot2c_f32_bf16 v19, v38, v38
    v_dot2c_f32_bf16 v16, s25, v37
    v_dot2c_f32_bf16 v17, v37, v37
    v_dot2c_f32_bf16 v18, s25, v39
    v_dot2c_f32_bf16 v19, v39, v39
    s_waitcnt lgkmcnt(2)
    v_dot2c_f32_bf16 v16, s25, v40
    v_dot2c_f32_bf16 v17, v40, v40
    v_dot2c_f32_bf16 v18, s25, v42
    v_dot2c_f32_bf16 v19, v42, v42
    v_dot2c_f32_bf16 v16, s25, v41
    v_dot2c_f32_bf16 v17, v41, v41
    v_dot2c_f32_bf16 v18, s25, v43
    v_dot2c_f32_bf16 v19, v43, v43
    s_waitcnt lgkmcnt(0)
    v_dot2c_f32_bf16 v16, s25, v44
    v_dot2c_f32_bf16 v17, v44, v44
    v_dot2c_f32_bf16 v18, s25, v46
    v_dot2c_f32_bf16 v19, v46, v46
    v_dot2c_f32_bf16 v16, s25, v45
    v_dot2c_f32_bf16 v17, v45, v45
    v_dot2c_f32_bf16 v18, s25, v47
    v_dot2c_f32_bf16 v19, v47, v47
    s_nop 2
    ds_write_b128 v28, v[16:19]
    s_waitcnt lgkmcnt(0)
    s_barrier
    s_cmp_lg_u32 s10, 1
    s_cbranch_scc1 ffn_help0_0
    ds_read_b64 v[32:33], v30 offset:0
    ds_read_b64 v[34:35], v30 offset:512
    ds_read_b64 v[36:37], v30 offset:1024
    ds_read_b64 v[38:39], v30 offset:1536
    ds_read_b64 v[40:41], v30 offset:2048
    ds_read_b64 v[42:43], v30 offset:2560
    ds_read_b64 v[44:45], v30 offset:3072
    ds_read_b64 v[46:47], v30 offset:3584
    s_waitcnt lgkmcnt(0)
    v_pk_add_f32 v[32:33], v[32:33], v[40:41]
    v_pk_add_f32 v[34:35], v[34:35], v[42:43]
    v_pk_add_f32 v[36:37], v[36:37], v[44:45]
    v_pk_add_f32 v[38:39], v[38:39], v[46:47]
    v_pk_add_f32 v[32:33], v[32:33], v[36:37]
    v_pk_add_f32 v[34:35], v[34:35], v[38:39]
    v_pk_add_f32 v[32:33], v[32:33], v[34:35]
    v_or_b32 v33, 1, v33
    global_store_dwordx2 v12, v[32:33], s[8:9] sc1
ffn_help0_0:
    v_add_u32 v12, 0x4000, v12
    v_subrev_u32 v8, 98304, v8
    v_subrev_u32 v9, 98304, v9
    s_waitcnt vmcnt(9)
    s_barrier
    s_mov_b64 exec, 1
    v_mov_b32 v153, 2
    global_store_dword v152, v153, s[8:9] offset:0 sc1
    s_mov_b64 exec, -1
ffn_hpXL_0:
    s_sleep 13
    global_load_dword v31, v13, s[8:9] offset:0 sc1
    s_waitcnt vmcnt(0)
    v_cmp_gt_u32 vcc, 2, v31
    s_nop 1
    s_and_b64 exec, exec, vcc
    s_cbranch_execnz ffn_hpXL_0
    s_mov_b64 exec, -1
    s_add_u32 m0, s21, 0
    s_add_u32 s24, s21, 1048576
    buffer_load_dwordx4 v4, s[16:19], s24 offen sc1 lds
    s_add_u32 m0, s21, 4096
    s_add_u32 s24, s21, 1052672
    buffer_load_dwordx4 v4, s[16:19], s24 offen sc1 lds
    s_add_u32 m0, s21, 8192
    s_add_u32 s24, s21, 1056768
    buffer_load_dwordx4 v4, s[16:19], s24 offen sc1 lds
    s_add_u32 m0, s21, 12288
    s_add_u32 s24, s21, 1060864
    buffer_load_dwordx4 v4, s[16:19], s24 offen sc1 lds
    s_add_u32 m0, s21, 16384
    s_add_u32 s24, s21, 1064960
    buffer_load_dwordx4 v4, s[16:19], s24 offen sc1 lds
    s_add_u32 m0, s21, 20480
    s_add_u32 s24, s21, 1069056
    buffer_load_dwordx4 v4, s[16:19], s24 offen sc1 lds
    s_add_u32 m0, s21, 24576
    s_add_u32 s24, s21, 1073152
    buffer_load_dwordx4 v4, s[16:19], s24 offen sc1 lds
    s_add_u32 m0, s21, 28672
    s_add_u32 s24, s21, 1077248
    buffer_load_dwordx4 v4, s[16:19], s24 offen sc1 lds
    s_xor_b32 s21, s21, 0x8000
    s_add_u32 m0, s21, 0
    s_add_u32 s24, s21, 1048576
    buffer_load_dwordx4 v4, s[16:19], s24 offen sc1 lds
    s_add_u32 m0, s21, 4096
    s_add_u32 s24, s21, 1052672
    buffer_load_dwordx4 v4, s[16:19], s24 offen sc1 lds
    s_add_u32 m0, s21, 8192
    s_add_u32 s24, s21, 1056768
    buffer_load_dwordx4 v4, s[16:19], s24 offen sc1 lds
    s_add_u32 m0, s21, 12288
    s_add_u32 s24, s21, 1060864
    buffer_load_dwordx4 v4, s[16:19], s24 offen sc1 lds
    s_add_u32 m0, s21, 16384
    s_add_u32 s24, s21, 1064960
    buffer_load_dwordx4 v4, s[16:19], s24 offen sc1 lds
    s_add_u32 m0, s21, 20480
    s_add_u32 s24, s21, 1069056
    buffer_load_dwordx4 v4, s[16:19], s24 offen sc1 lds
    s_add_u32 m0, s21, 24576
    s_add_u32 s24, s21, 1073152
    buffer_load_dwordx4 v4, s[16:19], s24 offen sc1 lds
    s_add_u32 m0, s21, 28672
    s_add_u32 s24, s21, 1077248
    s_xor_b32 s21, s21, 0x8000
    buffer_load_dwordx4 v4, s[16:19], s24 offen sc1 lds
    v_mov_b32 v16, 0
    v_mov_b32 v17, 0
    v_mov_b32 v18, 0
    v_mov_b32 v19, 0
    s_waitcnt vmcnt(12)
    ds_read_b64_tr_b16 v[32:33], v8 offset:0
    ds_read_b64_tr_b16 v[34:35], v9 offset:0
    ds_read_b64_tr_b16 v[36:37], v8 offset:4096
    ds_read_b64_tr_b16 v[38:39], v9 offset:4096
    ds_read_b64_tr_b16 v[40:41], v8 offset:8192
    ds_read_b64_tr_b16 v[42:43], v9 offset:8192
    ds_read_b64_tr_b16 v[44:45], v8 offset:12288
    ds_read_b64_tr_b16 v[46:47], v9 offset:12288
    s_waitcnt lgkmcnt(6)
    v_dot2c_f32_bf16 v16, s25, v32
    v_dot2c_f32_bf16 v17, v32, v32
    v_dot2c_f32_bf16 v18, s25, v34
    v_dot2c_f32_bf16 v19, v34, v34
    v_dot2c_f32_bf16 v16, s25, v33
    v_dot2c_f32_bf16 v17, v33, v33
    v_dot2c_f32_bf16 v18, s25, v35
    v_dot2c_f32_bf16 v19, v35, v35
    s_waitcnt lgkmcnt(4)
    v_dot2c_f32_bf16 v16, s25, v36
    v_dot2c_f32_bf16 v17, v36, v36
    v_dot2c_f32_bf16 v18, s25, v38
    v_dot2c_f32_bf16 v19, v38, v38
    v_dot2c_f32_bf16 v16, s25, v37
    v_dot2c_f32_bf16 v17, v37, v37
    v_dot2c_f32_bf16 v18, s25, v39
    v_dot2c_f32_bf16 v19, v39, v39
    s_waitcnt lgkmcnt(2)
    v_dot2c_f32_bf16 v16, s25, v40
    v_dot2c_f32_bf16 v17, v40, v40
    v_dot2c_f32_bf16 v18, s25, v42
    v_dot2c_f32_bf16 v19, v42, v42
    v_dot2c_f32_bf16 v16, s25, v41
    v_dot2c_f32_bf16 v17, v41, v41
    v_dot2c_f32_bf16 v18, s25, v43
    v_dot2c_f32_bf16 v19, v43, v43
    s_waitcnt lgkmcnt(0)
    v_dot2c_f32_bf16 v16, s25, v44
    v_dot2c_f32_bf16 v17, v44, v44
    v_dot2c_f32_bf16 v18, s25, v46
    v_dot2c_f32_bf16 v19, v46, v46
    v_dot2c_f32_bf16 v16, s25, v45
    v_dot2c_f32_bf16 v17, v45, v45
    v_dot2c_f32_bf16 v18, s25, v47
    v_dot2c_f32_bf16 v19, v47, v47
    s_waitcnt vmcnt(8)
    ds_read_b64_tr_b16 v[32:33], v8 offset:16384
    ds_read_b64_tr_b16 v[34:35], v9 offset:16384
    ds_read_b64_tr_b16 v[36:37], v8 offset:20480
    ds_read_b64_tr_b16 v[38:39], v9 offset:20480
    ds_read_b64_tr_b16 v[40:41], v8 offset:24576
    ds_read_b64_tr_b16 v[42:43], v9 offset:24576
    ds_read_b64_tr_b16 v[44:45], v8 offset:28672
    ds_read_b64_tr_b16 v[46:47], v9 offset:28672
    s_waitcnt lgkmcnt(6)
    v_dot2c_f32_bf16 v16, s25, v32
    v_dot2c_f32_bf16 v17, v32, v32
    v_dot2c_f32_bf16 v18, s25, v34
    v_dot2c_f32_bf16 v19, v34, v34
    v_dot2c_f32_bf16 v16, s25, v33
    v_dot2c_f32_bf16 v17, v33, v33
    v_dot2c_f32_bf16 v18, s25, v35
    v_dot2c_f32_bf16 v19, v35, v35
    s_waitcnt lgkmcnt(4)
    v_dot2c_f32_bf16 v16, s25, v36
    v_dot2c_f32_bf16 v17, v36, v36
    v_dot2c_f32_bf16 v18, s25, v38
    v_dot2c_f32_bf16 v19, v38, v38
    v_dot2c_f32_bf16 v16, s25, v37
    v_dot2c_f32_bf16 v17, v37, v37
    v_dot2c_f32_bf16 v18, s25, v39
    v_dot2c_f32_bf16 v19, v39, v39
    s_waitcnt lgkmcnt(2)
    v_dot2c_f32_bf16 v16, s25, v40
    v_dot2c_f32_bf16 v17, v40, v40
    v_dot2c_f32_bf16 v18, s25, v42
    v_dot2c_f32_bf16 v19, v42, v42
    v_dot2c_f32_bf16 v16, s25, v41
    v_dot2c_f32_bf16 v17, v41, v41
    v_dot2c_f32_bf16 v18, s25, v43
    v_dot2c_f32_bf16 v19, v43, v43
    s_waitcnt lgkmcnt(0)
    v_dot2c_f32_bf16 v16, s25, v44
    v_dot2c_f32_bf16 v17, v44, v44
    v_dot2c_f32_bf16 v18, s25, v46
    v_dot2c_f32_bf16 v19, v46, v46
    v_dot2c_f32_bf16 v16, s25, v45
    v_dot2c_f32_bf16 v17, v45, v45
    v_dot2c_f32_bf16 v18, s25, v47
    v_dot2c_f32_bf16 v19, v47, v47
    s_nop 2
    ds_write_b128 v28, v[16:19]
    s_waitcnt lgkmcnt(0)
    s_barrier
    s_cmp_lg_u32 s10, 1
    s_cbranch_scc1 ffn_help1_0
    ds_read_b64 v[32:33], v30 offset:0
    ds_read_b64 v[34:35], v30 offset:512
    ds_read_b64 v[36:37], v30 offset:1024
    ds_read_b64 v[38:39], v30 offset:1536
    ds_read_b64 v[40:41], v30 offset:2048
    ds_read_b64 v[42:43], v30 offset:2560
    ds_read_b64 v[44:45], v30 offset:3072
    ds_read_b64 v[46:47], v30 offset:3584
    s_waitcnt lgkmcnt(0)
    v_pk_add_f32 v[32:33], v[32:33], v[40:41]
    v_pk_add_f32 v[34:35], v[34:35], v[42:43]
    v_pk_add_f32 v[36:37], v[36:37], v[44:45]
    v_pk_add_f32 v[38:39], v[38:39], v[46:47]
    v_pk_add_f32 v[32:33], v[32:33], v[36:37]
    v_pk_add_f32 v[34:35], v[34:35], v[38:39]
    v_pk_add_f32 v[32:33], v[32:33], v[34:35]
    v_or_b32 v33, 1, v33
    global_store_dwordx2 v12, v[32:33], s[8:9] sc1
ffn_help1_0:
    s_waitcnt vmcnt(0)
    s_barrier
    ds_read_b64_tr_b16 v[20:21], v11 offset:0
    ds_read_b64_tr_b16 v[22:23], v11 offset:1024
    ds_read_b64_tr_b16 v[24:25], v10 offset:0
    ds_read_b64_tr_b16 v[26:27], v10 offset:1024
    s_waitcnt lgkmcnt(0)
    s_barrier
    s_add_u32 m0, s28, 4294868992
    s_add_u32 s24, s23, 196608
    buffer_load_dwordx4 v155, s[68:71], s24 offen offset:0 lds
    s_add_u32 s24, s23, 203776
    buffer_load_dwordx4 v155, s[68:71], s24 offen offset:1024 lds
    s_add_u32 s24, s23, 210944
    buffer_load_dwordx4 v155, s[68:71], s24 offen offset:2048 lds
    s_add_u32 s24, s23, 218112
    buffer_load_dwordx4 v155, s[68:71], s24 offen offset:3072 lds
    s_add_u32 m0, s28, 4294873088
    s_add_u32 s24, s23, 229376
    buffer_load_dwordx4 v155, s[68:71], s24 offen offset:0 lds
    s_add_u32 s24, s23, 236544
    buffer_load_dwordx4 v155, s[68:71], s24 offen offset:1024 lds
    s_add_u32 s24, s23, 243712
    buffer_load_dwordx4 v155, s[68:71], s24 offen offset:2048 lds
    s_add_u32 s24, s23, 250880
    buffer_load_dwordx4 v155, s[68:71], s24 offen offset:3072 lds
    s_add_u32 m0, s28, 4294877184
    s_add_u32 s24, s23, 262144
    buffer_load_dwordx4 v155, s[68:71], s24 offen offset:0 lds
    s_add_u32 s24, s23, 269312
    buffer_load_dwordx4 v155, s[68:71], s24 offen offset:1024 lds
    s_add_u32 s24, s23, 276480
    buffer_load_dwordx4 v155, s[68:71], s24 offen offset:2048 lds
    s_add_u32 s24, s23, 283648
    buffer_load_dwordx4 v155, s[68:71], s24 offen offset:3072 lds
    s_add_u32 m0, s28, 4294881280
    s_add_u32 s24, s23, 294912
    buffer_load_dwordx4 v155, s[68:71], s24 offen offset:0 lds
    s_add_u32 s24, s23, 302080
    buffer_load_dwordx4 v155, s[68:71], s24 offen offset:1024 lds
    s_add_u32 s24, s23, 309248
    buffer_load_dwordx4 v155, s[68:71], s24 offen offset:2048 lds
    s_add_u32 s24, s23, 316416
    buffer_load_dwordx4 v155, s[68:71], s24 offen offset:3072 lds
    s_add_u32 m0, s28, 0
    s_add_u32 s24, s23, 327680
    buffer_load_dwordx4 v155, s[68:71], s24 offen offset:0 lds
    s_add_u32 s24, s23, 334848
    buffer_load_dwordx4 v155, s[68:71], s24 offen offset:1024 lds
    s_add_u32 s24, s23, 342016
    buffer_load_dwordx4 v155, s[68:71], s24 offen offset:2048 lds
    s_add_u32 s24, s23, 349184
    buffer_load_dwordx4 v155, s[68:71], s24 offen offset:3072 lds
    s_add_u32 m0, s28, 4096
    s_add_u32 s24, s23, 360448
    buffer_load_dwordx4 v155, s[68:71], s24 offen offset:0 lds
    s_add_u32 s24, s23, 367616
    buffer_load_dwordx4 v155, s[68:71], s24 offen offset:1024 lds
    s_add_u32 s24, s23, 374784
    buffer_load_dwordx4 v155, s[68:71], s24 offen offset:2048 lds
    s_add_u32 s24, s23, 381952
    buffer_load_dwordx4 v155, s[68:71], s24 offen offset:3072 lds
    s_add_u32 m0, s28, 8192
    s_add_u32 s24, s23, 393216
    buffer_load_dwordx4 v155, s[68:71], s24 offen offset:0 lds
    s_add_u32 s24, s23, 400384
    buffer_load_dwordx4 v155, s[68:71], s24 offen offset:1024 lds
    s_add_u32 s24, s23, 407552
    buffer_load_dwordx4 v155, s[68:71], s24 offen offset:2048 lds
    s_add_u32 s24, s23, 414720
    buffer_load_dwordx4 v155, s[68:71], s24 offen offset:3072 lds
    s_add_u32 m0, s28, 12288
    s_add_u32 s24, s23, 425984
    buffer_load_dwordx4 v155, s[68:71], s24 offen offset:0 lds
    s_add_u32 s24, s23, 433152
    buffer_load_dwordx4 v155, s[68:71], s24 offen offset:1024 lds
    s_add_u32 s24, s23, 440320
    buffer_load_dwordx4 v155, s[68:71], s24 offen offset:2048 lds
    s_add_u32 s24, s23, 447488
    buffer_load_dwordx4 v155, s[68:71], s24 offen offset:3072 lds
    s_waitcnt vmcnt(30)
    ds_read_b64_tr_b16 a[96:97], v29 offset:0
    ds_read_b64_tr_b16 a[100:101], v154 offset:0
    ds_read_b64_tr_b16 a[98:99], v29 offset:1024
    ds_read_b64_tr_b16 a[102:103], v154 offset:1024
    s_waitcnt vmcnt(28)
    ds_read_b64_tr_b16 a[104:105], v29 offset:2048
    ds_read_b64_tr_b16 a[108:109], v154 offset:2048
    ds_read_b64_tr_b16 a[106:107], v29 offset:3072
    ds_read_b64_tr_b16 a[110:111], v154 offset:3072
    s_waitcnt vmcnt(26)
    ds_read_b64_tr_b16 a[112:113], v29 offset:4096
    ds_read_b64_tr_b16 a[116:117], v154 offset:4096
    ds_read_b64_tr_b16 a[114:115], v29 offset:5120
    ds_read_b64_tr_b16 a[118:119], v154 offset:5120
    s_waitcnt vmcnt(24)
    ds_read_b64_tr_b16 a[120:121], v29 offset:6144
    ds_read_b64_tr_b16 a[124:125], v154 offset:6144
    ds_read_b64_tr_b16 a[122:123], v29 offset:7168
    ds_read_b64_tr_b16 a[126:127], v154 offset:7168
    s_waitcnt vmcnt(22)
    ds_read_b64_tr_b16 a[128:129], v29 offset:8192
    ds_read_b64_tr_b16 a[132:133], v154 offset:8192
    ds_read_b64_tr_b16 a[130:131], v29 offset:9216
    ds_read_b64_tr_b16 a[134:135], v154 offset:9216
    s_waitcnt vmcnt(20)
    ds_read_b64_tr_b16 a[136:137], v29 offset:10240
    ds_read_b64_tr_b16 a[140:141], v154 offset:10240
    ds_read_b64_tr_b16 a[138:139], v29 offset:11264
    ds_read_b64_tr_b16 a[142:143], v154 offset:11264
    s_waitcnt vmcnt(18)
    ds_read_b64_tr_b16 a[144:145], v29 offset:12288
    ds_read_b64_tr_b16 a[148:149], v154 offset:12288
    ds_read_b64_tr_b16 a[146:147], v29 offset:13312
    ds_read_b64_tr_b16 a[150:151], v154 offset:13312
    s_waitcnt vmcnt(16)
    ds_read_b64_tr_b16 a[152:153], v29 offset:14336
    ds_read_b64_tr_b16 a[156:157], v154 offset:14336
    ds_read_b64_tr_b16 a[154:155], v29 offset:15360
    ds_read_b64_tr_b16 a[158:159], v154 offset:15360
    v_add_u32 v29, 98304, v29
    v_add_u32 v154, 98304, v154
    s_waitcnt vmcnt(14)
    ds_read_b64_tr_b16 a[160:161], v29 offset:0
    ds_read_b64_tr_b16 a[164:165], v154 offset:0
    ds_read_b64_tr_b16 a[162:163], v29 offset:1024
    ds_read_b64_tr_b16 a[166:167], v154 offset:1024
    s_waitcnt vmcnt(12)
    ds_read_b64_tr_b16 a[168:169], v29 offset:2048
    ds_read_b64_tr_b16 a[172:173], v154 offset:2048
    ds_read_b64_tr_b16 a[170:171], v29 offset:3072
    ds_read_b64_tr_b16 a[174:175], v154 offset:3072
    s_waitcnt vmcnt(10)
    ds_read_b64_tr_b16 a[176:177], v29 offset:4096
    ds_read_b64_tr_b16 a[180:181], v154 offset:4096
    ds_read_b64_tr_b16 a[178:179], v29 offset:5120
    ds_read_b64_tr_b16 a[182:183], v154 offset:5120
    s_waitcnt vmcnt(8)
    ds_read_b64_tr_b16 a[184:185], v29 offset:6144
    ds_read_b64_tr_b16 a[188:189], v154 offset:6144
    ds_read_b64_tr_b16 a[186:187], v29 offset:7168
    ds_read_b64_tr_b16 a[190:191], v154 offset:7168
    s_waitcnt vmcnt(7)
    ds_read_b64_tr_b16 a[192:193], v29 offset:8192
    ds_read_b64_tr_b16 a[196:197], v154 offset:8192
    s_waitcnt vmcnt(6)
    ds_read_b64_tr_b16 a[194:195], v29 offset:9216
    ds_read_b64_tr_b16 a[198:199], v154 offset:9216
    s_waitcnt vmcnt(5)
    ds_read_b64_tr_b16 a[200:201], v29 offset:10240
    ds_read_b64_tr_b16 a[204:205], v154 offset:10240
    s_waitcnt vmcnt(4)
    ds_read_b64_tr_b16 a[202:203], v29 offset:11264
    ds_read_b64_tr_b16 a[206:207], v154 offset:11264
    s_waitcnt vmcnt(3)
    ds_read_b64_tr_b16 a[208:209], v29 offset:12288
    ds_read_b64_tr_b16 a[212:213], v154 offset:12288
    s_waitcnt vmcnt(2)
    ds_read_b64_tr_b16 a[210:211], v29 offset:13312
    ds_read_b64_tr_b16 a[214:215], v154 offset:13312
    s_waitcnt vmcnt(1)
    ds_read_b64_tr_b16 a[216:217], v29 offset:14336
    ds_read_b64_tr_b16 a[220:221], v154 offset:14336
    s_waitcnt vmcnt(0)
    ds_read_b64_tr_b16 a[218:219], v29 offset:15360
    ds_read_b64_tr_b16 a[222:223], v154 offset:15360
    s_getpc_b64 s[4:5]
htc_0:
    s_sub_u32 s4, s4, htc_0-ffn_g2_0
    s_subb_u32 s5, s5, 0
    v_lshlrev_b32 v2, 7, v0
    v_min_u32 v2, code_end-ffn_g2_0-4, v2
    global_load_dword v31, v2, s[4:5]
    v_and_b32 v3, 31, v1
    v_lshrrev_b32 v4, 5, v1
    s_lshl_b32 s24, s32, 5
    v_add_u32 v3, s24, v3
    s_lshl_b32 s24, s46, 12
    s_add_u32 s24, s24, 0
    s_add_u32 s44, s8, s24
    s_addc_u32 s45, s9, 0
    v_lshlrev_b32 v28, 14, v4
    v_lshl_add_u32 v28, v3, 3, v28
    v_lshlrev_b32 v29, 2, v4
    v_lshl_add_u32 v29, v3, 3, v29
    v_add_u32 v29, 17039360, v29
    v_lshlrev_b32 v8, 2, v0
    v_add_u32 v8, 131072, v8
    v_lshlrev_b32 v30, 5, v0
    v_add_u32 v30, 17137664, v30
    s_lshl_b32 s24, s10, 13
    s_add_u32 s24, s24, 65536
    v_add_u32 v10, s24, v5
    v_xor_b32 v11, 0x2000, v10
    v_xor_b32 v13, 0x4000, v10
    v_xor_b32 v6, 0x6000, v10
    s_waitcnt lgkmcnt(0)
ffn_hpHE_0:
    s_sleep 2
    global_load_dword v31, v15, s[8:9] offset:0 sc1
    s_waitcnt vmcnt(0)
    v_cmp_gt_u32 vcc, 1, v31
    s_nop 1
    s_and_b64 exec, exec, vcc
    s_cbranch_execnz ffn_hpHE_0
    s_mov_b64 exec, -1
    global_load_dwordx4 v[128:131], v7, s[42:43] offset:0 sc1
    global_load_dwordx4 v[132:135], v7, s[42:43] offset:1024 sc1
    global_load_dwordx4 v[136:139], v7, s[42:43] offset:2048 sc1
    global_load_dwordx4 v[140:143], v7, s[42:43] offset:3072 sc1
    v_add_u32 v7, 4096, v7
    global_load_dwordx4 v[144:147], v7, s[42:43] offset:0 sc1
    global_load_dwordx4 v[148:151], v7, s[42:43] offset:1024 sc1
    global_load_dwordx4 v[32:35], v7, s[42:43] offset:2048 sc1
    global_load_dwordx4 v[36:39], v7, s[42:43] offset:3072 sc1
    v_add_u32 v7, 4096, v7
    global_load_dwordx4 v[40:43], v7, s[42:43] offset:0 sc1
    global_load_dwordx4 v[44:47], v7, s[42:43] offset:1024 sc1
    s_waitcnt vmcnt(0)
    s_branch ffn_g2_0
pollL:
    s_sleep 2
    global_load_dword v3, v11, s[8:9] offset:0 sc1
    s_waitcnt vmcnt(0)
    v_cmp_gt_u32 vcc, 4, v3
    s_nop 1
    s_and_b64 exec, exec, vcc
    s_cbranch_execnz pollL
    s_mov_b64 exec, -1
    s_branch pollL_ok
pollXE_1:
    s_sleep 2
    global_load_dword v16, v13, s[8:9] offset:0 sc1
    s_waitcnt vmcnt(0)
    v_cmp_gt_u32 vcc, 5, v16
    s_nop 1
    s_and_b64 exec, exec, vcc
    s_cbranch_execnz pollXE_1
    s_mov_b64 exec, -1
    s_branch pollXE_1_ok
ffn_retry0_1:
    global_load_dwordx4 v[56:59], v12, s[8:9] offset:0 sc1
    global_load_dwordx4 v[60:63], v12, s[8:9] offset:512 sc1
    s_waitcnt vmcnt(0)
    s_branch ffn_chk0_1
pollXL_1:
    s_sleep 2
    global_load_dword v31, v13, s[8:9] offset:0 sc1
    s_waitcnt vmcnt(0)
    v_cmp_gt_u32 vcc, 6, v31
    s_nop 1
    s_and_b64 exec, exec, vcc
    s_cbranch_execnz pollXL_1
    s_mov_b64 exec, -1
    s_branch pollXL_1_ok
pollHE_1:
    s_sleep 2
    global_load_dword v31, v15, s[8:9] offset:8 sc1
    s_waitcnt vmcnt(0)
    v_cmp_gt_u32 vcc, 1, v31
    s_nop 1
    s_and_b64 exec, exec, vcc
    s_cbranch_execnz pollHE_1
    s_mov_b64 exec, -1
    s_branch pollHE_1_ok
ffn_retry1_1:
    global_load_dwordx4 v[56:59], v12, s[8:9] offset:0 sc1
    global_load_dwordx4 v[60:63], v12, s[8:9] offset:512 sc1
    s_waitcnt vmcnt(0)
    s_branch ffn_chk1_1
pollHL_1:
    s_sleep 2
    global_load_dword v31, v15, s[8:9] offset:12 sc1
    s_waitcnt vmcnt(0)
    v_cmp_gt_u32 vcc, 1, v31
    s_nop 1
    s_and_b64 exec, exec, vcc
    s_cbranch_execnz pollHL_1
    s_mov_b64 exec, -1
    s_branch pollHL_1_ok
ffn_helper_1:
    v_lshrrev_b32 v2, 5, v1
    v_lshlrev_b32 v2, 9, v2
    v_sub_u32 v8, v8, v2
    v_sub_u32 v9, v9, v2
    s_xor_b32 s24, s21, 32768
    v_add_u32 v8, s24, v8
    v_add_u32 v9, s24, v9
    v_lshlrev_b32 v28, 4, v0
    v_add_u32 v28, 94208, v28
    v_and_b32 v3, 31, v1
    v_lshlrev_b32 v30, 4, v3
    v_lshrrev_b32 v3, 5, v1
    v_lshl_add_u32 v30, v3, 3, v30
    v_add_u32 v30, 94208, v30
    v_add_u32 v12, v12, v2
    s_lshl_b32 s24, s35, 3
    v_add_u32 v12, s24, v12
    v_mov_b32 v16, 0
    v_mov_b32 v17, 0
    v_mov_b32 v18, 0
    v_mov_b32 v19, 0
    s_waitcnt vmcnt(12)
    ds_read_b64_tr_b16 v[32:33], v8 offset:0
    ds_read_b64_tr_b16 v[34:35], v9 offset:0
    ds_read_b64_tr_b16 v[36:37], v8 offset:4096
    ds_read_b64_tr_b16 v[38:39], v9 offset:4096
    ds_read_b64_tr_b16 v[40:41], v8 offset:8192
    ds_read_b64_tr_b16 v[42:43], v9 offset:8192
    ds_read_b64_tr_b16 v[44:45], v8 offset:12288
    ds_read_b64_tr_b16 v[46:47], v9 offset:12288
    s_waitcnt lgkmcnt(6)
    v_dot2c_f32_bf16 v16, s25, v32
    v_dot2c_f32_bf16 v17, v32, v32
    v_dot2c_f32_bf16 v18, s25, v34
    v_dot2c_f32_bf16 v19, v34, v34
    v_dot2c_f32_bf16 v16, s25, v33
    v_dot2c_f32_bf16 v17, v33, v33
    v_dot2c_f32_bf16 v18, s25, v35
    v_dot2c_f32_bf16 v19, v35, v35
    s_waitcnt lgkmcnt(4)
    v_dot2c_f32_bf16 v16, s25, v36
    v_dot2c_f32_bf16 v17, v36, v36
    v_dot2c_f32_bf16 v18, s25, v38
    v_dot2c_f32_bf16 v19, v38, v38
    v_dot2c_f32_bf16 v16, s25, v37
    v_dot2c_f32_bf16 v17, v37, v37
    v_dot2c_f32_bf16 v18, s25, v39
    v_dot2c_f32_bf16 v19, v39, v39
    s_waitcnt lgkmcnt(2)
    v_dot2c_f32_bf16 v16, s25, v40
    v_dot2c_f32_bf16 v17, v40, v40
    v_dot2c_f32_bf16 v18, s25, v42
    v_dot2c_f32_bf16 v19, v42, v42
    v_dot2c_f32_bf16 v16, s25, v41
    v_dot2c_f32_bf16 v17, v41, v41
    v_dot2c_f32_bf16 v18, s25, v43
    v_dot2c_f32_bf16 v19, v43, v43
    s_waitcnt lgkmcnt(0)
    v_dot2c_f32_bf16 v16, s25, v44
    v_dot2c_f32_bf16 v17, v44, v44
    v_dot2c_f32_bf16 v18, s25, v46
    v_dot2c_f32_bf16 v19, v46, v46
    v_dot2c_f32_bf16 v16, s25, v45
    v_dot2c_f32_bf16 v17, v45, v45
    v_dot2c_f32_bf16 v18, s25, v47
    v_dot2c_f32_bf16 v19, v47, v47
    s_waitcnt vmcnt(8)
    ds_read_b64_tr_b16 v[32:33], v8 offset:16384
    ds_read_b64_tr_b16 v[34:35], v9 offset:16384
    ds_read_b64_tr_b16 v[36:37], v8 offset:20480
    ds_read_b64_tr_b16 v[38:39], v9 offset:20480
    ds_read_b64_tr_b16 v[40:41], v8 offset:24576
    ds_read_b64_tr_b16 v[42:43], v9 offset:24576
    ds_read_b64_tr_b16 v[44:45], v8 offset:28672
    ds_read_b64_tr_b16 v[46:47], v9 offset:28672
    s_waitcnt lgkmcnt(6)
    v_dot2c_f32_bf16 v16, s25, v32
    v_dot2c_f32_bf16 v17, v32, v32
    v_dot2c_f32_bf16 v18, s25, v34
    v_dot2c_f32_bf16 v19, v34, v34
    v_dot2c_f32_bf16 v16, s25, v33
    v_dot2c_f32_bf16 v17, v33, v33
    v_dot2c_f32_bf16 v18, s25, v35
    v_dot2c_f32_bf16 v19, v35, v35
    s_waitcnt lgkmcnt(4)
    v_dot2c_f32_bf16 v16, s25, v36
    v_dot2c_f32_bf16 v17, v36, v36
    v_dot2c_f32_bf16 v18, s25, v38
    v_dot2c_f32_bf16 v19, v38, v38
    v_dot2c_f32_bf16 v16, s25, v37
    v_dot2c_f32_bf16 v17, v37, v37
    v_dot2c_f32_bf16 v18, s25, v39
    v_dot2c_f32_bf16 v19, v39, v39
    s_waitcnt lgkmcnt(2)
    v_dot2c_f32_bf16 v16, s25, v40
    v_dot2c_f32_bf16 v17, v40, v40
    v_dot2c_f32_bf16 v18, s25, v42
    v_dot2c_f32_bf16 v19, v42, v42
    v_dot2c_f32_bf16 v16, s25, v41
    v_dot2c_f32_bf16 v17, v41, v41
    v_dot2c_f32_bf16 v18, s25, v43
    v_dot2c_f32_bf16 v19, v43, v43
    s_waitcnt lgkmcnt(0)
    v_dot2c_f32_bf16 v16, s25, v44
    v_dot2c_f32_bf16 v17, v44, v44
    v_dot2c_f32_bf16 v18, s25, v46
    v_dot2c_f32_bf16 v19, v46, v46
    v_dot2c_f32_bf16 v16, s25, v45
    v_dot2c_f32_bf16 v17, v45, v45
    v_dot2c_f32_bf16 v18, s25, v47
    v_dot2c_f32_bf16 v19, v47, v47
    s_nop 2
    ds_write_b128 v28, v[16:19]
    s_waitcnt lgkmcnt(0)
    s_barrier
    s_cmp_lg_u32 s10, 1
    s_cbranch_scc1 ffn_help0_1
    ds_read_b64 v[32:33], v30 offset:0
    ds_read_b64 v[34:35], v30 offset:512
    ds_read_b64 v[36:37], v30 offset:1024
    ds_read_b64 v[38:39], v30 offset:1536
    ds_read_b64 v[40:41], v30 offset:2048
    ds_read_b64 v[42:43], v30 offset:2560
    ds_read_b64 v[44:45], v30 offset:3072
    ds_read_b64 v[46:47], v30 offset:3584
    s_waitcnt lgkmcnt(0)
    v_pk_add_f32 v[32:33], v[32:33], v[40:41]
    v_pk_add_f32 v[34:35], v[34:35], v[42:43]
    v_pk_add_f32 v[36:37], v[36:37], v[44:45]
    v_pk_add_f32 v[38:39], v[38:39], v[46:47]
    v_pk_add_f32 v[32:33], v[32:33], v[36:37]
    v_pk_add_f32 v[34:35], v[34:35], v[38:39]
    v_pk_add_f32 v[32:33], v[32:33], v[34:35]
    v_or_b32 v33, 1, v33
    global_store_dwordx2 v12, v[32:33], s[8:9] sc1
ffn_help0_1:
    v_add_u32 v12, 0x4000, v12
    v_subrev_u32 v8, 98304, v8
    v_subrev_u32 v9, 98304, v9
    s_waitcnt vmcnt(4)
    s_barrier
    s_mov_b64 exec, 1
    v_mov_b32 v153, 6
    global_store_dword v152, v153, s[8:9] offset:0 sc1
    s_mov_b64 exec, -1
    s_add_u32 m0, s21, 122880
    s_add_u32 s24, s21, 24576
    buffer_load_dwordx4 v4, s[16:19], s24 offen sc1 lds
    s_add_u32 m0, s21, 126976
    s_add_u32 s24, s21, 28672
    s_xor_b32 s21, s21, 0x8000
    buffer_load_dwordx4 v4, s[16:19], s24 offen sc1 lds
ffn_hpXL_1:
    s_sleep 13
    global_load_dword v31, v13, s[8:9] offset:0 sc1
    s_waitcnt vmcnt(0)
    v_cmp_gt_u32 vcc, 6, v31
    s_nop 1
    s_and_b64 exec, exec, vcc
    s_cbranch_execnz ffn_hpXL_1
    s_mov_b64 exec, -1
    s_add_u32 m0, s21, 0
    s_add_u32 s24, s21, 1048576
    buffer_load_dwordx4 v4, s[16:19], s24 offen sc1 lds
    s_add_u32 m0, s21, 4096
    s_add_u32 s24, s21, 1052672
    buffer_load_dwordx4 v4, s[16:19], s24 offen sc1 lds
    s_add_u32 m0, s21, 8192
    s_add_u32 s24, s21, 1056768
    buffer_load_dwordx4 v4, s[16:19], s24 offen sc1 lds
    s_add_u32 m0, s21, 12288
    s_add_u32 s24, s21, 1060864
    buffer_load_dwordx4 v4, s[16:19], s24 offen sc1 lds
    s_add_u32 m0, s21, 16384
    s_add_u32 s24, s21, 1064960
    buffer_load_dwordx4 v4, s[16:19], s24 offen sc1 lds
    s_add_u32 m0, s21, 20480
    s_add_u32 s24, s21, 1069056
    buffer_load_dwordx4 v4, s[16:19], s24 offen sc1 lds
    s_add_u32 m0, s21, 24576
    s_add_u32 s24, s21, 1073152
    buffer_load_dwordx4 v4, s[16:19], s24 offen sc1 lds
    s_add_u32 m0, s21, 28672
    s_add_u32 s24, s21, 1077248
    buffer_load_dwordx4 v4, s[16:19], s24 offen sc1 lds
    s_xor_b32 s21, s21, 0x8000
    s_add_u32 m0, s21, 0
    s_add_u32 s24, s21, 1048576
    buffer_load_dwordx4 v4, s[16:19], s24 offen sc1 lds
    s_add_u32 m0, s21, 4096
    s_add_u32 s24, s21, 1052672
    buffer_load_dwordx4 v4, s[16:19], s24 offen sc1 lds
    s_add_u32 m0, s21, 8192
    s_add_u32 s24, s21, 1056768
    buffer_load_dwordx4 v4, s[16:19], s24 offen sc1 lds
    s_add_u32 m0, s21, 12288
    s_add_u32 s24, s21, 1060864
    buffer_load_dwordx4 v4, s[16:19], s24 offen sc1 lds
    s_add_u32 m0, s21, 16384
    s_add_u32 s24, s21, 1064960
    buffer_load_dwordx4 v4, s[16:19], s24 offen sc1 lds
    s_add_u32 m0, s21, 20480
    s_add_u32 s24, s21, 1069056
    buffer_load_dwordx4 v4, s[16:19], s24 offen sc1 lds
    s_add_u32 m0, s21, 24576
    s_add_u32 s24, s21, 1073152
    buffer_load_dwordx4 v4, s[16:19], s24 offen sc1 lds
    s_add_u32 m0, s21, 28672
    s_add_u32 s24, s21, 1077248
    s_xor_b32 s21, s21, 0x8000
    buffer_load_dwordx4 v4, s[16:19], s24 offen sc1 lds
    v_mov_b32 v16, 0
    v_mov_b32 v17, 0
    v_mov_b32 v18, 0
    v_mov_b32 v19, 0
    s_waitcnt vmcnt(12)
    ds_read_b64_tr_b16 v[32:33], v8 offset:0
    ds_read_b64_tr_b16 v[34:35], v9 offset:0
    ds_read_b64_tr_b16 v[36:37], v8 offset:4096
    ds_read_b64_tr_b16 v[38:39], v9 offset:4096
    ds_read_b64_tr_b16 v[40:41], v8 offset:8192
    ds_read_b64_tr_b16 v[42:43], v9 offset:8192
    ds_read_b64_tr_b16 v[44:45], v8 offset:12288
    ds_read_b64_tr_b16 v[46:47], v9 offset:12288
    s_waitcnt lgkmcnt(6)
    v_dot2c_f32_bf16 v16, s25, v32
    v_dot2c_f32_bf16 v17, v32, v32
    v_dot2c_f32_bf16 v18, s25, v34
    v_dot2c_f32_bf16 v19, v34, v34
    v_dot2c_f32_bf16 v16, s25, v33
    v_dot2c_f32_bf16 v17, v33, v33
    v_dot2c_f32_bf16 v18, s25, v35
    v_dot2c_f32_bf16 v19, v35, v35
    s_waitcnt lgkmcnt(4)
    v_dot2c_f32_bf16 v16, s25, v36
    v_dot2c_f32_bf16 v17, v36, v36
    v_dot2c_f32_bf16 v18, s25, v38
    v_dot2c_f32_bf16 v19, v38, v38
    v_dot2c_f32_bf16 v16, s25, v37
    v_dot2c_f32_bf16 v17, v37, v37
    v_dot2c_f32_bf16 v18, s25, v39
    v_dot2c_f32_bf16 v19, v39, v39
    s_waitcnt lgkmcnt(2)
    v_dot2c_f32_bf16 v16, s25, v40
    v_dot2c_f32_bf16 v17, v40, v40
    v_dot2c_f32_bf16 v18, s25, v42
    v_dot2c_f32_bf16 v19, v42, v42
    v_dot2c_f32_bf16 v16, s25, v41
    v_dot2c_f32_bf16 v17, v41, v41
    v_dot2c_f32_bf16 v18, s25, v43
    v_dot2c_f32_bf16 v19, v43, v43
    s_waitcnt lgkmcnt(0)
    v_dot2c_f32_bf16 v16, s25, v44
    v_dot2c_f32_bf16 v17, v44, v44
    v_dot2c_f32_bf16 v18, s25, v46
    v_dot2c_f32_bf16 v19, v46, v46
    v_dot2c_f32_bf16 v16, s25, v45
    v_dot2c_f32_bf16 v17, v45, v45
    v_dot2c_f32_bf16 v18, s25, v47
    v_dot2c_f32_bf16 v19, v47, v47
    s_waitcnt vmcnt(8)
    ds_read_b64_tr_b16 v[32:33], v8 offset:16384
    ds_read_b64_tr_b16 v[34:35], v9 offset:16384
    ds_read_b64_tr_b16 v[36:37], v8 offset:20480
    ds_read_b64_tr_b16 v[38:39], v9 offset:20480
    ds_read_b64_tr_b16 v[40:41], v8 offset:24576
    ds_read_b64_tr_b16 v[42:43], v9 offset:24576
    ds_read_b64_tr_b16 v[44:45], v8 offset:28672
    ds_read_b64_tr_b16 v[46:47], v9 offset:28672
    s_waitcnt lgkmcnt(6)
    v_dot2c_f32_bf16 v16, s25, v32
    v_dot2c_f32_bf16 v17, v32, v32
    v_dot2c_f32_bf16 v18, s25, v34
    v_dot2c_f32_bf16 v19, v34, v34
    v_dot2c_f32_bf16 v16, s25, v33
    v_dot2c_f32_bf16 v17, v33, v33
    v_dot2c_f32_bf16 v18, s25, v35
    v_dot2c_f32_bf16 v19, v35, v35
    s_waitcnt lgkmcnt(4)
    v_dot2c_f32_bf16 v16, s25, v36
    v_dot2c_f32_bf16 v17, v36, v36
    v_dot2c_f32_bf16 v18, s25, v38
    v_dot2c_f32_bf16 v19, v38, v38
    v_dot2c_f32_bf16 v16, s25, v37
    v_dot2c_f32_bf16 v17, v37, v37
    v_dot2c_f32_bf16 v18, s25, v39
    v_dot2c_f32_bf16 v19, v39, v39
    s_waitcnt lgkmcnt(2)
    v_dot2c_f32_bf16 v16, s25, v40
    v_dot2c_f32_bf16 v17, v40, v40
    v_dot2c_f32_bf16 v18, s25, v42
    v_dot2c_f32_bf16 v19, v42, v42
    v_dot2c_f32_bf16 v16, s25, v41
    v_dot2c_f32_bf16 v17, v41, v41
    v_dot2c_f32_bf16 v18, s25, v43
    v_dot2c_f32_bf16 v19, v43, v43
    s_waitcnt lgkmcnt(0)
    v_dot2c_f32_bf16 v16, s25, v44
    v_dot2c_f32_bf16 v17, v44, v44
    v_dot2c_f32_bf16 v18, s25, v46
    v_dot2c_f32_bf16 v19, v46, v46
    v_dot2c_f32_bf16 v16, s25, v45
    v_dot2c_f32_bf16 v17, v45, v45
    v_dot2c_f32_bf16 v18, s25, v47
    v_dot2c_f32_bf16 v19, v47, v47
    s_nop 2
    ds_write_b128 v28, v[16:19]
    s_waitcnt lgkmcnt(0)
    s_barrier
    s_cmp_lg_u32 s10, 1
    s_cbranch_scc1 ffn_help1_1
    ds_read_b64 v[32:33], v30 offset:0
    ds_read_b64 v[34:35], v30 offset:512
    ds_read_b64 v[36:37], v30 offset:1024
    ds_read_b64 v[38:39], v30 offset:1536
    ds_read_b64 v[40:41], v30 offset:2048
    ds_read_b64 v[42:43], v30 offset:2560
    ds_read_b64 v[44:45], v30 offset:3072
    ds_read_b64 v[46:47], v30 offset:3584
    s_waitcnt lgkmcnt(0)
    v_pk_add_f32 v[32:33], v[32:33], v[40:41]
    v_pk_add_f32 v[34:35], v[34:35], v[42:43]
    v_pk_add_f32 v[36:37], v[36:37], v[44:45]
    v_pk_add_f32 v[38:39], v[38:39], v[46:47]
    v_pk_add_f32 v[32:33], v[32:33], v[36:37]
    v_pk_add_f32 v[34:35], v[34:35], v[38:39]
    v_pk_add_f32 v[32:33], v[32:33], v[34:35]
    v_or_b32 v33, 1, v33
    global_store_dwordx2 v12, v[32:33], s[8:9] sc1
ffn_help1_1:
    s_waitcnt vmcnt(0)
    s_barrier
    ds_read_b64_tr_b16 v[20:21], v11 offset:0
    ds_read_b64_tr_b16 v[22:23], v11 offset:1024
    ds_read_b64_tr_b16 v[24:25], v10 offset:0
    ds_read_b64_tr_b16 v[26:27], v10 offset:1024
    v_and_b32 v3, 31, v1
    v_lshrrev_b32 v4, 5, v1
    s_lshl_b32 s24, s32, 5
    v_add_u32 v3, s24, v3
    s_lshl_b32 s24, s46, 1
    s_add_u32 s44, s6, s24
    s_addc_u32 s45, s7, 0
    v_lshlrev_b32 v28, 4, v4
    v_lshl_add_u32 v28, v3, 10, v28
    s_lshl_b32 s24, s10, 13
    s_add_u32 s24, s24, 65536
    v_add_u32 v10, s24, v5
    v_xor_b32 v11, 0x2000, v10
    v_xor_b32 v13, 0x4000, v10
    v_xor_b32 v6, 0x6000, v10
    s_waitcnt lgkmcnt(0)
ffn_hpHE_1:
    s_sleep 2
    global_load_dword v31, v15, s[8:9] offset:8 sc1
    s_waitcnt vmcnt(0)
    v_cmp_gt_u32 vcc, 1, v31
    s_nop 1
    s_and_b64 exec, exec, vcc
    s_cbranch_execnz ffn_hpHE_1
    s_mov_b64 exec, -1
    global_load_dwordx4 v[128:131], v7, s[42:43] offset:0 sc1
    global_load_dwordx4 v[132:135], v7, s[42:43] offset:1024 sc1
    global_load_dwordx4 v[136:139], v7, s[42:43] offset:2048 sc1
    global_load_dwordx4 v[140:143], v7, s[42:43] offset:3072 sc1
    v_add_u32 v7, 4096, v7
    global_load_dwordx4 v[144:147], v7, s[42:43] offset:0 sc1
    global_load_dwordx4 v[148:151], v7, s[42:43] offset:1024 sc1
    global_load_dwordx4 v[32:35], v7, s[42:43] offset:2048 sc1
    global_load_dwordx4 v[36:39], v7, s[42:43] offset:3072 sc1
    v_add_u32 v7, 4096, v7
    global_load_dwordx4 v[40:43], v7, s[42:43] offset:0 sc1
    global_load_dwordx4 v[44:47], v7, s[42:43] offset:1024 sc1
    s_waitcnt vmcnt(0)
    s_branch ffn_g2_1
code_end:
.section .rodata,"a"
.p2align 6
.amdhsa_kernel interleave_layers__ssm_conv_s4d__dense_activation_silu__prompt_kernel
  .amdhsa_next_free_vgpr 512
  .amdhsa_next_free_sgpr 72
  .amdhsa_accum_offset 256
  .amdhsa_group_segment_fixed_size 0
  .amdhsa_kernarg_size 104
  .amdhsa_user_sgpr_count 2
  .amdhsa_user_sgpr_kernarg_segment_ptr 1
  .amdhsa_system_sgpr_workgroup_id_x 1
.end_amdhsa_kernel
```
